```python
import torch

def _softmax(x, axis=-1):
    return torch.softmax(x, dim=axis)
def _gelu(x):
    return torch.nn.functional.gelu(x, approximate="tanh")
def _silu(x):
    return torch.nn.functional.silu(x)
def _sigmoid(x):
    return torch.sigmoid(x)
def _layernorm(x, axis=-1, eps=1e-5):
    m = x.mean(dim=axis, keepdim=True)
    v = x.var(dim=axis, keepdim=True, unbiased=False)
    return (x - m) / torch.sqrt(v + eps)
def _scatter_add(tgt, idx, src, axis=0):
    return tgt.clone().index_add_(axis, idx, src)
def _segment_sum(src, seg, n):
    out = torch.zeros((n,) + src.shape[1:], dtype=src.dtype)
    return out.index_add_(0, seg, src)
def _pad(x, pw):
    flat = tuple(v for pair in reversed(pw) for v in pair)
    return torch.nn.functional.pad(x, flat)

kernel_name = 'sequential_preLN__ssm_conv_s4d__glu_gated_bilinear__prompt'

def setup_inputs():

    _w = (lambda a: (lambda t: t.to(torch.bfloat16) if t.is_floating_point() else t)(torch.as_tensor(a)))
    def _A_setup():
        Bsz, L, D, N = 1, 2048, 576, 128
        return {
            "u": _w((lambda *s: torch.randn(*s, dtype=torch.bfloat16) * 0.05)(Bsz, L, D)),
            "log_A_real": _w((lambda *s: torch.randn(*s, dtype=torch.bfloat16) * 6.4)(D, N) * 0.5),
            "A_imag": _w((lambda *s: torch.randn(*s, dtype=torch.bfloat16) * 0.05)(D, N) * 3.14),
            "C_real": _w((lambda *s: torch.randn(*s, dtype=torch.bfloat16) * 0.05)(D, N) / N ** 0.5),
            "C_imag": _w((lambda *s: torch.randn(*s, dtype=torch.bfloat16) * 0.05)(D, N) / N ** 0.5),
            "log_dt": _w((lambda *s: torch.randn(*s, dtype=torch.bfloat16) * 0.05)(D) * 0.5 - 4.0),
            "D_skip": _w((lambda *s: torch.randn(*s, dtype=torch.bfloat16) * 0.05)(D)),
        }
    _A_in = _A_setup()

    def _B_setup():
        B, S, D, F = 1, 2048, 576, 4608
        return {
            "x": _w((lambda *s: torch.randn(*s, dtype=torch.bfloat16) * 0.05)(B, S, D)),
            "w_gate": _w((lambda *s: torch.randn(*s, dtype=torch.bfloat16) * 0.4)(D, F) * (D ** -0.5)),
            "w_up": _w((lambda *s: torch.randn(*s, dtype=torch.bfloat16) * 0.4)(D, F) * (D ** -0.5)),
            "w_down": _w((lambda *s: torch.randn(*s, dtype=torch.bfloat16) * 0.4)(F, D) * (F ** -0.5)),
        }
    _B_in = _B_setup()

    return {
        "A_u": _A_in["u"],
        "A_log_A_real": _A_in["log_A_real"],
        "A_A_imag": _A_in["A_imag"],
        "A_C_real": _A_in["C_real"],
        "A_C_imag": _A_in["C_imag"],
        "A_log_dt": _A_in["log_dt"],
        "A_D_skip": _A_in["D_skip"],
        "B_x": _B_in["x"],
        "B_w_gate": _B_in["w_gate"],
        "B_w_up": _B_in["w_up"],
        "B_w_down": _B_in["w_down"],
    }

def reference(A_u, A_log_A_real, A_A_imag, A_C_real, A_C_imag, A_log_dt, A_D_skip, B_x, B_w_gate, B_w_up, B_w_down):
    def _A_ref(u, log_A_real, A_imag, C_real, C_imag, log_dt, D_skip):
        L = u.shape[1]
        dt = torch.exp(log_dt)
        A = -torch.exp(log_A_real) + 1j * A_imag
        C = (C_real + 1j * C_imag) * dt[:, None]
        pos = (lambda x, dt: x.to(dt))(torch.arange(L), log_dt.dtype)
        P = torch.exp((A * dt[:, None])[:, :, None] * pos[None, None, :])
        K = 2.0 * torch.einsum("dn,dnl->dl", C, P).real
        L2 = 2 * L
        u_t = (lambda x, *d: x.permute(*d))(u, 0, 2, 1)
        Kf = (lambda x, *a, **k: torch.fft.rfft(x.float(), *a, **k))(K, L2)
        Uf = (lambda x, *a, **k: torch.fft.rfft(x.float(), *a, **k))(u_t, L2)
        y = (lambda x, *a, **k: torch.fft.irfft(x, *a, **k).to(torch.bfloat16))(Uf * Kf[None, :, :], L2)[:, :, :L]
        y = (lambda x, *d: x.permute(*d))(y, 0, 2, 1)
        return y + u * D_skip[None, None, :]

    def _B_ref(x, w_gate, w_up, w_down):
        g = torch.einsum("bsd,df->bsf", x, w_gate)
        u = torch.einsum("bsd,df->bsf", x, w_up)
        h = g * u
        return torch.einsum("bsf,fd->bsd", h, w_down)

    x = A_u
    h = x + _A_ref(_layernorm(x, axis=-1), A_log_A_real, A_A_imag, A_C_real, A_C_imag, A_log_dt, A_D_skip)
    h2 = h + _B_ref(_layernorm(h, axis=-1), B_w_gate, B_w_up, B_w_down)
    return h2
```

```asm
; @launch kernel=k1_kernel grid=(400,1,1) block=(256,1,1) lds=73728
; @launch kernel=k3_kernel grid=(256,1,1) block=(256,1,1) lds=160768
.amdgcn_target "amdgcn-amd-amdhsa--gfx950"
.text
.globl k1_kernel
.p2align 8
.type k1_kernel,@function
k1_kernel:
    s_getpc_b64 s[70:71]
PF_1:
    v_lshlrev_b32 v1, 7, v0
    v_min_u32 v1, K1_END-PF_1, v1
    global_load_dword v247, v1, s[70:71]
    s_sub_u32 s3, s2, 0
    s_cmp_lt_u32 s2, 144
    s_cbranch_scc1 ROLE_2
    s_sub_u32 s3, s2, 144
    s_cmp_lt_u32 s2, 256
    s_cbranch_scc1 ROLE_3
    s_sub_u32 s3, s2, 144
    s_cmp_lt_u32 s2, 272
    s_cbranch_scc1 ROLE_3
    s_sub_u32 s3, s2, 272
    s_cmp_lt_u32 s2, 400
    s_cbranch_scc1 ROLE_4
    s_endpgm
ROLE_2:
    s_setprio 2
    s_load_dwordx8 s[4:11], s[0:1], 8
    s_load_dwordx4 s[12:15], s[0:1], 40
    s_load_dwordx4 s[36:39], s[0:1], 96
    v_lshrrev_b32 v1, 6, v0
    v_and_b32 v2, 63, v0
    v_readfirstlane_b32 s16, v1
    s_lshl_b32 s17, s3, 2
    s_add_u32 s17, s17, s16
    s_lshl_b32 s20, s17, 8
    v_lshlrev_b32 v29, 2, v2
    v_add_u32 v3, s20, v29
    s_lshr_b32 s21, s17, 1
    s_lshl_b32 s21, s21, 2
    v_mov_b32 v23, 0
    v_lshlrev_b32 v24, 7, v2
    s_lshl_b32 s56, s17, 20
    s_add_u32 s57, s56, 8192
    s_waitcnt lgkmcnt(0)
    global_load_dword v4, v3, s[4:5] nt
    global_load_dword v5, v3, s[6:7] nt
    global_load_dword v6, v3, s[8:9] nt
    global_load_dword v7, v3, s[10:11] nt
    s_load_dword s22, s[12:13], s21
    s_load_dword s20, s[14:15], s21
    s_add_u32 s52, s38, 9650176
    s_addc_u32 s53, s39, 0
    s_and_b32 s53, s53, 0xffff
    s_mov_b32 s54, 16384
    s_mov_b32 s55, 0x00020000
    buffer_store_dword v23, v24, s[52:55], s56 offen sc1
    buffer_store_dword v23, v24, s[52:55], s57 offen sc1
    s_mul_i32 s26, s16, 17984
    s_mov_b32 s23, 0xffff
    s_mov_b32 s24, 0xffff0000
    s_add_u32 s30, s26, 16416
    s_mov_b32 m0, s26
    v_lshlrev_b32 v8, 3, v2
    v_sub_u32 v8, 1535, v8
    v_subrev_u32 v9, 0, v8
    v_subrev_u32 v10, 1, v8
    v_cvt_f32_i32 v11, v9
    v_cvt_f32_i32 v12, v10
    v_cvt_pk_bf16_f32 v11, v11, v12
    v_and_b32 v12, s23, v11
    v_lshrrev_b32 v11, 16, v11
    v_subrev_u32 v12, 0x4280, v12
    v_subrev_u32 v11, 0x4280, v11
    v_lshl_add_u32 v180, v12, 1, s30
    v_lshl_add_u32 v181, v11, 1, s30
    v_subrev_u32 v9, 2, v8
    v_subrev_u32 v10, 3, v8
    v_cvt_f32_i32 v11, v9
    v_cvt_f32_i32 v12, v10
    v_cvt_pk_bf16_f32 v11, v11, v12
    v_and_b32 v12, s23, v11
    v_lshrrev_b32 v11, 16, v11
    v_subrev_u32 v12, 0x4280, v12
    v_subrev_u32 v11, 0x4280, v11
    v_lshl_add_u32 v182, v12, 1, s30
    v_lshl_add_u32 v183, v11, 1, s30
    v_subrev_u32 v9, 4, v8
    v_subrev_u32 v10, 5, v8
    v_cvt_f32_i32 v11, v9
    v_cvt_f32_i32 v12, v10
    v_cvt_pk_bf16_f32 v11, v11, v12
    v_and_b32 v12, s23, v11
    v_lshrrev_b32 v11, 16, v11
    v_subrev_u32 v12, 0x4280, v12
    v_subrev_u32 v11, 0x4280, v11
    v_lshl_add_u32 v184, v12, 1, s30
    v_lshl_add_u32 v185, v11, 1, s30
    v_subrev_u32 v9, 6, v8
    v_subrev_u32 v10, 7, v8
    v_cvt_f32_i32 v11, v9
    v_cvt_f32_i32 v12, v10
    v_cvt_pk_bf16_f32 v11, v11, v12
    v_and_b32 v12, s23, v11
    v_lshrrev_b32 v11, 16, v11
    v_subrev_u32 v12, 0x4280, v12
    v_subrev_u32 v11, 0x4280, v11
    v_lshl_add_u32 v186, v12, 1, s30
    v_lshl_add_u32 v187, v11, 1, s30
    v_subrev_u32 v9, 8, v8
    v_cvt_f32_i32 v11, v9
    v_cvt_pk_bf16_f32 v11, v11, v11
    v_and_b32 v12, s23, v11
    v_subrev_u32 v12, 0x4280, v12
    v_lshl_add_u32 v188, v12, 1, s30
    v_lshlrev_b32 v8, 3, v2
    v_sub_u32 v8, 1023, v8
    v_subrev_u32 v9, 0, v8
    v_subrev_u32 v10, 1, v8
    v_cvt_f32_i32 v11, v9
    v_cvt_f32_i32 v12, v10
    v_cvt_pk_bf16_f32 v11, v11, v12
    v_and_b32 v12, s23, v11
    v_lshrrev_b32 v11, 16, v11
    v_subrev_u32 v12, 0x4280, v12
    v_subrev_u32 v11, 0x4280, v11
    v_lshl_add_u32 v189, v12, 1, s30
    v_lshl_add_u32 v190, v11, 1, s30
    v_subrev_u32 v9, 2, v8
    v_subrev_u32 v10, 3, v8
    v_cvt_f32_i32 v11, v9
    v_cvt_f32_i32 v12, v10
    v_cvt_pk_bf16_f32 v11, v11, v12
    v_and_b32 v12, s23, v11
    v_lshrrev_b32 v11, 16, v11
    v_subrev_u32 v12, 0x4280, v12
    v_subrev_u32 v11, 0x4280, v11
    v_lshl_add_u32 v191, v12, 1, s30
    v_lshl_add_u32 v192, v11, 1, s30
    v_subrev_u32 v9, 4, v8
    v_subrev_u32 v10, 5, v8
    v_cvt_f32_i32 v11, v9
    v_cvt_f32_i32 v12, v10
    v_cvt_pk_bf16_f32 v11, v11, v12
    v_and_b32 v12, s23, v11
    v_lshrrev_b32 v11, 16, v11
    v_subrev_u32 v12, 0x4280, v12
    v_subrev_u32 v11, 0x4280, v11
    v_lshl_add_u32 v193, v12, 1, s30
    v_lshl_add_u32 v194, v11, 1, s30
    v_subrev_u32 v9, 6, v8
    v_subrev_u32 v10, 7, v8
    v_cvt_f32_i32 v11, v9
    v_cvt_f32_i32 v12, v10
    v_cvt_pk_bf16_f32 v11, v11, v12
    v_and_b32 v12, s23, v11
    v_lshrrev_b32 v11, 16, v11
    v_subrev_u32 v12, 0x4280, v12
    v_subrev_u32 v11, 0x4280, v11
    v_lshl_add_u32 v195, v12, 1, s30
    v_lshl_add_u32 v196, v11, 1, s30
    v_subrev_u32 v9, 8, v8
    v_cvt_f32_i32 v11, v9
    v_cvt_pk_bf16_f32 v11, v11, v11
    v_and_b32 v12, s23, v11
    v_subrev_u32 v12, 0x4280, v12
    v_lshl_add_u32 v197, v12, 1, s30
    v_lshlrev_b32 v8, 3, v2
    v_sub_u32 v8, 511, v8
    v_subrev_u32 v9, 0, v8
    v_subrev_u32 v10, 1, v8
    v_cvt_f32_i32 v11, v9
    v_cvt_f32_i32 v12, v10
    v_cvt_pk_bf16_f32 v11, v11, v12
    v_and_b32 v12, s23, v11
    v_lshrrev_b32 v11, 16, v11
    v_subrev_u32 v12, 0x4280, v12
    v_subrev_u32 v11, 0x4280, v11
    v_cmp_gt_i32 vcc, 0x100, v9
    s_nop 1
    v_cndmask_b32 v12, v12, v9, vcc
    v_cmp_gt_i32 vcc, 0x100, v10
    s_nop 1
    v_cndmask_b32 v11, v11, v10, vcc
    v_lshl_add_u32 v198, v12, 1, s30
    v_lshl_add_u32 v199, v11, 1, s30
    v_subrev_u32 v9, 2, v8
    v_subrev_u32 v10, 3, v8
    v_cvt_f32_i32 v11, v9
    v_cvt_f32_i32 v12, v10
    v_cvt_pk_bf16_f32 v11, v11, v12
    v_and_b32 v12, s23, v11
    v_lshrrev_b32 v11, 16, v11
    v_subrev_u32 v12, 0x4280, v12
    v_subrev_u32 v11, 0x4280, v11
    v_cmp_gt_i32 vcc, 0x100, v9
    s_nop 1
    v_cndmask_b32 v12, v12, v9, vcc
    v_cmp_gt_i32 vcc, 0x100, v10
    s_nop 1
    v_cndmask_b32 v11, v11, v10, vcc
    v_lshl_add_u32 v200, v12, 1, s30
    v_lshl_add_u32 v201, v11, 1, s30
    v_subrev_u32 v9, 4, v8
    v_subrev_u32 v10, 5, v8
    v_cvt_f32_i32 v11, v9
    v_cvt_f32_i32 v12, v10
    v_cvt_pk_bf16_f32 v11, v11, v12
    v_and_b32 v12, s23, v11
    v_lshrrev_b32 v11, 16, v11
    v_subrev_u32 v12, 0x4280, v12
    v_subrev_u32 v11, 0x4280, v11
    v_cmp_gt_i32 vcc, 0x100, v9
    s_nop 1
    v_cndmask_b32 v12, v12, v9, vcc
    v_cmp_gt_i32 vcc, 0x100, v10
    s_nop 1
    v_cndmask_b32 v11, v11, v10, vcc
    v_lshl_add_u32 v202, v12, 1, s30
    v_lshl_add_u32 v203, v11, 1, s30
    v_subrev_u32 v9, 6, v8
    v_subrev_u32 v10, 7, v8
    v_cvt_f32_i32 v11, v9
    v_cvt_f32_i32 v12, v10
    v_cvt_pk_bf16_f32 v11, v11, v12
    v_and_b32 v12, s23, v11
    v_lshrrev_b32 v11, 16, v11
    v_subrev_u32 v12, 0x4280, v12
    v_subrev_u32 v11, 0x4280, v11
    v_cmp_gt_i32 vcc, 0x100, v9
    s_nop 1
    v_cndmask_b32 v12, v12, v9, vcc
    v_cmp_gt_i32 vcc, 0x100, v10
    s_nop 1
    v_cndmask_b32 v11, v11, v10, vcc
    v_lshl_add_u32 v204, v12, 1, s30
    v_lshl_add_u32 v205, v11, 1, s30
    v_subrev_u32 v9, 8, v8
    v_cvt_f32_i32 v11, v9
    v_cvt_pk_bf16_f32 v11, v11, v11
    v_and_b32 v12, s23, v11
    v_subrev_u32 v12, 0x4280, v12
    v_cmp_gt_i32 vcc, 0x100, v9
    s_nop 1
    v_cndmask_b32 v12, v12, v9, vcc
    v_mov_b32 v10, 0x300
    v_cmp_gt_i32 vcc, 0, v9
    s_nop 1
    v_cndmask_b32 v12, v12, v10, vcc
    v_lshl_add_u32 v206, v12, 1, s30
    v_add_u32 v13, s26, v29
    v_and_b32 v15, 15, v2
    v_lshrrev_b32 v16, 4, v2
    v_mul_u32_u24 v14, 288, v15
    v_lshl_add_u32 v14, v16, 4, v14
    v_add_u32 v14, s26, v14
    v_lshrrev_b32 v44, 1, v16
    v_and_b32 v45, 1, v16
    v_lshlrev_b32 v170, 8, v44
    v_lshl_add_u32 v170, v45, 3, v170
    v_lshl_add_u32 v170, v15, 4, v170
    v_add_u32 v170, s30, v170
    v_sub_u32 v46, 3, v44
    v_lshlrev_b32 v171, v46, v15
    v_lshl_add_u32 v171, v16, 7, v171
    v_add_u32 v171, s30, v171
    v_mul_u32_u24 v172, 60, v44
    v_add3_u32 v172, v172, v171, 4
    v_lshlrev_b32 v173, 7, v16
    v_lshl_add_u32 v173, v15, 1, v173
    v_add_u32 v173, s30, v173
    s_and_b32 s28, s17, 1
    s_lshl_b32 s28, s28, 4
    s_waitcnt lgkmcnt(0)
    s_lshr_b32 s22, s22, s28
    s_lshl_b32 s22, s22, 16
    s_lshr_b32 s20, s20, s28
    s_lshl_b32 s20, s20, 16
    v_mov_b32 v17, 1069066811
    v_mul_f32 v17, s22, v17
    v_exp_f32 v17, v17
    s_nop 0
    v_cvt_pk_bf16_f32 v17, 0, v17
    s_mov_b32 s40, s36
    s_and_b32 s41, s37, 0xffff
    s_mov_b32 s42, 256
    s_mov_b32 s43, 0x00020000
    v_and_b32 v22, 3, v2
    v_bfe_u32 v23, v2, 2, 3
    v_lshl_add_u32 v22, v23, 4, v22
    v_lshlrev_b32 v22, 7, v22
    s_lshl_b32 s19, s16, 9
    v_mov_b32 v23, 0
    s_add_u32 s44, s38, 0
    s_addc_u32 s45, s39, 0
    s_and_b32 s45, s45, 0xffff
    s_mov_b32 s46, 4718592
    s_mov_b32 s47, 0x00020000
    s_add_u32 s48, s38, 10485760
    s_addc_u32 s49, s39, 0
    s_and_b32 s49, s49, 0xffff
    s_mov_b32 s50, 2359296
    s_mov_b32 s51, 0x00020000
    v_mov_b32 v156, 0
    v_mov_b32 v157, 0
    v_mov_b32 v158, 0
    v_mov_b32 v159, 0
    v_mov_b32 v160, 0
    v_mov_b32 v161, 0
    v_mov_b32 v162, 0
    v_mov_b32 v163, 0
    v_mov_b32 v164, 0
    v_mov_b32 v165, 0
    v_mov_b32 v166, 0
    v_mov_b32 v167, 0
    v_lshlrev_b32 v24, 16, v2
    v_mov_b32 v25, 1
    s_waitcnt vmcnt(0)
    buffer_store_dword v25, v24, s[40:43], s56 offen sc1
    v_lshlrev_b32 v18, 16, v6
    v_and_b32 v19, s24, v6
    v_lshlrev_b32 v20, 16, v7
    v_and_b32 v21, s24, v7
    v_max3_f32 v18, |v18|, |v19|, |v20|
    v_max_f32 v18, v18, |v21|
    s_nop 1
    v_max_f32_dpp v18, v18, v18 row_ror:8 row_mask:0xf bank_mask:0xf
    s_nop 1
    v_max_f32_dpp v18, v18, v18 row_ror:4 row_mask:0xf bank_mask:0xf
    s_nop 1
    v_max_f32_dpp v18, v18, v18 row_ror:2 row_mask:0xf bank_mask:0xf
    s_nop 1
    v_max_f32_dpp v18, v18, v18 row_ror:1 row_mask:0xf bank_mask:0xf
    v_mov_b32 v19, v18
    s_nop 1
    v_permlane16_swap_b32 v18, v19
    v_max_f32 v18, v18, v19
    v_mov_b32 v19, v18
    s_nop 1
    v_permlane32_swap_b32 v18, v19
    v_max_f32 v18, v18, v19
    v_frexp_exp_i32_f32 v19, v18
    v_sub_u32 v20, 0, v19
    v_add_u32 v19, 1, v19
    v_ldexp_f32 v21, v17, v19
    s_mov_b32 s27, 16
    v_readfirstlane_b32 s21, v21
C2_HALF:
    v_lshlrev_b32 v8, s27, v4
    v_and_b32 v8, s24, v8
    v_lshlrev_b32 v9, s27, v5
    v_and_b32 v9, s24, v9
    v_lshlrev_b32 v10, s27, v6
    v_and_b32 v10, s24, v10
    v_lshlrev_b32 v11, s27, v7
    v_and_b32 v11, s24, v11
    v_mul_f32 v8, 1069066811, v8
    v_exp_f32 v8, v8
    v_ldexp_f32 v30, v10, v20
    v_ldexp_f32 v31, v11, v20
    v_cvt_pk_bf16_f32 v8, 0, v8
    v_mul_f32 v9, v9, v17
    v_mul_f32 v8, v8, v17
    v_mul_f32 v9, 1042479491, v9
    v_mul_f32 v8, 3216550459, v8
    v_mul_f32 v90, 1.0, v8
    v_mul_f32 v93, 1.0, v9
    v_mul_f32 v91, 0x41000000, v8
    v_mul_f32 v94, 0x41000000, v9
    v_mul_f32 v92, 0x43000000, v8
    v_mul_f32 v95, 0x43000000, v9
    v_exp_f32 v90, v90
    v_fract_f32 v93, v93
    v_exp_f32 v91, v91
    v_fract_f32 v94, v94
    v_exp_f32 v92, v92
    v_fract_f32 v95, v95
    v_cos_f32 v32, v93
    v_sin_f32 v33, v93
    v_cos_f32 v34, v94
    v_sin_f32 v35, v94
    v_cos_f32 v36, v95
    v_sin_f32 v37, v95
    v_mul_f32 v32, v90, v32
    v_mul_f32 v33, v90, v33
    v_mul_f32 v34, v91, v34
    v_mul_f32 v35, v91, v35
    v_mul_f32 v36, v92, v36
    v_mul_f32 v37, v92, v37
    v_cvt_pk_f16_f32 v90, v30, -v31
    v_mov_b32 v89, 0x3c00
    v_pk_mul_f32 v[70:71], v[36:37], v[36:37] op_sel:[0,0] op_sel_hi:[0,1]
    ds_write_addtid_b32 v90 offset:11808
    ds_write_addtid_b32 v89 offset:0
    v_pk_fma_f32 v[70:71], v[36:37], v[36:37], v[70:71] op_sel:[1,1,0] op_sel_hi:[1,0,1] neg_lo:[1,0,0]
    v_cvt_pk_f16_f32 v91, v70, v71
    ds_write_addtid_b32 v91 offset:4608
    v_pk_mul_f32 v[26:27], v[30:31], v[34:35] op_sel:[0,0] op_sel_hi:[0,1]
    v_cvt_pk_f16_f32 v93, v32, v33
    v_pk_mul_f32 v[72:73], v[70:71], v[36:37] op_sel:[0,0] op_sel_hi:[0,1]
    v_pk_fma_f32 v[26:27], v[30:31], v[34:35], v[26:27] op_sel:[1,1,0] op_sel_hi:[1,0,1] neg_lo:[1,0,0]
    ds_write_addtid_b32 v93 offset:288
    v_pk_fma_f32 v[72:73], v[70:71], v[36:37], v[72:73] op_sel:[1,1,0] op_sel_hi:[1,0,1] neg_lo:[1,0,0]
    v_cvt_pk_f16_f32 v92, v26, -v27
    v_cvt_pk_f16_f32 v94, v72, v73
    ds_write_addtid_b32 v92 offset:12096
    ds_write_addtid_b32 v94 offset:5760
    v_pk_mul_f32 v[30:31], v[26:27], v[34:35] op_sel:[0,0] op_sel_hi:[0,1]
    v_cvt_pk_f16_f32 v96, v36, v37
    v_pk_mul_f32 v[74:75], v[72:73], v[36:37] op_sel:[0,0] op_sel_hi:[0,1]
    v_pk_fma_f32 v[30:31], v[26:27], v[34:35], v[30:31] op_sel:[1,1,0] op_sel_hi:[1,0,1] neg_lo:[1,0,0]
    ds_write_addtid_b32 v96 offset:2304
    v_pk_fma_f32 v[74:75], v[72:73], v[36:37], v[74:75] op_sel:[1,1,0] op_sel_hi:[1,0,1] neg_lo:[1,0,0]
    v_cvt_pk_f16_f32 v95, v30, -v31
    v_cvt_pk_f16_f32 v97, v74, v75
    ds_write_addtid_b32 v95 offset:12384
    ds_write_addtid_b32 v97 offset:6912
    v_pk_mul_f32 v[26:27], v[30:31], v[34:35] op_sel:[0,0] op_sel_hi:[0,1]
    v_pk_mul_f32 v[40:41], v[32:33], v[32:33] op_sel:[0,0] op_sel_hi:[0,1]
    v_pk_mul_f32 v[76:77], v[74:75], v[36:37] op_sel:[0,0] op_sel_hi:[0,1]
    v_pk_fma_f32 v[26:27], v[30:31], v[34:35], v[26:27] op_sel:[1,1,0] op_sel_hi:[1,0,1] neg_lo:[1,0,0]
    v_pk_fma_f32 v[40:41], v[32:33], v[32:33], v[40:41] op_sel:[1,1,0] op_sel_hi:[1,0,1] neg_lo:[1,0,0]
    v_pk_fma_f32 v[76:77], v[74:75], v[36:37], v[76:77] op_sel:[1,1,0] op_sel_hi:[1,0,1] neg_lo:[1,0,0]
    v_cvt_pk_f16_f32 v90, v26, -v27
    v_cvt_pk_f16_f32 v91, v40, v41
    v_cvt_pk_f16_f32 v92, v76, v77
    ds_write_addtid_b32 v90 offset:12672
    ds_write_addtid_b32 v91 offset:576
    ds_write_addtid_b32 v92 offset:7488
    v_pk_mul_f32 v[30:31], v[26:27], v[34:35] op_sel:[0,0] op_sel_hi:[0,1]
    v_pk_mul_f32 v[42:43], v[40:41], v[32:33] op_sel:[0,0] op_sel_hi:[0,1]
    v_pk_mul_f32 v[78:79], v[76:77], v[36:37] op_sel:[0,0] op_sel_hi:[0,1]
    v_pk_fma_f32 v[30:31], v[26:27], v[34:35], v[30:31] op_sel:[1,1,0] op_sel_hi:[1,0,1] neg_lo:[1,0,0]
    v_pk_fma_f32 v[42:43], v[40:41], v[32:33], v[42:43] op_sel:[1,1,0] op_sel_hi:[1,0,1] neg_lo:[1,0,0]
    v_pk_fma_f32 v[78:79], v[76:77], v[36:37], v[78:79] op_sel:[1,1,0] op_sel_hi:[1,0,1] neg_lo:[1,0,0]
    v_cvt_pk_f16_f32 v93, v30, -v31
    v_cvt_pk_f16_f32 v94, v42, v43
    v_cvt_pk_f16_f32 v95, v78, v79
    ds_write_addtid_b32 v93 offset:12960
    ds_write_addtid_b32 v94 offset:864
    ds_write_addtid_b32 v95 offset:8064
    v_pk_mul_f32 v[26:27], v[30:31], v[34:35] op_sel:[0,0] op_sel_hi:[0,1]
    v_pk_mul_f32 v[44:45], v[42:43], v[32:33] op_sel:[0,0] op_sel_hi:[0,1]
    v_pk_mul_f32 v[80:81], v[78:79], v[36:37] op_sel:[0,0] op_sel_hi:[0,1]
    v_pk_fma_f32 v[26:27], v[30:31], v[34:35], v[26:27] op_sel:[1,1,0] op_sel_hi:[1,0,1] neg_lo:[1,0,0]
    v_pk_fma_f32 v[44:45], v[42:43], v[32:33], v[44:45] op_sel:[1,1,0] op_sel_hi:[1,0,1] neg_lo:[1,0,0]
    v_pk_fma_f32 v[80:81], v[78:79], v[36:37], v[80:81] op_sel:[1,1,0] op_sel_hi:[1,0,1] neg_lo:[1,0,0]
    v_cvt_pk_f16_f32 v96, v26, -v27
    v_cvt_pk_f16_f32 v97, v44, v45
    v_cvt_pk_f16_f32 v90, v80, v81
    ds_write_addtid_b32 v96 offset:13248
    ds_write_addtid_b32 v97 offset:1152
    ds_write_addtid_b32 v90 offset:8640
    v_pk_mul_f32 v[30:31], v[26:27], v[34:35] op_sel:[0,0] op_sel_hi:[0,1]
    v_pk_mul_f32 v[46:47], v[44:45], v[32:33] op_sel:[0,0] op_sel_hi:[0,1]
    v_pk_mul_f32 v[82:83], v[80:81], v[36:37] op_sel:[0,0] op_sel_hi:[0,1]
    v_pk_fma_f32 v[30:31], v[26:27], v[34:35], v[30:31] op_sel:[1,1,0] op_sel_hi:[1,0,1] neg_lo:[1,0,0]
    v_pk_fma_f32 v[46:47], v[44:45], v[32:33], v[46:47] op_sel:[1,1,0] op_sel_hi:[1,0,1] neg_lo:[1,0,0]
    v_pk_fma_f32 v[82:83], v[80:81], v[36:37], v[82:83] op_sel:[1,1,0] op_sel_hi:[1,0,1] neg_lo:[1,0,0]
    v_cvt_pk_f16_f32 v91, v30, -v31
    v_cvt_pk_f16_f32 v92, v46, v47
    v_cvt_pk_f16_f32 v93, v82, v83
    ds_write_addtid_b32 v91 offset:13536
    ds_write_addtid_b32 v92 offset:1440
    ds_write_addtid_b32 v93 offset:9216
    v_pk_mul_f32 v[26:27], v[30:31], v[34:35] op_sel:[0,0] op_sel_hi:[0,1]
    v_pk_mul_f32 v[48:49], v[46:47], v[32:33] op_sel:[0,0] op_sel_hi:[0,1]
    v_pk_mul_f32 v[84:85], v[82:83], v[36:37] op_sel:[0,0] op_sel_hi:[0,1]
    v_pk_fma_f32 v[26:27], v[30:31], v[34:35], v[26:27] op_sel:[1,1,0] op_sel_hi:[1,0,1] neg_lo:[1,0,0]
    v_pk_fma_f32 v[48:49], v[46:47], v[32:33], v[48:49] op_sel:[1,1,0] op_sel_hi:[1,0,1] neg_lo:[1,0,0]
    v_pk_fma_f32 v[84:85], v[82:83], v[36:37], v[84:85] op_sel:[1,1,0] op_sel_hi:[1,0,1] neg_lo:[1,0,0]
    v_cvt_pk_f16_f32 v94, v26, -v27
    v_cvt_pk_f16_f32 v95, v48, v49
    v_cvt_pk_f16_f32 v96, v84, v85
    ds_write_addtid_b32 v94 offset:13824
    ds_write_addtid_b32 v95 offset:1728
    ds_write_addtid_b32 v96 offset:9504
    v_pk_mul_f32 v[30:31], v[26:27], v[34:35] op_sel:[0,0] op_sel_hi:[0,1]
    v_pk_mul_f32 v[50:51], v[48:49], v[32:33] op_sel:[0,0] op_sel_hi:[0,1]
    v_pk_mul_f32 v[82:83], v[84:85], v[36:37] op_sel:[0,0] op_sel_hi:[0,1]
    v_pk_fma_f32 v[30:31], v[26:27], v[34:35], v[30:31] op_sel:[1,1,0] op_sel_hi:[1,0,1] neg_lo:[1,0,0]
    v_pk_fma_f32 v[50:51], v[48:49], v[32:33], v[50:51] op_sel:[1,1,0] op_sel_hi:[1,0,1] neg_lo:[1,0,0]
    v_pk_fma_f32 v[82:83], v[84:85], v[36:37], v[82:83] op_sel:[1,1,0] op_sel_hi:[1,0,1] neg_lo:[1,0,0]
    v_cvt_pk_f16_f32 v97, v30, -v31
    v_cvt_pk_f16_f32 v90, v50, v51
    v_cvt_pk_f16_f32 v91, v82, v83
    ds_write_addtid_b32 v97 offset:14112
    ds_write_addtid_b32 v90 offset:2016
    ds_write_addtid_b32 v91 offset:9792
    v_pk_mul_f32 v[26:27], v[30:31], v[34:35] op_sel:[0,0] op_sel_hi:[0,1]
    v_pk_mul_f32 v[60:61], v[36:37], v[32:33] op_sel:[0,0] op_sel_hi:[0,1]
    v_pk_mul_f32 v[84:85], v[82:83], v[36:37] op_sel:[0,0] op_sel_hi:[0,1]
    v_pk_fma_f32 v[26:27], v[30:31], v[34:35], v[26:27] op_sel:[1,1,0] op_sel_hi:[1,0,1] neg_lo:[1,0,0]
    v_pk_fma_f32 v[60:61], v[36:37], v[32:33], v[60:61] op_sel:[1,1,0] op_sel_hi:[1,0,1] neg_lo:[1,0,0]
    v_pk_fma_f32 v[84:85], v[82:83], v[36:37], v[84:85] op_sel:[1,1,0] op_sel_hi:[1,0,1] neg_lo:[1,0,0]
    v_cvt_pk_f16_f32 v92, v26, -v27
    v_cvt_pk_f16_f32 v93, v60, v61
    v_cvt_pk_f16_f32 v94, v84, v85
    ds_write_addtid_b32 v92 offset:14400
    ds_write_addtid_b32 v93 offset:2592
    ds_write_addtid_b32 v94 offset:10080
    v_pk_mul_f32 v[30:31], v[26:27], v[34:35] op_sel:[0,0] op_sel_hi:[0,1]
    v_pk_mul_f32 v[62:63], v[36:37], v[40:41] op_sel:[0,0] op_sel_hi:[0,1]
    v_pk_mul_f32 v[82:83], v[84:85], v[36:37] op_sel:[0,0] op_sel_hi:[0,1]
    v_pk_fma_f32 v[30:31], v[26:27], v[34:35], v[30:31] op_sel:[1,1,0] op_sel_hi:[1,0,1] neg_lo:[1,0,0]
    v_pk_fma_f32 v[62:63], v[36:37], v[40:41], v[62:63] op_sel:[1,1,0] op_sel_hi:[1,0,1] neg_lo:[1,0,0]
    v_pk_fma_f32 v[82:83], v[84:85], v[36:37], v[82:83] op_sel:[1,1,0] op_sel_hi:[1,0,1] neg_lo:[1,0,0]
    v_cvt_pk_f16_f32 v95, v30, -v31
    v_cvt_pk_f16_f32 v96, v62, v63
    v_cvt_pk_f16_f32 v97, v82, v83
    ds_write_addtid_b32 v95 offset:14688
    ds_write_addtid_b32 v96 offset:2880
    ds_write_addtid_b32 v97 offset:10368
    v_pk_mul_f32 v[26:27], v[30:31], v[34:35] op_sel:[0,0] op_sel_hi:[0,1]
    v_pk_mul_f32 v[64:65], v[36:37], v[42:43] op_sel:[0,0] op_sel_hi:[0,1]
    v_pk_mul_f32 v[84:85], v[82:83], v[36:37] op_sel:[0,0] op_sel_hi:[0,1]
    v_pk_fma_f32 v[26:27], v[30:31], v[34:35], v[26:27] op_sel:[1,1,0] op_sel_hi:[1,0,1] neg_lo:[1,0,0]
    v_pk_fma_f32 v[64:65], v[36:37], v[42:43], v[64:65] op_sel:[1,1,0] op_sel_hi:[1,0,1] neg_lo:[1,0,0]
    v_pk_fma_f32 v[84:85], v[82:83], v[36:37], v[84:85] op_sel:[1,1,0] op_sel_hi:[1,0,1] neg_lo:[1,0,0]
    v_cvt_pk_f16_f32 v90, v26, -v27
    v_cvt_pk_f16_f32 v91, v64, v65
    v_cvt_pk_f16_f32 v92, v84, v85
    ds_write_addtid_b32 v90 offset:14976
    ds_write_addtid_b32 v91 offset:3168
    ds_write_addtid_b32 v92 offset:10656
    v_pk_mul_f32 v[30:31], v[26:27], v[34:35] op_sel:[0,0] op_sel_hi:[0,1]
    v_pk_mul_f32 v[66:67], v[36:37], v[44:45] op_sel:[0,0] op_sel_hi:[0,1]
    v_pk_mul_f32 v[82:83], v[84:85], v[36:37] op_sel:[0,0] op_sel_hi:[0,1]
    v_pk_fma_f32 v[30:31], v[26:27], v[34:35], v[30:31] op_sel:[1,1,0] op_sel_hi:[1,0,1] neg_lo:[1,0,0]
    v_pk_fma_f32 v[66:67], v[36:37], v[44:45], v[66:67] op_sel:[1,1,0] op_sel_hi:[1,0,1] neg_lo:[1,0,0]
    v_pk_fma_f32 v[82:83], v[84:85], v[36:37], v[82:83] op_sel:[1,1,0] op_sel_hi:[1,0,1] neg_lo:[1,0,0]
    v_cvt_pk_f16_f32 v93, v30, -v31
    v_cvt_pk_f16_f32 v94, v66, v67
    v_cvt_pk_f16_f32 v95, v82, v83
    ds_write_addtid_b32 v93 offset:15264
    ds_write_addtid_b32 v94 offset:3456
    ds_write_addtid_b32 v95 offset:10944
    v_pk_mul_f32 v[26:27], v[30:31], v[34:35] op_sel:[0,0] op_sel_hi:[0,1]
    v_pk_mul_f32 v[60:61], v[36:37], v[46:47] op_sel:[0,0] op_sel_hi:[0,1]
    v_pk_mul_f32 v[84:85], v[82:83], v[36:37] op_sel:[0,0] op_sel_hi:[0,1]
    v_pk_fma_f32 v[26:27], v[30:31], v[34:35], v[26:27] op_sel:[1,1,0] op_sel_hi:[1,0,1] neg_lo:[1,0,0]
    v_pk_fma_f32 v[60:61], v[36:37], v[46:47], v[60:61] op_sel:[1,1,0] op_sel_hi:[1,0,1] neg_lo:[1,0,0]
    v_pk_fma_f32 v[84:85], v[82:83], v[36:37], v[84:85] op_sel:[1,1,0] op_sel_hi:[1,0,1] neg_lo:[1,0,0]
    v_cvt_pk_f16_f32 v96, v26, -v27
    v_cvt_pk_f16_f32 v97, v60, v61
    v_cvt_pk_f16_f32 v90, v84, v85
    ds_write_addtid_b32 v96 offset:15552
    ds_write_addtid_b32 v97 offset:3744
    ds_write_addtid_b32 v90 offset:11232
    v_pk_mul_f32 v[30:31], v[26:27], v[34:35] op_sel:[0,0] op_sel_hi:[0,1]
    v_pk_mul_f32 v[62:63], v[36:37], v[48:49] op_sel:[0,0] op_sel_hi:[0,1]
    v_pk_mul_f32 v[82:83], v[84:85], v[36:37] op_sel:[0,0] op_sel_hi:[0,1]
    v_pk_fma_f32 v[30:31], v[26:27], v[34:35], v[30:31] op_sel:[1,1,0] op_sel_hi:[1,0,1] neg_lo:[1,0,0]
    v_pk_fma_f32 v[62:63], v[36:37], v[48:49], v[62:63] op_sel:[1,1,0] op_sel_hi:[1,0,1] neg_lo:[1,0,0]
    v_pk_fma_f32 v[82:83], v[84:85], v[36:37], v[82:83] op_sel:[1,1,0] op_sel_hi:[1,0,1] neg_lo:[1,0,0]
    v_cvt_pk_f16_f32 v91, v30, -v31
    v_cvt_pk_f16_f32 v92, v62, v63
    v_cvt_pk_f16_f32 v93, v82, v83
    ds_write_addtid_b32 v91 offset:15840
    ds_write_addtid_b32 v92 offset:4032
    ds_write_addtid_b32 v93 offset:11520
    v_pk_mul_f32 v[26:27], v[30:31], v[34:35] op_sel:[0,0] op_sel_hi:[0,1]
    v_pk_mul_f32 v[64:65], v[36:37], v[50:51] op_sel:[0,0] op_sel_hi:[0,1]
    v_pk_fma_f32 v[26:27], v[30:31], v[34:35], v[26:27] op_sel:[1,1,0] op_sel_hi:[1,0,1] neg_lo:[1,0,0]
    v_pk_fma_f32 v[64:65], v[36:37], v[50:51], v[64:65] op_sel:[1,1,0] op_sel_hi:[1,0,1] neg_lo:[1,0,0]
    v_cvt_pk_f16_f32 v94, v26, -v27
    v_cvt_pk_f16_f32 v95, v64, v65
    ds_write_addtid_b32 v94 offset:16128
    ds_write_addtid_b32 v95 offset:4320
    v_pk_mul_f32 v[66:67], v[70:71], v[40:41] op_sel:[0,0] op_sel_hi:[0,1]
    v_pk_mul_f32 v[60:61], v[70:71], v[44:45] op_sel:[0,0] op_sel_hi:[0,1]
    v_pk_mul_f32 v[62:63], v[70:71], v[48:49] op_sel:[0,0] op_sel_hi:[0,1]
    v_pk_mul_f32 v[64:65], v[72:73], v[40:41] op_sel:[0,0] op_sel_hi:[0,1]
    v_pk_fma_f32 v[66:67], v[70:71], v[40:41], v[66:67] op_sel:[1,1,0] op_sel_hi:[1,0,1] neg_lo:[1,0,0]
    v_pk_fma_f32 v[60:61], v[70:71], v[44:45], v[60:61] op_sel:[1,1,0] op_sel_hi:[1,0,1] neg_lo:[1,0,0]
    v_pk_fma_f32 v[62:63], v[70:71], v[48:49], v[62:63] op_sel:[1,1,0] op_sel_hi:[1,0,1] neg_lo:[1,0,0]
    v_pk_fma_f32 v[64:65], v[72:73], v[40:41], v[64:65] op_sel:[1,1,0] op_sel_hi:[1,0,1] neg_lo:[1,0,0]
    v_cvt_pk_f16_f32 v96, v66, v67
    v_cvt_pk_f16_f32 v97, v60, v61
    v_cvt_pk_f16_f32 v90, v62, v63
    v_cvt_pk_f16_f32 v91, v64, v65
    ds_write_addtid_b32 v96 offset:4896
    ds_write_addtid_b32 v97 offset:5184
    ds_write_addtid_b32 v90 offset:5472
    ds_write_addtid_b32 v91 offset:6048
    v_pk_mul_f32 v[66:67], v[72:73], v[44:45] op_sel:[0,0] op_sel_hi:[0,1]
    v_pk_mul_f32 v[60:61], v[72:73], v[48:49] op_sel:[0,0] op_sel_hi:[0,1]
    v_pk_mul_f32 v[62:63], v[74:75], v[44:45] op_sel:[0,0] op_sel_hi:[0,1]
    v_pk_mul_f32 v[64:65], v[76:77], v[44:45] op_sel:[0,0] op_sel_hi:[0,1]
    v_pk_fma_f32 v[66:67], v[72:73], v[44:45], v[66:67] op_sel:[1,1,0] op_sel_hi:[1,0,1] neg_lo:[1,0,0]
    v_pk_fma_f32 v[60:61], v[72:73], v[48:49], v[60:61] op_sel:[1,1,0] op_sel_hi:[1,0,1] neg_lo:[1,0,0]
    v_pk_fma_f32 v[62:63], v[74:75], v[44:45], v[62:63] op_sel:[1,1,0] op_sel_hi:[1,0,1] neg_lo:[1,0,0]
    v_pk_fma_f32 v[64:65], v[76:77], v[44:45], v[64:65] op_sel:[1,1,0] op_sel_hi:[1,0,1] neg_lo:[1,0,0]
    v_cvt_pk_f16_f32 v92, v66, v67
    v_cvt_pk_f16_f32 v93, v60, v61
    v_cvt_pk_f16_f32 v94, v62, v63
    v_cvt_pk_f16_f32 v95, v64, v65
    ds_write_addtid_b32 v92 offset:6336
    ds_write_addtid_b32 v93 offset:6624
    ds_write_addtid_b32 v94 offset:7200
    ds_write_addtid_b32 v95 offset:7776
    v_pk_mul_f32 v[66:67], v[78:79], v[44:45] op_sel:[0,0] op_sel_hi:[0,1]
    v_pk_mul_f32 v[60:61], v[80:81], v[44:45] op_sel:[0,0] op_sel_hi:[0,1]
    v_pk_fma_f32 v[66:67], v[78:79], v[44:45], v[66:67] op_sel:[1,1,0] op_sel_hi:[1,0,1] neg_lo:[1,0,0]
    v_pk_fma_f32 v[60:61], v[80:81], v[44:45], v[60:61] op_sel:[1,1,0] op_sel_hi:[1,0,1] neg_lo:[1,0,0]
    v_cvt_pk_f16_f32 v96, v66, v67
    v_cvt_pk_f16_f32 v97, v60, v61
    ds_write_addtid_b32 v96 offset:8352
    ds_write_addtid_b32 v97 offset:8928
    ds_read_b128 v[40:43], v14 offset:11808
    ds_read_b128 v[100:103], v14 offset:0
    ds_read_b128 v[116:119], v14 offset:4608
    ds_read_b128 v[132:135], v14 offset:9216
    ds_read_b128 v[44:47], v14 offset:11872
    ds_read_b128 v[104:107], v14 offset:64
    ds_read_b128 v[120:123], v14 offset:4672
    ds_read_b128 v[136:139], v14 offset:9280
    ds_read_b128 v[48:51], v14 offset:11936
    ds_read_b128 v[108:111], v14 offset:128
    ds_read_b128 v[124:127], v14 offset:4736
    ds_read_b128 v[140:143], v14 offset:9344
    ds_read_b128 v[52:55], v14 offset:12000
    ds_read_b128 v[112:115], v14 offset:192
    ds_read_b128 v[128:131], v14 offset:4800
    ds_read_b128 v[144:147], v14 offset:9408
    s_waitcnt lgkmcnt(12)
    v_mfma_f32_16x16x32_f16 v[156:159], v[100:103], v[40:43], v[156:159]
    v_mfma_f32_16x16x32_f16 v[160:163], v[116:119], v[40:43], v[160:163]
    v_mfma_f32_16x16x32_f16 v[164:167], v[132:135], v[40:43], v[164:167]
    s_waitcnt lgkmcnt(8)
    v_mfma_f32_16x16x32_f16 v[156:159], v[104:107], v[44:47], v[156:159]
    v_mfma_f32_16x16x32_f16 v[160:163], v[120:123], v[44:47], v[160:163]
    v_mfma_f32_16x16x32_f16 v[164:167], v[136:139], v[44:47], v[164:167]
    s_waitcnt lgkmcnt(4)
    v_mfma_f32_16x16x32_f16 v[156:159], v[108:111], v[48:51], v[156:159]
    v_mfma_f32_16x16x32_f16 v[160:163], v[124:127], v[48:51], v[160:163]
    v_mfma_f32_16x16x32_f16 v[164:167], v[140:143], v[48:51], v[164:167]
    s_waitcnt lgkmcnt(0)
    v_mfma_f32_16x16x32_f16 v[156:159], v[112:115], v[52:55], v[156:159]
    v_mfma_f32_16x16x32_f16 v[160:163], v[128:131], v[52:55], v[160:163]
    v_mfma_f32_16x16x32_f16 v[164:167], v[144:147], v[52:55], v[164:167]
    s_sub_u32 s27, s27, 16
    s_cbranch_scc0 C2_HALF
    buffer_load_dword v28, v23, s[40:43], 0 offen sc1
    v_mov_b32 v10, 0
    v_mov_b32 v11, 0
    s_nop 0
    v_cvt_pk_f16_f32 v88, v156, v157
    v_cvt_pk_f16_f32 v89, v158, v159
    ds_write_b64 v170, v[88:89]
    v_cvt_pk_f16_f32 v90, v160, v161
    v_cvt_pk_f16_f32 v91, v162, v163
    ds_write_b32 v171, v90 offset:512
    ds_write_b32 v172, v91 offset:512
    v_cvt_pk_f16_f32 v92, v164, v165
    v_cvt_pk_f16_f32 v93, v166, v167
    ds_write_b16 v173, v92 offset:1024
    ds_write_b16_d16_hi v173, v92 offset:1056
    ds_write_b16 v173, v93 offset:1088
    ds_write_b16_d16_hi v173, v93 offset:1120
    v_mov_b32 v12, s30
    ds_write_b32 v12, v10 offset:1536
    v_lshl_add_u32 v8, v2, 4, s26
    ds_read_u16 v40, v180 offset:128
    ds_read_u16 v41, v181 offset:128
    ds_read_u16 v42, v182 offset:128
    ds_read_u16 v43, v183 offset:128
    ds_read_u16 v44, v184 offset:128
    ds_read_u16 v45, v185 offset:128
    ds_read_u16 v46, v186 offset:128
    ds_read_u16 v47, v187 offset:128
    ds_read_u16 v48, v188 offset:128
    ds_read_u16 v50, v180 offset:0
    ds_read_u16 v51, v181 offset:0
    ds_read_u16 v52, v182 offset:0
    ds_read_u16 v53, v183 offset:0
    ds_read_u16 v54, v184 offset:0
    ds_read_u16 v55, v185 offset:0
    ds_read_u16 v56, v186 offset:0
    ds_read_u16 v57, v187 offset:0
    ds_read_u16 v58, v188 offset:0
    s_waitcnt lgkmcnt(9)
    v_lshl_or_b32 v100, v41, 16, v40
    v_lshl_or_b32 v101, v43, 16, v42
    v_lshl_or_b32 v102, v45, 16, v44
    v_lshl_or_b32 v103, v47, 16, v46
    v_lshl_or_b32 v104, v42, 16, v41
    v_lshl_or_b32 v105, v44, 16, v43
    v_lshl_or_b32 v106, v46, 16, v45
    v_lshl_or_b32 v107, v48, 16, v47
    ds_write_b128 v8, v[100:103] offset:0
    ds_write_b128 v8, v[104:107] offset:4160
    ds_read_u16 v60, v189 offset:0
    ds_read_u16 v61, v190 offset:0
    ds_read_u16 v62, v191 offset:0
    ds_read_u16 v63, v192 offset:0
    ds_read_u16 v64, v193 offset:0
    ds_read_u16 v65, v194 offset:0
    ds_read_u16 v66, v195 offset:0
    ds_read_u16 v67, v196 offset:0
    ds_read_u16 v68, v197 offset:0
    s_waitcnt lgkmcnt(11)
    v_lshl_or_b32 v108, v51, 16, v50
    v_lshl_or_b32 v109, v53, 16, v52
    v_lshl_or_b32 v110, v55, 16, v54
    v_lshl_or_b32 v111, v57, 16, v56
    v_lshl_or_b32 v112, v52, 16, v51
    v_lshl_or_b32 v113, v54, 16, v53
    v_lshl_or_b32 v114, v56, 16, v55
    v_lshl_or_b32 v115, v58, 16, v57
    ds_write_b128 v8, v[108:111] offset:1024
    ds_write_b128 v8, v[112:115] offset:5184
    ds_read_u16 v70, v198 offset:0
    ds_read_u16 v71, v199 offset:0
    ds_read_u16 v72, v200 offset:0
    ds_read_u16 v73, v201 offset:0
    ds_read_u16 v74, v202 offset:0
    ds_read_u16 v75, v203 offset:0
    ds_read_u16 v76, v204 offset:0
    ds_read_u16 v77, v205 offset:0
    ds_read_u16 v78, v206 offset:0
    s_waitcnt lgkmcnt(11)
    v_lshl_or_b32 v116, v61, 16, v60
    v_lshl_or_b32 v117, v63, 16, v62
    v_lshl_or_b32 v118, v65, 16, v64
    v_lshl_or_b32 v119, v67, 16, v66
    v_lshl_or_b32 v120, v62, 16, v61
    v_lshl_or_b32 v121, v64, 16, v63
    v_lshl_or_b32 v122, v66, 16, v65
    v_lshl_or_b32 v123, v68, 16, v67
    ds_write_b128 v8, v[116:119] offset:2048
    ds_write_b128 v8, v[120:123] offset:6208
    s_waitcnt lgkmcnt(2)
    v_lshl_or_b32 v124, v71, 16, v70
    v_lshl_or_b32 v125, v73, 16, v72
    v_lshl_or_b32 v126, v75, 16, v74
    v_lshl_or_b32 v127, v77, 16, v76
    v_lshl_or_b32 v128, v72, 16, v71
    v_lshl_or_b32 v129, v74, 16, v73
    v_lshl_or_b32 v130, v76, 16, v75
    v_lshl_or_b32 v131, v78, 16, v77
    ds_write_b128 v8, v[124:127] offset:3072
    ds_write_b128 v8, v[128:131] offset:7232
    v_and_b32 v4, 15, v0
    v_lshrrev_b32 v3, 4, v0
    v_mul_u32_u24 v3, 36864, v3
    v_lshl_add_u32 v3, v4, 4, v3
    s_lshl_b32 s18, s3, 8
    v_lshrrev_b32 v6, 2, v4
    v_mul_u32_u24 v6, 17984, v6
    v_and_b32 v7, 1, v0
    v_lshl_add_u32 v6, v7, 4, v6
    v_bfe_u32 v7, v0, 1, 1
    v_lshl_add_u32 v6, v7, 12, v6
    v_lshrrev_b32 v7, 4, v0
    v_lshl_add_u32 v6, v7, 5, v6
    v_lshl_add_u32 v9, v2, 3, s26
    ds_write_b64 v9, v[10:11] offset:8320
    v_bfe_u32 v7, v2, 3, 1
    v_mul_u32_u24 v7, 4160, v7
    v_and_b32 v12, 7, v2
    v_lshl_add_u32 v7, v12, 2, v7
    v_add_u32 v7, s26, v7
    ds_write_b32 v7, v10 offset:4096
    s_mov_b32 s31, 300000
C2_RDY:
    s_waitcnt vmcnt(0)
    v_cmp_ne_u32 vcc, 1, v28
    s_nop 3
    s_cbranch_vccz C2_RDY_OK
    s_sleep 2
    buffer_load_dword v28, v23, s[40:43], 0 offen sc1
    s_sub_u32 s31, s31, 1
    s_cmp_lg_u32 s31, 0
    s_cbranch_scc1 C2_RDY
C2_RDY_OK:
    s_mov_b32 s31, 300000
    buffer_load_dword v28, v22, s[52:55], s19 offen sc1
C2_POLL:
    s_waitcnt vmcnt(0)
    v_cmp_ne_u32 vcc, 1, v28
    s_nop 3
    s_cbranch_vccz C2_POLL_OK
    s_sleep 2
    buffer_load_dword v28, v22, s[52:55], s19 offen sc1
    s_sub_u32 s31, s31, 1
    s_cmp_lg_u32 s31, 0
    s_cbranch_scc1 C2_POLL
C2_POLL_OK:
    buffer_load_dwordx4 v[128:131], v3, s[44:47], s18 offen sc1
    s_add_u32 s18, s18, 589824
    buffer_load_dwordx4 v[132:135], v3, s[44:47], s18 offen sc1
    s_add_u32 s18, s18, 589824
    buffer_load_dwordx4 v[136:139], v3, s[44:47], s18 offen sc1
    s_add_u32 s18, s18, 589824
    buffer_load_dwordx4 v[140:143], v3, s[44:47], s18 offen sc1
    s_add_u32 s18, s18, 589824
    buffer_load_dwordx4 v[144:147], v3, s[44:47], s18 offen sc1
    s_add_u32 s18, s18, 589824
    buffer_load_dwordx4 v[148:151], v3, s[44:47], s18 offen sc1
    s_add_u32 s18, s18, 589824
    buffer_load_dwordx4 v[152:155], v3, s[44:47], s18 offen sc1
    s_add_u32 s18, s18, 589824
    buffer_load_dwordx4 v[156:159], v3, s[44:47], s18 offen sc1
    s_add_u32 s18, s18, 589824
    v_lshrrev_b32 v13, 4, v2
    v_lshlrev_b32 v14, 3, v13
    v_sub_u32 v14, v14, v4
    v_add_u32 v14, 15, v14
    v_and_b32 v15, 1, v14
    v_mul_u32_u24 v15, 4160, v15
    v_lshrrev_b32 v14, 1, v14
    v_lshl_add_u32 v15, v14, 2, v15
    v_add_u32 v19, s26, v15
    v_add_u32 v18, 1024, v19
    v_add_u32 v17, 2048, v19
    v_add_u32 v16, 3072, v19
    v_lshlrev_b32 v20, 5, v4
    v_lshl_add_u32 v21, v13, 3, v20
    v_lshl_add_u32 v20, v13, 4, v20
    v_add_u32 v20, s26, v20
    v_add_u32 v21, s26, v21
    v_and_b32 v22, 1, v13
    v_lshrrev_b32 v23, 3, v4
    v_lshl_add_u32 v22, v22, 1, v23
    v_mul_u32_u24 v22, 147456, v22
    v_and_b32 v23, 7, v4
    v_lshl_add_u32 v22, v23, 5, v22
    v_lshrrev_b32 v23, 1, v13
    v_lshl_add_u32 v22, v23, 4, v22
    s_lshl_b32 s32, s17, 8
    s_add_u32 s33, s32, 589824
    s_add_u32 s34, s32, 1179648
    s_add_u32 s35, s32, 1769472
    ds_read2_b32 v[64:65], v16 offset0:240 offset1:241
    ds_read2_b32 v[66:67], v16 offset0:242 offset1:243
    ds_read2_b32 v[68:69], v16 offset0:112 offset1:113
    ds_read2_b32 v[70:71], v16 offset0:114 offset1:115
    ds_read2_b32 v[72:73], v17 offset0:240 offset1:241
    ds_read2_b32 v[74:75], v17 offset0:242 offset1:243
    ds_read2_b32 v[76:77], v17 offset0:112 offset1:113
    ds_read2_b32 v[78:79], v17 offset0:114 offset1:115
    ds_read2_b32 v[80:81], v18 offset0:240 offset1:241
    ds_read2_b32 v[82:83], v18 offset0:242 offset1:243
    ds_read2_b32 v[84:85], v18 offset0:112 offset1:113
    ds_read2_b32 v[86:87], v18 offset0:114 offset1:115
    ds_read2_b32 v[88:89], v19 offset0:240 offset1:241
    ds_read2_b32 v[90:91], v19 offset0:242 offset1:243
    ds_read2_b32 v[92:93], v19 offset0:112 offset1:113
    ds_read2_b32 v[94:95], v19 offset0:114 offset1:115
    s_waitcnt lgkmcnt(0)
    s_barrier
    s_waitcnt vmcnt(7)
    ds_write_b128 v6, v[128:131] offset:8832
    s_waitcnt vmcnt(6)
    ds_write_b128 v6, v[132:135] offset:9344
    s_waitcnt vmcnt(5)
    ds_write_b128 v6, v[136:139] offset:9856
    s_waitcnt vmcnt(4)
    ds_write_b128 v6, v[140:143] offset:10368
    s_waitcnt vmcnt(3)
    ds_write_b128 v6, v[144:147] offset:10880
    s_waitcnt vmcnt(2)
    ds_write_b128 v6, v[148:151] offset:11392
    s_waitcnt vmcnt(1)
    ds_write_b128 v6, v[152:155] offset:11904
    s_waitcnt vmcnt(0)
    ds_write_b128 v6, v[156:159] offset:12416
    s_waitcnt lgkmcnt(0)
    s_barrier
    ds_read_b128 v[128:131], v20 offset:8800
    ds_read_b128 v[132:135], v20 offset:9312
    ds_read_b128 v[136:139], v20 offset:9824
    ds_read_b128 v[140:143], v20 offset:10336
    ds_read_b128 v[144:147], v20 offset:10848
    ds_read_b128 v[148:151], v20 offset:11360
    ds_read_b128 v[152:155], v20 offset:11872
    ds_read_b128 v[156:159], v20 offset:12384
    s_waitcnt lgkmcnt(7)
    v_mfma_f32_16x16x32_f16 v[32:35], v[64:67], v[128:131], 0
    ds_read2_b32 v[96:97], v16 offset0:224 offset1:225
    s_waitcnt lgkmcnt(7)
    v_mfma_f32_16x16x32_f16 v[36:39], v[64:67], v[132:135], 0
    ds_read2_b32 v[98:99], v16 offset0:226 offset1:227
    ds_read_b128 v[188:191], v20 offset:12320
    v_mfma_f32_16x16x32_f16 v[36:39], v[68:71], v[128:131], v[36:39]
    s_waitcnt lgkmcnt(8)
    v_mfma_f32_16x16x32_f16 v[40:43], v[64:67], v[136:139], 0
    v_mfma_f32_16x16x32_f16 v[40:43], v[68:71], v[132:135], v[40:43]
    ds_read2_b32 v[100:101], v16 offset0:96 offset1:97
    ds_read2_b32 v[102:103], v16 offset0:98 offset1:99
    v_mfma_f32_16x16x32_f16 v[40:43], v[72:75], v[128:131], v[40:43]
    ds_read_b128 v[184:187], v20 offset:11808
    s_waitcnt lgkmcnt(10)
    v_mfma_f32_16x16x32_f16 v[44:47], v[64:67], v[140:143], 0
    v_mfma_f32_16x16x32_f16 v[44:47], v[68:71], v[136:139], v[44:47]
    v_mfma_f32_16x16x32_f16 v[44:47], v[72:75], v[132:135], v[44:47]
    ds_read2_b32 v[104:105], v17 offset0:224 offset1:225
    ds_read2_b32 v[106:107], v17 offset0:226 offset1:227
    v_mfma_f32_16x16x32_f16 v[44:47], v[76:79], v[128:131], v[44:47]
    ds_read_b128 v[180:183], v20 offset:11296
    s_waitcnt lgkmcnt(12)
    v_mfma_f32_16x16x32_f16 v[48:51], v[64:67], v[144:147], 0
    v_mfma_f32_16x16x32_f16 v[48:51], v[68:71], v[140:143], v[48:51]
    v_mfma_f32_16x16x32_f16 v[48:51], v[72:75], v[136:139], v[48:51]
    ds_read2_b32 v[108:109], v17 offset0:96 offset1:97
    ds_read2_b32 v[110:111], v17 offset0:98 offset1:99
    v_mfma_f32_16x16x32_f16 v[48:51], v[76:79], v[132:135], v[48:51]
    ds_read_b128 v[176:179], v20 offset:10784
    v_mfma_f32_16x16x32_f16 v[48:51], v[80:83], v[128:131], v[48:51]
    s_waitcnt lgkmcnt(14)
    v_mfma_f32_16x16x32_f16 v[52:55], v[64:67], v[148:151], 0
    v_mfma_f32_16x16x32_f16 v[52:55], v[68:71], v[144:147], v[52:55]
    ds_read2_b32 v[112:113], v18 offset0:224 offset1:225
    ds_read2_b32 v[114:115], v18 offset0:226 offset1:227
    v_mfma_f32_16x16x32_f16 v[52:55], v[72:75], v[140:143], v[52:55]
    ds_read_b128 v[172:175], v20 offset:10272
    v_mfma_f32_16x16x32_f16 v[52:55], v[76:79], v[136:139], v[52:55]
    v_mfma_f32_16x16x32_f16 v[52:55], v[80:83], v[132:135], v[52:55]
    v_mfma_f32_16x16x32_f16 v[52:55], v[84:87], v[128:131], v[52:55]
    ds_read2_b32 v[116:117], v18 offset0:96 offset1:97
    s_waitcnt lgkmcnt(15)
    v_mfma_f32_16x16x32_f16 v[56:59], v[64:67], v[152:155], 0
    ds_read2_b32 v[118:119], v18 offset0:98 offset1:99
    ds_read_b128 v[168:171], v20 offset:9760
    v_mfma_f32_16x16x32_f16 v[56:59], v[68:71], v[148:151], v[56:59]
    v_mfma_f32_16x16x32_f16 v[56:59], v[72:75], v[144:147], v[56:59]
    v_mfma_f32_16x16x32_f16 v[56:59], v[76:79], v[140:143], v[56:59]
    ds_read2_b32 v[120:121], v19 offset0:224 offset1:225
    ds_read2_b32 v[122:123], v19 offset0:226 offset1:227
    v_mfma_f32_16x16x32_f16 v[56:59], v[80:83], v[136:139], v[56:59]
    ds_read_b128 v[164:167], v20 offset:9248
    v_mfma_f32_16x16x32_f16 v[56:59], v[84:87], v[132:135], v[56:59]
    v_mfma_f32_16x16x32_f16 v[56:59], v[88:91], v[128:131], v[56:59]
    v_mfma_f32_16x16x32_f16 v[60:63], v[64:67], v[156:159], 0
    ds_read2_b32 v[124:125], v19 offset0:96 offset1:97
    ds_read2_b32 v[126:127], v19 offset0:98 offset1:99
    v_mfma_f32_16x16x32_f16 v[60:63], v[68:71], v[152:155], v[60:63]
    ds_read_b128 v[160:163], v20 offset:8736
    v_mfma_f32_16x16x32_f16 v[60:63], v[72:75], v[148:151], v[60:63]
    v_mfma_f32_16x16x32_f16 v[60:63], v[76:79], v[144:147], v[60:63]
    v_mfma_f32_16x16x32_f16 v[60:63], v[80:83], v[140:143], v[60:63]
    v_mfma_f32_16x16x32_f16 v[60:63], v[84:87], v[136:139], v[60:63]
    v_mfma_f32_16x16x32_f16 v[60:63], v[88:91], v[132:135], v[60:63]
    v_mfma_f32_16x16x32_f16 v[60:63], v[92:95], v[128:131], v[60:63]
    s_waitcnt lgkmcnt(12)
    v_mfma_f32_16x16x32_f16 v[60:63], v[96:99], v[188:191], v[60:63]
    ds_read2_b32 v[64:65], v16 offset0:208 offset1:209
    ds_read2_b32 v[66:67], v16 offset0:210 offset1:211
    v_mfma_f32_16x16x32_f16 v[60:63], v[100:103], v[184:187], v[60:63]
    ds_read_b128 v[156:159], v20 offset:12256
    v_mfma_f32_16x16x32_f16 v[60:63], v[104:107], v[180:183], v[60:63]
    v_mfma_f32_16x16x32_f16 v[60:63], v[108:111], v[176:179], v[60:63]
    s_waitcnt lgkmcnt(3)
    v_mfma_f32_16x16x32_f16 v[60:63], v[112:115], v[172:175], v[60:63]
    ds_read2_b32 v[68:69], v16 offset0:80 offset1:81
    ds_read2_b32 v[70:71], v16 offset0:82 offset1:83
    v_mfma_f32_16x16x32_f16 v[60:63], v[116:119], v[168:171], v[60:63]
    ds_read_b128 v[152:155], v20 offset:11744
    ds_read_b64 v[224:225], v21 offset:8832
    v_mfma_f32_16x16x32_f16 v[60:63], v[120:123], v[164:167], v[60:63]
    ds_read_b64 v[232:233], v21 offset:12928
    v_mfma_f32_16x16x32_f16 v[60:63], v[124:127], v[160:163], v[60:63]
    v_mfma_f32_16x16x32_f16 v[56:59], v[96:99], v[184:187], v[56:59]
    ds_read2_b32 v[72:73], v17 offset0:208 offset1:209
    ds_read2_b32 v[74:75], v17 offset0:210 offset1:211
    v_mfma_f32_16x16x32_f16 v[56:59], v[100:103], v[180:183], v[56:59]
    ds_read_b128 v[148:151], v20 offset:11232
    v_mfma_f32_16x16x32_f16 v[56:59], v[104:107], v[176:179], v[56:59]
    v_mfma_f32_16x16x32_f16 v[56:59], v[108:111], v[172:175], v[56:59]
    v_mfma_f32_16x16x32_f16 v[56:59], v[112:115], v[168:171], v[56:59]
    ds_read2_b32 v[76:77], v17 offset0:80 offset1:81
    ds_read2_b32 v[78:79], v17 offset0:82 offset1:83
    v_mfma_f32_16x16x32_f16 v[56:59], v[116:119], v[164:167], v[56:59]
    ds_read_b128 v[144:147], v20 offset:10720
    v_mfma_f32_16x16x32_f16 v[56:59], v[120:123], v[160:163], v[56:59]
    v_mfma_f32_16x16x32_f16 v[52:55], v[96:99], v[180:183], v[52:55]
    v_mfma_f32_16x16x32_f16 v[52:55], v[100:103], v[176:179], v[52:55]
    ds_read2_b32 v[80:81], v18 offset0:208 offset1:209
    ds_read2_b32 v[82:83], v18 offset0:210 offset1:211
    v_mfma_f32_16x16x32_f16 v[52:55], v[104:107], v[172:175], v[52:55]
    ds_read_b128 v[140:143], v20 offset:10208
    v_mfma_f32_16x16x32_f16 v[52:55], v[108:111], v[168:171], v[52:55]
    v_mfma_f32_16x16x32_f16 v[52:55], v[112:115], v[164:167], v[52:55]
    v_mfma_f32_16x16x32_f16 v[52:55], v[116:119], v[160:163], v[52:55]
    ds_read2_b32 v[84:85], v18 offset0:80 offset1:81
    ds_read2_b32 v[86:87], v18 offset0:82 offset1:83
    v_mfma_f32_16x16x32_f16 v[48:51], v[96:99], v[176:179], v[48:51]
    ds_read_b128 v[136:139], v20 offset:9696
    v_mfma_f32_16x16x32_f16 v[48:51], v[100:103], v[172:175], v[48:51]
    v_mfma_f32_16x16x32_f16 v[48:51], v[104:107], v[168:171], v[48:51]
    v_mfma_f32_16x16x32_f16 v[48:51], v[108:111], v[164:167], v[48:51]
    ds_read2_b32 v[88:89], v19 offset0:208 offset1:209
    ds_read2_b32 v[90:91], v19 offset0:210 offset1:211
    v_mfma_f32_16x16x32_f16 v[48:51], v[112:115], v[160:163], v[48:51]
    ds_read_b128 v[132:135], v20 offset:9184
    v_mfma_f32_16x16x32_f16 v[44:47], v[96:99], v[172:175], v[44:47]
    v_mfma_f32_16x16x32_f16 v[44:47], v[100:103], v[168:171], v[44:47]
    v_mfma_f32_16x16x32_f16 v[44:47], v[104:107], v[164:167], v[44:47]
    ds_read2_b32 v[92:93], v19 offset0:80 offset1:81
    ds_read2_b32 v[94:95], v19 offset0:82 offset1:83
    v_mfma_f32_16x16x32_f16 v[44:47], v[108:111], v[160:163], v[44:47]
    ds_read_b128 v[128:131], v20 offset:8672
    ds_read_b64 v[226:227], v21 offset:9344
    v_mfma_f32_16x16x32_f16 v[40:43], v[96:99], v[168:171], v[40:43]
    ds_read_b64 v[234:235], v21 offset:13440
    v_mfma_f32_16x16x32_f16 v[40:43], v[100:103], v[164:167], v[40:43]
    v_mfma_f32_16x16x32_f16 v[40:43], v[104:107], v[160:163], v[40:43]
    v_mfma_f32_16x16x32_f16 v[36:39], v[96:99], v[164:167], v[36:39]
    v_mfma_f32_16x16x32_f16 v[36:39], v[100:103], v[160:163], v[36:39]
    v_mfma_f32_16x16x32_f16 v[32:35], v[96:99], v[160:163], v[32:35]
    s_waitcnt lgkmcnt(14)
    v_mfma_f32_16x16x32_f16 v[60:63], v[64:67], v[156:159], v[60:63]
    ds_read2_b32 v[96:97], v16 offset0:192 offset1:193
    ds_read2_b32 v[98:99], v16 offset0:194 offset1:195
    v_mfma_f32_16x16x32_f16 v[60:63], v[68:71], v[152:155], v[60:63]
    ds_read_b128 v[188:191], v20 offset:12192
    v_fma_mix_f32 v192, v224, s20, 0 op_sel:[0,0,0] op_sel_hi:[1,0,0]
    v_mfma_f32_16x16x32_f16 v[60:63], v[72:75], v[148:151], v[60:63]
    v_fma_mix_f32 v193, v224, s20, 0 op_sel:[1,0,0] op_sel_hi:[1,0,0]
    v_fma_mix_f32 v194, v225, s20, 0 op_sel:[0,0,0] op_sel_hi:[1,0,0]
    v_mfma_f32_16x16x32_f16 v[60:63], v[76:79], v[144:147], v[60:63]
    v_fma_mix_f32 v195, v225, s20, 0 op_sel:[1,0,0] op_sel_hi:[1,0,0]
    s_waitcnt lgkmcnt(5)
    v_mfma_f32_16x16x32_f16 v[60:63], v[80:83], v[140:143], v[60:63]
    ds_read2_b32 v[100:101], v16 offset0:64 offset1:65
    ds_read2_b32 v[102:103], v16 offset0:66 offset1:67
    v_mfma_f32_16x16x32_f16 v[60:63], v[84:87], v[136:139], v[60:63]
    ds_read_b128 v[184:187], v20 offset:11680
    v_cvt_pk_bf16_f32 v192, 0, v192
    v_mfma_f32_16x16x32_f16 v[60:63], v[88:91], v[132:135], v[60:63]
    v_cvt_pk_bf16_f32 v193, 0, v193
    v_cvt_pk_bf16_f32 v194, 0, v194
    v_mfma_f32_16x16x32_f16 v[60:63], v[92:95], v[128:131], v[60:63]
    v_cvt_pk_bf16_f32 v195, 0, v195
    v_lshlrev_b32 v228, 16, v232
    v_mfma_f32_16x16x32_f16 v[56:59], v[64:67], v[152:155], v[56:59]
    ds_read2_b32 v[104:105], v17 offset0:192 offset1:193
    ds_read2_b32 v[106:107], v17 offset0:194 offset1:195
    v_mfma_f32_16x16x32_f16 v[56:59], v[68:71], v[148:151], v[56:59]
    ds_read_b128 v[180:183], v20 offset:11168
    v_and_b32 v229, s24, v232
    v_mfma_f32_16x16x32_f16 v[56:59], v[72:75], v[144:147], v[56:59]
    v_lshlrev_b32 v230, 16, v233
    v_and_b32 v231, s24, v233
    v_mfma_f32_16x16x32_f16 v[56:59], v[76:79], v[140:143], v[56:59]
    v_add_f32 v192, v192, v228
    v_add_f32 v193, v193, v229
    v_mfma_f32_16x16x32_f16 v[56:59], v[80:83], v[136:139], v[56:59]
    ds_read2_b32 v[108:109], v17 offset0:64 offset1:65
    ds_read2_b32 v[110:111], v17 offset0:66 offset1:67
    v_mfma_f32_16x16x32_f16 v[56:59], v[84:87], v[132:135], v[56:59]
    ds_read_b128 v[176:179], v20 offset:10656
    v_add_f32 v194, v194, v230
    v_mfma_f32_16x16x32_f16 v[56:59], v[88:91], v[128:131], v[56:59]
    v_add_f32 v195, v195, v231
    v_mfma_f32_16x16x32_f16 v[52:55], v[64:67], v[148:151], v[52:55]
    v_mfma_f32_16x16x32_f16 v[52:55], v[68:71], v[144:147], v[52:55]
    ds_read2_b32 v[112:113], v18 offset0:192 offset1:193
    ds_read2_b32 v[114:115], v18 offset0:194 offset1:195
    v_mfma_f32_16x16x32_f16 v[52:55], v[72:75], v[140:143], v[52:55]
    ds_read_b128 v[172:175], v20 offset:10144
    ds_read_b64 v[224:225], v21 offset:9856
    v_mfma_f32_16x16x32_f16 v[52:55], v[76:79], v[136:139], v[52:55]
    ds_read_b64 v[232:233], v21 offset:13952
    v_mfma_f32_16x16x32_f16 v[52:55], v[80:83], v[132:135], v[52:55]
    v_mfma_f32_16x16x32_f16 v[52:55], v[84:87], v[128:131], v[52:55]
    ds_read2_b32 v[116:117], v18 offset0:64 offset1:65
    ds_read2_b32 v[118:119], v18 offset0:66 offset1:67
    v_mfma_f32_16x16x32_f16 v[48:51], v[64:67], v[144:147], v[48:51]
    ds_read_b128 v[168:171], v20 offset:9632
    v_mfma_f32_16x16x32_f16 v[48:51], v[68:71], v[140:143], v[48:51]
    v_mfma_f32_16x16x32_f16 v[48:51], v[72:75], v[136:139], v[48:51]
    v_mfma_f32_16x16x32_f16 v[48:51], v[76:79], v[132:135], v[48:51]
    ds_read2_b32 v[120:121], v19 offset0:192 offset1:193
    ds_read2_b32 v[122:123], v19 offset0:194 offset1:195
    v_mfma_f32_16x16x32_f16 v[48:51], v[80:83], v[128:131], v[48:51]
    ds_read_b128 v[164:167], v20 offset:9120
    s_waitcnt lgkmcnt(15)
    v_mfma_f32_16x16x32_f16 v[44:47], v[64:67], v[140:143], v[44:47]
    v_fma_mix_f32 v196, v226, s20, 0 op_sel:[0,0,0] op_sel_hi:[1,0,0]
    v_fma_mix_f32 v197, v226, s20, 0 op_sel:[1,0,0] op_sel_hi:[1,0,0]
    v_mfma_f32_16x16x32_f16 v[44:47], v[68:71], v[136:139], v[44:47]
    v_fma_mix_f32 v198, v227, s20, 0 op_sel:[0,0,0] op_sel_hi:[1,0,0]
    v_fma_mix_f32 v199, v227, s20, 0 op_sel:[1,0,0] op_sel_hi:[1,0,0]
    v_mfma_f32_16x16x32_f16 v[44:47], v[72:75], v[132:135], v[44:47]
    ds_read2_b32 v[124:125], v19 offset0:64 offset1:65
    ds_read2_b32 v[126:127], v19 offset0:66 offset1:67
    v_mfma_f32_16x16x32_f16 v[44:47], v[76:79], v[128:131], v[44:47]
    ds_read_b128 v[160:163], v20 offset:8608
    v_cvt_pk_bf16_f32 v196, 0, v196
    v_mfma_f32_16x16x32_f16 v[40:43], v[64:67], v[136:139], v[40:43]
    v_cvt_pk_bf16_f32 v197, 0, v197
    v_cvt_pk_bf16_f32 v198, 0, v198
    v_mfma_f32_16x16x32_f16 v[40:43], v[68:71], v[132:135], v[40:43]
    v_cvt_pk_bf16_f32 v199, 0, v199
    v_lshlrev_b32 v228, 16, v234
    v_mfma_f32_16x16x32_f16 v[40:43], v[72:75], v[128:131], v[40:43]
    v_and_b32 v229, s24, v234
    v_lshlrev_b32 v230, 16, v235
    v_mfma_f32_16x16x32_f16 v[36:39], v[64:67], v[132:135], v[36:39]
    v_and_b32 v231, s24, v235
    v_add_f32 v196, v196, v228
    v_mfma_f32_16x16x32_f16 v[36:39], v[68:71], v[128:131], v[36:39]
    v_add_f32 v197, v197, v229
    v_add_f32 v198, v198, v230
    v_mfma_f32_16x16x32_f16 v[32:35], v[64:67], v[128:131], v[32:35]
    v_add_f32 v199, v199, v231
    s_waitcnt lgkmcnt(14)
    v_mfma_f32_16x16x32_f16 v[60:63], v[96:99], v[188:191], v[60:63]
    ds_read2_b32 v[64:65], v16 offset0:176 offset1:177
    ds_read2_b32 v[66:67], v16 offset0:178 offset1:179
    v_mfma_f32_16x16x32_f16 v[60:63], v[100:103], v[184:187], v[60:63]
    ds_read_b128 v[156:159], v20 offset:12128
    v_mfma_f32_16x16x32_f16 v[60:63], v[104:107], v[180:183], v[60:63]
    v_mfma_f32_16x16x32_f16 v[60:63], v[108:111], v[176:179], v[60:63]
    s_waitcnt lgkmcnt(3)
    v_mfma_f32_16x16x32_f16 v[60:63], v[112:115], v[172:175], v[60:63]
    ds_read2_b32 v[68:69], v16 offset0:48 offset1:49
    ds_read2_b32 v[70:71], v16 offset0:50 offset1:51
    v_mfma_f32_16x16x32_f16 v[60:63], v[116:119], v[168:171], v[60:63]
    ds_read_b128 v[152:155], v20 offset:11616
    ds_read_b64 v[226:227], v21 offset:10368
    v_mfma_f32_16x16x32_f16 v[60:63], v[120:123], v[164:167], v[60:63]
    ds_read_b64 v[234:235], v21 offset:14464
    v_mfma_f32_16x16x32_f16 v[60:63], v[124:127], v[160:163], v[60:63]
    v_mfma_f32_16x16x32_f16 v[56:59], v[96:99], v[184:187], v[56:59]
    ds_read2_b32 v[72:73], v17 offset0:176 offset1:177
    ds_read2_b32 v[74:75], v17 offset0:178 offset1:179
    v_mfma_f32_16x16x32_f16 v[56:59], v[100:103], v[180:183], v[56:59]
    ds_read_b128 v[148:151], v20 offset:11104
    v_mfma_f32_16x16x32_f16 v[56:59], v[104:107], v[176:179], v[56:59]
    v_mfma_f32_16x16x32_f16 v[56:59], v[108:111], v[172:175], v[56:59]
    v_mfma_f32_16x16x32_f16 v[56:59], v[112:115], v[168:171], v[56:59]
    ds_read2_b32 v[76:77], v17 offset0:48 offset1:49
    ds_read2_b32 v[78:79], v17 offset0:50 offset1:51
    v_mfma_f32_16x16x32_f16 v[56:59], v[116:119], v[164:167], v[56:59]
    ds_read_b128 v[144:147], v20 offset:10592
    v_fma_mix_f32 v200, v224, s20, 0 op_sel:[0,0,0] op_sel_hi:[1,0,0]
    v_mfma_f32_16x16x32_f16 v[56:59], v[120:123], v[160:163], v[56:59]
    v_fma_mix_f32 v201, v224, s20, 0 op_sel:[1,0,0] op_sel_hi:[1,0,0]
    v_fma_mix_f32 v202, v225, s20, 0 op_sel:[0,0,0] op_sel_hi:[1,0,0]
    v_mfma_f32_16x16x32_f16 v[52:55], v[96:99], v[180:183], v[52:55]
    v_fma_mix_f32 v203, v225, s20, 0 op_sel:[1,0,0] op_sel_hi:[1,0,0]
    v_cvt_pk_bf16_f32 v200, 0, v200
    v_mfma_f32_16x16x32_f16 v[52:55], v[100:103], v[176:179], v[52:55]
    ds_read2_b32 v[80:81], v18 offset0:176 offset1:177
    ds_read2_b32 v[82:83], v18 offset0:178 offset1:179
    v_mfma_f32_16x16x32_f16 v[52:55], v[104:107], v[172:175], v[52:55]
    ds_read_b128 v[140:143], v20 offset:10080
    v_cvt_pk_bf16_f32 v201, 0, v201
    v_mfma_f32_16x16x32_f16 v[52:55], v[108:111], v[168:171], v[52:55]
    v_cvt_pk_bf16_f32 v202, 0, v202
    v_cvt_pk_bf16_f32 v203, 0, v203
    v_mfma_f32_16x16x32_f16 v[52:55], v[112:115], v[164:167], v[52:55]
    v_lshlrev_b32 v228, 16, v232
    v_and_b32 v229, s24, v232
    v_mfma_f32_16x16x32_f16 v[52:55], v[116:119], v[160:163], v[52:55]
    ds_read2_b32 v[84:85], v18 offset0:48 offset1:49
    ds_read2_b32 v[86:87], v18 offset0:50 offset1:51
    v_mfma_f32_16x16x32_f16 v[48:51], v[96:99], v[176:179], v[48:51]
    ds_read_b128 v[136:139], v20 offset:9568
    v_lshlrev_b32 v230, 16, v233
    v_mfma_f32_16x16x32_f16 v[48:51], v[100:103], v[172:175], v[48:51]
    v_and_b32 v231, s24, v233
    v_add_f32 v200, v200, v228
    v_mfma_f32_16x16x32_f16 v[48:51], v[104:107], v[168:171], v[48:51]
    v_add_f32 v201, v201, v229
    v_add_f32 v202, v202, v230
    v_mfma_f32_16x16x32_f16 v[48:51], v[108:111], v[164:167], v[48:51]
    ds_read2_b32 v[88:89], v19 offset0:176 offset1:177
    ds_read2_b32 v[90:91], v19 offset0:178 offset1:179
    v_mfma_f32_16x16x32_f16 v[48:51], v[112:115], v[160:163], v[48:51]
    ds_read_b128 v[132:135], v20 offset:9056
    v_add_f32 v203, v203, v231
    v_mfma_f32_16x16x32_f16 v[44:47], v[96:99], v[172:175], v[44:47]
    v_mfma_f32_16x16x32_f16 v[44:47], v[100:103], v[168:171], v[44:47]
    v_mfma_f32_16x16x32_f16 v[44:47], v[104:107], v[164:167], v[44:47]
    ds_read2_b32 v[92:93], v19 offset0:48 offset1:49
    ds_read2_b32 v[94:95], v19 offset0:50 offset1:51
    v_mfma_f32_16x16x32_f16 v[44:47], v[108:111], v[160:163], v[44:47]
    ds_read_b128 v[128:131], v20 offset:8544
    ds_read_b64 v[224:225], v21 offset:10880
    v_mfma_f32_16x16x32_f16 v[40:43], v[96:99], v[168:171], v[40:43]
    ds_read_b64 v[232:233], v21 offset:14976
    v_mfma_f32_16x16x32_f16 v[40:43], v[100:103], v[164:167], v[40:43]
    v_mfma_f32_16x16x32_f16 v[40:43], v[104:107], v[160:163], v[40:43]
    v_mfma_f32_16x16x32_f16 v[36:39], v[96:99], v[164:167], v[36:39]
    v_mfma_f32_16x16x32_f16 v[36:39], v[100:103], v[160:163], v[36:39]
    v_mfma_f32_16x16x32_f16 v[32:35], v[96:99], v[160:163], v[32:35]
    s_waitcnt lgkmcnt(14)
    v_mfma_f32_16x16x32_f16 v[60:63], v[64:67], v[156:159], v[60:63]
    ds_read2_b32 v[96:97], v16 offset0:160 offset1:161
    ds_read2_b32 v[98:99], v16 offset0:162 offset1:163
    v_mfma_f32_16x16x32_f16 v[60:63], v[68:71], v[152:155], v[60:63]
    ds_read_b128 v[188:191], v20 offset:12064
    v_fma_mix_f32 v204, v226, s20, 0 op_sel:[0,0,0] op_sel_hi:[1,0,0]
    v_mfma_f32_16x16x32_f16 v[60:63], v[72:75], v[148:151], v[60:63]
    v_fma_mix_f32 v205, v226, s20, 0 op_sel:[1,0,0] op_sel_hi:[1,0,0]
    v_fma_mix_f32 v206, v227, s20, 0 op_sel:[0,0,0] op_sel_hi:[1,0,0]
    v_mfma_f32_16x16x32_f16 v[60:63], v[76:79], v[144:147], v[60:63]
    v_fma_mix_f32 v207, v227, s20, 0 op_sel:[1,0,0] op_sel_hi:[1,0,0]
    s_waitcnt lgkmcnt(5)
    v_mfma_f32_16x16x32_f16 v[60:63], v[80:83], v[140:143], v[60:63]
    ds_read2_b32 v[100:101], v16 offset0:32 offset1:33
    ds_read2_b32 v[102:103], v16 offset0:34 offset1:35
    v_mfma_f32_16x16x32_f16 v[60:63], v[84:87], v[136:139], v[60:63]
    ds_read_b128 v[184:187], v20 offset:11552
    v_cvt_pk_bf16_f32 v204, 0, v204
    v_mfma_f32_16x16x32_f16 v[60:63], v[88:91], v[132:135], v[60:63]
    v_cvt_pk_bf16_f32 v205, 0, v205
    v_cvt_pk_bf16_f32 v206, 0, v206
    v_mfma_f32_16x16x32_f16 v[60:63], v[92:95], v[128:131], v[60:63]
    v_cvt_pk_bf16_f32 v207, 0, v207
    v_lshlrev_b32 v228, 16, v234
    v_mfma_f32_16x16x32_f16 v[56:59], v[64:67], v[152:155], v[56:59]
    ds_read2_b32 v[104:105], v17 offset0:160 offset1:161
    ds_read2_b32 v[106:107], v17 offset0:162 offset1:163
    v_mfma_f32_16x16x32_f16 v[56:59], v[68:71], v[148:151], v[56:59]
    ds_read_b128 v[180:183], v20 offset:11040
    v_and_b32 v229, s24, v234
    v_mfma_f32_16x16x32_f16 v[56:59], v[72:75], v[144:147], v[56:59]
    v_lshlrev_b32 v230, 16, v235
    v_and_b32 v231, s24, v235
    v_mfma_f32_16x16x32_f16 v[56:59], v[76:79], v[140:143], v[56:59]
    v_add_f32 v204, v204, v228
    v_add_f32 v205, v205, v229
    v_mfma_f32_16x16x32_f16 v[56:59], v[80:83], v[136:139], v[56:59]
    ds_read2_b32 v[108:109], v17 offset0:32 offset1:33
    ds_read2_b32 v[110:111], v17 offset0:34 offset1:35
    v_mfma_f32_16x16x32_f16 v[56:59], v[84:87], v[132:135], v[56:59]
    ds_read_b128 v[176:179], v20 offset:10528
    v_add_f32 v206, v206, v230
    v_mfma_f32_16x16x32_f16 v[56:59], v[88:91], v[128:131], v[56:59]
    v_add_f32 v207, v207, v231
    v_mfma_f32_16x16x32_f16 v[52:55], v[64:67], v[148:151], v[52:55]
    v_mfma_f32_16x16x32_f16 v[52:55], v[68:71], v[144:147], v[52:55]
    ds_read2_b32 v[112:113], v18 offset0:160 offset1:161
    ds_read2_b32 v[114:115], v18 offset0:162 offset1:163
    v_mfma_f32_16x16x32_f16 v[52:55], v[72:75], v[140:143], v[52:55]
    ds_read_b128 v[172:175], v20 offset:10016
    ds_read_b64 v[226:227], v21 offset:11392
    v_mfma_f32_16x16x32_f16 v[52:55], v[76:79], v[136:139], v[52:55]
    ds_read_b64 v[234:235], v21 offset:15488
    v_mfma_f32_16x16x32_f16 v[52:55], v[80:83], v[132:135], v[52:55]
    v_mfma_f32_16x16x32_f16 v[52:55], v[84:87], v[128:131], v[52:55]
    ds_read2_b32 v[116:117], v18 offset0:32 offset1:33
    ds_read2_b32 v[118:119], v18 offset0:34 offset1:35
    v_mfma_f32_16x16x32_f16 v[48:51], v[64:67], v[144:147], v[48:51]
    ds_read_b128 v[168:171], v20 offset:9504
    v_mfma_f32_16x16x32_f16 v[48:51], v[68:71], v[140:143], v[48:51]
    v_mfma_f32_16x16x32_f16 v[48:51], v[72:75], v[136:139], v[48:51]
    v_mfma_f32_16x16x32_f16 v[48:51], v[76:79], v[132:135], v[48:51]
    ds_read2_b32 v[120:121], v19 offset0:160 offset1:161
    ds_read2_b32 v[122:123], v19 offset0:162 offset1:163
    v_mfma_f32_16x16x32_f16 v[48:51], v[80:83], v[128:131], v[48:51]
    ds_read_b128 v[164:167], v20 offset:8992
    s_waitcnt lgkmcnt(15)
    v_mfma_f32_16x16x32_f16 v[44:47], v[64:67], v[140:143], v[44:47]
    v_fma_mix_f32 v208, v224, s20, 0 op_sel:[0,0,0] op_sel_hi:[1,0,0]
    v_fma_mix_f32 v209, v224, s20, 0 op_sel:[1,0,0] op_sel_hi:[1,0,0]
    v_mfma_f32_16x16x32_f16 v[44:47], v[68:71], v[136:139], v[44:47]
    v_fma_mix_f32 v210, v225, s20, 0 op_sel:[0,0,0] op_sel_hi:[1,0,0]
    v_fma_mix_f32 v211, v225, s20, 0 op_sel:[1,0,0] op_sel_hi:[1,0,0]
    v_mfma_f32_16x16x32_f16 v[44:47], v[72:75], v[132:135], v[44:47]
    ds_read2_b32 v[124:125], v19 offset0:32 offset1:33
    ds_read2_b32 v[126:127], v19 offset0:34 offset1:35
    v_mfma_f32_16x16x32_f16 v[44:47], v[76:79], v[128:131], v[44:47]
    ds_read_b128 v[160:163], v20 offset:8480
    v_cvt_pk_bf16_f32 v208, 0, v208
    v_mfma_f32_16x16x32_f16 v[40:43], v[64:67], v[136:139], v[40:43]
    v_cvt_pk_bf16_f32 v209, 0, v209
    v_cvt_pk_bf16_f32 v210, 0, v210
    v_mfma_f32_16x16x32_f16 v[40:43], v[68:71], v[132:135], v[40:43]
    v_cvt_pk_bf16_f32 v211, 0, v211
    v_lshlrev_b32 v228, 16, v232
    v_mfma_f32_16x16x32_f16 v[40:43], v[72:75], v[128:131], v[40:43]
    v_and_b32 v229, s24, v232
    v_lshlrev_b32 v230, 16, v233
    v_mfma_f32_16x16x32_f16 v[36:39], v[64:67], v[132:135], v[36:39]
    v_and_b32 v231, s24, v233
    v_add_f32 v208, v208, v228
    v_mfma_f32_16x16x32_f16 v[36:39], v[68:71], v[128:131], v[36:39]
    v_add_f32 v209, v209, v229
    v_add_f32 v210, v210, v230
    v_mfma_f32_16x16x32_f16 v[32:35], v[64:67], v[128:131], v[32:35]
    v_add_f32 v211, v211, v231
    s_waitcnt lgkmcnt(14)
    v_mfma_f32_16x16x32_f16 v[60:63], v[96:99], v[188:191], v[60:63]
    ds_read2_b32 v[64:65], v16 offset0:144 offset1:145
    ds_read2_b32 v[66:67], v16 offset0:146 offset1:147
    v_mfma_f32_16x16x32_f16 v[60:63], v[100:103], v[184:187], v[60:63]
    ds_read_b128 v[156:159], v20 offset:12000
    v_mfma_f32_16x16x32_f16 v[60:63], v[104:107], v[180:183], v[60:63]
    v_mfma_f32_16x16x32_f16 v[60:63], v[108:111], v[176:179], v[60:63]
    s_waitcnt lgkmcnt(3)
    v_mfma_f32_16x16x32_f16 v[60:63], v[112:115], v[172:175], v[60:63]
    ds_read2_b32 v[68:69], v16 offset0:16 offset1:17
    ds_read2_b32 v[70:71], v16 offset0:18 offset1:19
    v_mfma_f32_16x16x32_f16 v[60:63], v[116:119], v[168:171], v[60:63]
    ds_read_b128 v[152:155], v20 offset:11488
    ds_read_b64 v[224:225], v21 offset:11904
    v_mfma_f32_16x16x32_f16 v[60:63], v[120:123], v[164:167], v[60:63]
    ds_read_b64 v[232:233], v21 offset:16000
    v_mfma_f32_16x16x32_f16 v[60:63], v[124:127], v[160:163], v[60:63]
    v_mfma_f32_16x16x32_f16 v[56:59], v[96:99], v[184:187], v[56:59]
    ds_read2_b32 v[72:73], v17 offset0:144 offset1:145
    ds_read2_b32 v[74:75], v17 offset0:146 offset1:147
    v_mfma_f32_16x16x32_f16 v[56:59], v[100:103], v[180:183], v[56:59]
    ds_read_b128 v[148:151], v20 offset:10976
    v_mfma_f32_16x16x32_f16 v[56:59], v[104:107], v[176:179], v[56:59]
    v_mfma_f32_16x16x32_f16 v[56:59], v[108:111], v[172:175], v[56:59]
    v_mfma_f32_16x16x32_f16 v[56:59], v[112:115], v[168:171], v[56:59]
    ds_read2_b32 v[76:77], v17 offset0:16 offset1:17
    ds_read2_b32 v[78:79], v17 offset0:18 offset1:19
    v_mfma_f32_16x16x32_f16 v[56:59], v[116:119], v[164:167], v[56:59]
    ds_read_b128 v[144:147], v20 offset:10464
    v_fma_mix_f32 v212, v226, s20, 0 op_sel:[0,0,0] op_sel_hi:[1,0,0]
    v_mfma_f32_16x16x32_f16 v[56:59], v[120:123], v[160:163], v[56:59]
    v_fma_mix_f32 v213, v226, s20, 0 op_sel:[1,0,0] op_sel_hi:[1,0,0]
    v_fma_mix_f32 v214, v227, s20, 0 op_sel:[0,0,0] op_sel_hi:[1,0,0]
    v_mfma_f32_16x16x32_f16 v[52:55], v[96:99], v[180:183], v[52:55]
    v_fma_mix_f32 v215, v227, s20, 0 op_sel:[1,0,0] op_sel_hi:[1,0,0]
    v_cvt_pk_bf16_f32 v212, 0, v212
    v_mfma_f32_16x16x32_f16 v[52:55], v[100:103], v[176:179], v[52:55]
    ds_read2_b32 v[80:81], v18 offset0:144 offset1:145
    ds_read2_b32 v[82:83], v18 offset0:146 offset1:147
    v_mfma_f32_16x16x32_f16 v[52:55], v[104:107], v[172:175], v[52:55]
    ds_read_b128 v[140:143], v20 offset:9952
    v_cvt_pk_bf16_f32 v213, 0, v213
    v_mfma_f32_16x16x32_f16 v[52:55], v[108:111], v[168:171], v[52:55]
    v_cvt_pk_bf16_f32 v214, 0, v214
    v_cvt_pk_bf16_f32 v215, 0, v215
    v_mfma_f32_16x16x32_f16 v[52:55], v[112:115], v[164:167], v[52:55]
    v_lshlrev_b32 v228, 16, v234
    v_and_b32 v229, s24, v234
    v_mfma_f32_16x16x32_f16 v[52:55], v[116:119], v[160:163], v[52:55]
    ds_read2_b32 v[84:85], v18 offset0:16 offset1:17
    ds_read2_b32 v[86:87], v18 offset0:18 offset1:19
    v_mfma_f32_16x16x32_f16 v[48:51], v[96:99], v[176:179], v[48:51]
    ds_read_b128 v[136:139], v20 offset:9440
    v_lshlrev_b32 v230, 16, v235
    v_mfma_f32_16x16x32_f16 v[48:51], v[100:103], v[172:175], v[48:51]
    v_and_b32 v231, s24, v235
    v_add_f32 v212, v212, v228
    v_mfma_f32_16x16x32_f16 v[48:51], v[104:107], v[168:171], v[48:51]
    v_add_f32 v213, v213, v229
    v_add_f32 v214, v214, v230
    v_mfma_f32_16x16x32_f16 v[48:51], v[108:111], v[164:167], v[48:51]
    ds_read2_b32 v[88:89], v19 offset0:144 offset1:145
    ds_read2_b32 v[90:91], v19 offset0:146 offset1:147
    v_mfma_f32_16x16x32_f16 v[48:51], v[112:115], v[160:163], v[48:51]
    ds_read_b128 v[132:135], v20 offset:8928
    v_add_f32 v215, v215, v231
    v_mfma_f32_16x16x32_f16 v[44:47], v[96:99], v[172:175], v[44:47]
    v_mfma_f32_16x16x32_f16 v[44:47], v[100:103], v[168:171], v[44:47]
    v_mfma_f32_16x16x32_f16 v[44:47], v[104:107], v[164:167], v[44:47]
    ds_read2_b32 v[92:93], v19 offset0:16 offset1:17
    ds_read2_b32 v[94:95], v19 offset0:18 offset1:19
    v_mfma_f32_16x16x32_f16 v[44:47], v[108:111], v[160:163], v[44:47]
    ds_read_b128 v[128:131], v20 offset:8416
    ds_read_b64 v[226:227], v21 offset:12416
    v_mfma_f32_16x16x32_f16 v[40:43], v[96:99], v[168:171], v[40:43]
    ds_read_b64 v[234:235], v21 offset:16512
    v_mfma_f32_16x16x32_f16 v[40:43], v[100:103], v[164:167], v[40:43]
    v_mfma_f32_16x16x32_f16 v[40:43], v[104:107], v[160:163], v[40:43]
    v_mfma_f32_16x16x32_f16 v[36:39], v[96:99], v[164:167], v[36:39]
    v_mfma_f32_16x16x32_f16 v[36:39], v[100:103], v[160:163], v[36:39]
    v_mfma_f32_16x16x32_f16 v[32:35], v[96:99], v[160:163], v[32:35]
    s_waitcnt lgkmcnt(14)
    v_mfma_f32_16x16x32_f16 v[60:63], v[64:67], v[156:159], v[60:63]
    ds_read2_b32 v[96:97], v16 offset0:128 offset1:129
    ds_read2_b32 v[98:99], v16 offset0:130 offset1:131
    v_mfma_f32_16x16x32_f16 v[60:63], v[68:71], v[152:155], v[60:63]
    ds_read_b128 v[188:191], v20 offset:11936
    v_fma_mix_f32 v216, v224, s20, 0 op_sel:[0,0,0] op_sel_hi:[1,0,0]
    v_mfma_f32_16x16x32_f16 v[60:63], v[72:75], v[148:151], v[60:63]
    v_fma_mix_f32 v217, v224, s20, 0 op_sel:[1,0,0] op_sel_hi:[1,0,0]
    v_fma_mix_f32 v218, v225, s20, 0 op_sel:[0,0,0] op_sel_hi:[1,0,0]
    v_mfma_f32_16x16x32_f16 v[60:63], v[76:79], v[144:147], v[60:63]
    v_fma_mix_f32 v219, v225, s20, 0 op_sel:[1,0,0] op_sel_hi:[1,0,0]
    s_waitcnt lgkmcnt(5)
    v_mfma_f32_16x16x32_f16 v[60:63], v[80:83], v[140:143], v[60:63]
    ds_read2_b32 v[100:101], v16 offset0:0 offset1:1
    ds_read2_b32 v[102:103], v16 offset0:2 offset1:3
    v_mfma_f32_16x16x32_f16 v[60:63], v[84:87], v[136:139], v[60:63]
    ds_read_b128 v[184:187], v20 offset:11424
    v_cvt_pk_bf16_f32 v216, 0, v216
    v_mfma_f32_16x16x32_f16 v[60:63], v[88:91], v[132:135], v[60:63]
    v_cvt_pk_bf16_f32 v217, 0, v217
    v_cvt_pk_bf16_f32 v218, 0, v218
    v_mfma_f32_16x16x32_f16 v[60:63], v[92:95], v[128:131], v[60:63]
    v_cvt_pk_bf16_f32 v219, 0, v219
    v_lshlrev_b32 v228, 16, v232
    v_mfma_f32_16x16x32_f16 v[56:59], v[64:67], v[152:155], v[56:59]
    ds_read2_b32 v[104:105], v17 offset0:128 offset1:129
    ds_read2_b32 v[106:107], v17 offset0:130 offset1:131
    v_mfma_f32_16x16x32_f16 v[56:59], v[68:71], v[148:151], v[56:59]
    ds_read_b128 v[180:183], v20 offset:10912
    v_and_b32 v229, s24, v232
    v_mfma_f32_16x16x32_f16 v[56:59], v[72:75], v[144:147], v[56:59]
    v_lshlrev_b32 v230, 16, v233
    v_and_b32 v231, s24, v233
    v_mfma_f32_16x16x32_f16 v[56:59], v[76:79], v[140:143], v[56:59]
    v_add_f32 v216, v216, v228
    v_add_f32 v217, v217, v229
    v_mfma_f32_16x16x32_f16 v[56:59], v[80:83], v[136:139], v[56:59]
    ds_read2_b32 v[108:109], v17 offset0:0 offset1:1
    ds_read2_b32 v[110:111], v17 offset0:2 offset1:3
    v_mfma_f32_16x16x32_f16 v[56:59], v[84:87], v[132:135], v[56:59]
    ds_read_b128 v[176:179], v20 offset:10400
    v_add_f32 v218, v218, v230
    v_mfma_f32_16x16x32_f16 v[56:59], v[88:91], v[128:131], v[56:59]
    v_add_f32 v219, v219, v231
    v_mfma_f32_16x16x32_f16 v[52:55], v[64:67], v[148:151], v[52:55]
    v_mfma_f32_16x16x32_f16 v[52:55], v[68:71], v[144:147], v[52:55]
    ds_read2_b32 v[112:113], v18 offset0:128 offset1:129
    ds_read2_b32 v[114:115], v18 offset0:130 offset1:131
    v_mfma_f32_16x16x32_f16 v[52:55], v[72:75], v[140:143], v[52:55]
    ds_read_b128 v[172:175], v20 offset:9888
    s_waitcnt lgkmcnt(15)
    v_mfma_f32_16x16x32_f16 v[52:55], v[76:79], v[136:139], v[52:55]
    v_fma_mix_f32 v220, v226, s20, 0 op_sel:[0,0,0] op_sel_hi:[1,0,0]
    v_fma_mix_f32 v221, v226, s20, 0 op_sel:[1,0,0] op_sel_hi:[1,0,0]
    v_mfma_f32_16x16x32_f16 v[52:55], v[80:83], v[132:135], v[52:55]
    v_fma_mix_f32 v222, v227, s20, 0 op_sel:[0,0,0] op_sel_hi:[1,0,0]
    v_fma_mix_f32 v223, v227, s20, 0 op_sel:[1,0,0] op_sel_hi:[1,0,0]
    v_mfma_f32_16x16x32_f16 v[52:55], v[84:87], v[128:131], v[52:55]
    ds_read2_b32 v[116:117], v18 offset0:0 offset1:1
    ds_read2_b32 v[118:119], v18 offset0:2 offset1:3
    v_mfma_f32_16x16x32_f16 v[48:51], v[64:67], v[144:147], v[48:51]
    ds_read_b128 v[168:171], v20 offset:9376
    v_cvt_pk_bf16_f32 v220, 0, v220
    v_mfma_f32_16x16x32_f16 v[48:51], v[68:71], v[140:143], v[48:51]
    v_cvt_pk_bf16_f32 v221, 0, v221
    v_cvt_pk_bf16_f32 v222, 0, v222
    v_mfma_f32_16x16x32_f16 v[48:51], v[72:75], v[136:139], v[48:51]
    v_cvt_pk_bf16_f32 v223, 0, v223
    v_lshlrev_b32 v228, 16, v234
    v_mfma_f32_16x16x32_f16 v[48:51], v[76:79], v[132:135], v[48:51]
    ds_read2_b32 v[120:121], v19 offset0:128 offset1:129
    ds_read2_b32 v[122:123], v19 offset0:130 offset1:131
    v_mfma_f32_16x16x32_f16 v[48:51], v[80:83], v[128:131], v[48:51]
    ds_read_b128 v[164:167], v20 offset:8864
    v_and_b32 v229, s24, v234
    v_mfma_f32_16x16x32_f16 v[44:47], v[64:67], v[140:143], v[44:47]
    v_lshlrev_b32 v230, 16, v235
    v_and_b32 v231, s24, v235
    v_mfma_f32_16x16x32_f16 v[44:47], v[68:71], v[136:139], v[44:47]
    v_add_f32 v220, v220, v228
    v_add_f32 v221, v221, v229
    v_mfma_f32_16x16x32_f16 v[44:47], v[72:75], v[132:135], v[44:47]
    ds_read2_b32 v[124:125], v19 offset0:0 offset1:1
    ds_read2_b32 v[126:127], v19 offset0:2 offset1:3
    v_mfma_f32_16x16x32_f16 v[44:47], v[76:79], v[128:131], v[44:47]
    ds_read_b128 v[160:163], v20 offset:8352
    v_add_f32 v222, v222, v230
    v_mfma_f32_16x16x32_f16 v[40:43], v[64:67], v[136:139], v[40:43]
    v_add_f32 v223, v223, v231
    v_mfma_f32_16x16x32_f16 v[40:43], v[68:71], v[132:135], v[40:43]
    v_mfma_f32_16x16x32_f16 v[40:43], v[72:75], v[128:131], v[40:43]
    v_mfma_f32_16x16x32_f16 v[36:39], v[64:67], v[132:135], v[36:39]
    v_mfma_f32_16x16x32_f16 v[36:39], v[68:71], v[128:131], v[36:39]
    v_mfma_f32_16x16x32_f16 v[32:35], v[64:67], v[128:131], v[32:35]
    s_waitcnt lgkmcnt(12)
    v_mfma_f32_16x16x32_f16 v[60:63], v[96:99], v[188:191], v[60:63]
    v_mfma_f32_16x16x32_f16 v[60:63], v[100:103], v[184:187], v[60:63]
    v_mfma_f32_16x16x32_f16 v[60:63], v[104:107], v[180:183], v[60:63]
    v_mfma_f32_16x16x32_f16 v[60:63], v[108:111], v[176:179], v[60:63]
    s_waitcnt lgkmcnt(0)
    v_mfma_f32_16x16x32_f16 v[60:63], v[112:115], v[172:175], v[60:63]
    v_mfma_f32_16x16x32_f16 v[60:63], v[116:119], v[168:171], v[60:63]
    v_mfma_f32_16x16x32_f16 v[60:63], v[120:123], v[164:167], v[60:63]
    v_mfma_f32_16x16x32_f16 v[60:63], v[124:127], v[160:163], v[60:63]
    v_mfma_f32_16x16x32_f16 v[56:59], v[96:99], v[184:187], v[56:59]
    v_mfma_f32_16x16x32_f16 v[56:59], v[100:103], v[180:183], v[56:59]
    v_mfma_f32_16x16x32_f16 v[56:59], v[104:107], v[176:179], v[56:59]
    v_mfma_f32_16x16x32_f16 v[56:59], v[108:111], v[172:175], v[56:59]
    v_mfma_f32_16x16x32_f16 v[56:59], v[112:115], v[168:171], v[56:59]
    v_mfma_f32_16x16x32_f16 v[56:59], v[116:119], v[164:167], v[56:59]
    v_mfma_f32_16x16x32_f16 v[56:59], v[120:123], v[160:163], v[56:59]
    v_mfma_f32_16x16x32_f16 v[52:55], v[96:99], v[180:183], v[52:55]
    v_fma_f32 v220, v60, s21, v220
    v_fma_f32 v221, v61, s21, v221
    v_mfma_f32_16x16x32_f16 v[52:55], v[100:103], v[176:179], v[52:55]
    v_fma_f32 v222, v62, s21, v222
    v_fma_f32 v223, v63, s21, v223
    v_mfma_f32_16x16x32_f16 v[52:55], v[104:107], v[172:175], v[52:55]
    v_cvt_pk_bf16_f32 v246, v220, v221
    v_cvt_pk_bf16_f32 v247, v222, v223
    v_mfma_f32_16x16x32_f16 v[52:55], v[108:111], v[168:171], v[52:55]
    v_fma_f32 v216, v56, s21, v216
    v_fma_f32 v217, v57, s21, v217
    v_mfma_f32_16x16x32_f16 v[52:55], v[112:115], v[164:167], v[52:55]
    v_fma_f32 v218, v58, s21, v218
    v_fma_f32 v219, v59, s21, v219
    v_mfma_f32_16x16x32_f16 v[52:55], v[116:119], v[160:163], v[52:55]
    v_cvt_pk_bf16_f32 v244, v216, v217
    v_cvt_pk_bf16_f32 v245, v218, v219
    v_mfma_f32_16x16x32_f16 v[48:51], v[96:99], v[176:179], v[48:51]
    v_permlane16_swap_b32 v244, v246
    v_mfma_f32_16x16x32_f16 v[48:51], v[100:103], v[172:175], v[48:51]
    v_permlane16_swap_b32 v245, v247
    v_mfma_f32_16x16x32_f16 v[48:51], v[104:107], v[168:171], v[48:51]
    buffer_store_dwordx4 v[244:247], v22, s[48:51], s35 offen sc1
    v_mfma_f32_16x16x32_f16 v[48:51], v[108:111], v[164:167], v[48:51]
    v_fma_f32 v212, v52, s21, v212
    v_fma_f32 v213, v53, s21, v213
    v_mfma_f32_16x16x32_f16 v[48:51], v[112:115], v[160:163], v[48:51]
    v_fma_f32 v214, v54, s21, v214
    v_fma_f32 v215, v55, s21, v215
    v_mfma_f32_16x16x32_f16 v[44:47], v[96:99], v[172:175], v[44:47]
    v_cvt_pk_bf16_f32 v242, v212, v213
    v_cvt_pk_bf16_f32 v243, v214, v215
    v_mfma_f32_16x16x32_f16 v[44:47], v[100:103], v[168:171], v[44:47]
    v_mfma_f32_16x16x32_f16 v[44:47], v[104:107], v[164:167], v[44:47]
    v_mfma_f32_16x16x32_f16 v[44:47], v[108:111], v[160:163], v[44:47]
    v_fma_f32 v208, v48, s21, v208
    v_fma_f32 v209, v49, s21, v209
    v_mfma_f32_16x16x32_f16 v[40:43], v[96:99], v[168:171], v[40:43]
    v_fma_f32 v210, v50, s21, v210
    v_fma_f32 v211, v51, s21, v211
    v_mfma_f32_16x16x32_f16 v[40:43], v[100:103], v[164:167], v[40:43]
    v_cvt_pk_bf16_f32 v240, v208, v209
    v_cvt_pk_bf16_f32 v241, v210, v211
    v_mfma_f32_16x16x32_f16 v[40:43], v[104:107], v[160:163], v[40:43]
    v_permlane16_swap_b32 v240, v242
    v_mfma_f32_16x16x32_f16 v[36:39], v[96:99], v[164:167], v[36:39]
    v_permlane16_swap_b32 v241, v243
    v_mfma_f32_16x16x32_f16 v[36:39], v[100:103], v[160:163], v[36:39]
    buffer_store_dwordx4 v[240:243], v22, s[48:51], s34 offen sc1
    v_mfma_f32_16x16x32_f16 v[32:35], v[96:99], v[160:163], v[32:35]
    v_fma_f32 v204, v44, s21, v204
    v_fma_f32 v205, v45, s21, v205
    v_fma_f32 v206, v46, s21, v206
    v_fma_f32 v207, v47, s21, v207
    v_cvt_pk_bf16_f32 v246, v204, v205
    v_cvt_pk_bf16_f32 v247, v206, v207
    v_fma_f32 v200, v40, s21, v200
    v_fma_f32 v201, v41, s21, v201
    v_fma_f32 v202, v42, s21, v202
    v_fma_f32 v203, v43, s21, v203
    v_cvt_pk_bf16_f32 v244, v200, v201
    v_cvt_pk_bf16_f32 v245, v202, v203
    s_nop 0
    v_permlane16_swap_b32 v244, v246
    v_permlane16_swap_b32 v245, v247
    buffer_store_dwordx4 v[244:247], v22, s[48:51], s33 offen sc1
    v_fma_f32 v196, v36, s21, v196
    v_fma_f32 v197, v37, s21, v197
    v_fma_f32 v198, v38, s21, v198
    v_fma_f32 v199, v39, s21, v199
    v_cvt_pk_bf16_f32 v242, v196, v197
    v_cvt_pk_bf16_f32 v243, v198, v199
    v_fma_f32 v192, v32, s21, v192
    v_fma_f32 v193, v33, s21, v193
    v_fma_f32 v194, v34, s21, v194
    v_fma_f32 v195, v35, s21, v195
    v_cvt_pk_bf16_f32 v240, v192, v193
    v_cvt_pk_bf16_f32 v241, v194, v195
    s_nop 0
    v_permlane16_swap_b32 v240, v242
    v_permlane16_swap_b32 v241, v243
    buffer_store_dwordx4 v[240:243], v22, s[48:51], s32 offen sc1
    s_endpgm
ROLE_3:
    s_setprio 3
    s_load_dwordx2 s[4:5], s[0:1], 0
    s_load_dwordx2 s[6:7], s[0:1], 104
    s_load_dwordx2 s[22:23], s[0:1], 96
    v_lshrrev_b32 v1, 4, v0
    v_and_b32 v2, 15, v0
    v_mul_u32_u24 v3, 1152, v1
    v_lshl_add_u32 v3, v2, 3, v3
    s_mul_i32 s16, s3, 18432
    s_waitcnt lgkmcnt(0)
    s_mov_b32 s8, s4
    s_and_b32 s9, s5, 0xffff
    s_mov_b32 s10, 2359296
    s_mov_b32 s11, 0x00020000
    buffer_load_dwordx2 v[10:11], v3, s[8:11], s16 offen offset:0 nt
    buffer_load_dwordx2 v[12:13], v3, s[8:11], s16 offen offset:128 nt
    buffer_load_dwordx2 v[14:15], v3, s[8:11], s16 offen offset:256 nt
    buffer_load_dwordx2 v[16:17], v3, s[8:11], s16 offen offset:384 nt
    buffer_load_dwordx2 v[18:19], v3, s[8:11], s16 offen offset:512 nt
    buffer_load_dwordx2 v[20:21], v3, s[8:11], s16 offen offset:640 nt
    buffer_load_dwordx2 v[22:23], v3, s[8:11], s16 offen offset:768 nt
    buffer_load_dwordx2 v[24:25], v3, s[8:11], s16 offen offset:896 nt
    buffer_load_dwordx2 v[26:27], v3, s[8:11], s16 offen offset:1024 nt
    s_add_u32 s12, s6, 0
    s_addc_u32 s13, s7, 0
    s_and_b32 s13, s13, 0xffff
    s_mov_b32 s14, 4718592
    s_mov_b32 s15, 0x00020000
    s_mov_b32 s24, s22
    s_and_b32 s25, s23, 0xffff
    s_mov_b32 s26, 256
    s_mov_b32 s27, 0x00020000
    s_add_u32 s28, s6, 9650176
    s_addc_u32 s29, s7, 0
    s_and_b32 s29, s29, 0xffff
    s_mov_b32 s30, 16384
    s_mov_b32 s31, 0x00020000
    v_mov_b32 v81, 0
    v_mul_u32_u24 v6, 1184, v1
    v_lshrrev_b32 v7, 3, v1
    v_lshl_add_u32 v6, v7, 7, v6
    v_lshl_add_u32 v6, v2, 3, v6
    s_mov_b32 s20, 0x3f803f80
    s_mov_b32 s21, 0xffff0000
    v_mov_b32 v4, 0
    v_mov_b32 v5, 0
    v_and_b32 v40, 63, v0
    v_lshrrev_b32 v41, 6, v0
    v_lshrrev_b32 v42, 4, v40
    v_and_b32 v43, 15, v40
    v_lshrrev_b32 v44, 1, v42
    v_mul_u32_u24 v8, 19200, v44
    v_and_b32 v44, 1, v42
    v_mul_u32_u24 v45, 9600, v44
    v_add_u32 v8, v8, v45
    v_lshrrev_b32 v44, 2, v43
    v_mul_u32_u24 v45, 1184, v44
    v_add_u32 v8, v8, v45
    v_and_b32 v44, 3, v43
    v_lshl_add_u32 v8, v44, 3, v8
    v_lshl_add_u32 v8, v41, 5, v8
    v_lshlrev_b32 v9, 6, v43
    v_lshl_add_u32 v9, v42, 4, v9
    v_lshl_add_u32 v9, v41, 10, v9
    s_mul_i32 s17, s3, 36864
    s_waitcnt vmcnt(8)
    v_dot2_f32_bf16 v4, v10, s20, v4
    v_dot2_f32_bf16 v5, v10, v10, v5
    v_dot2_f32_bf16 v4, v11, s20, v4
    v_dot2_f32_bf16 v5, v11, v11, v5
    ds_write_b64 v6, v[10:11] offset:19200
    s_waitcnt vmcnt(7)
    v_dot2_f32_bf16 v4, v12, s20, v4
    v_dot2_f32_bf16 v5, v12, v12, v5
    v_dot2_f32_bf16 v4, v13, s20, v4
    v_dot2_f32_bf16 v5, v13, v13, v5
    ds_write_b64 v6, v[12:13] offset:19328
    s_waitcnt vmcnt(6)
    v_dot2_f32_bf16 v4, v14, s20, v4
    v_dot2_f32_bf16 v5, v14, v14, v5
    v_dot2_f32_bf16 v4, v15, s20, v4
    v_dot2_f32_bf16 v5, v15, v15, v5
    ds_write_b64 v6, v[14:15] offset:19456
    s_waitcnt vmcnt(5)
    v_dot2_f32_bf16 v4, v16, s20, v4
    v_dot2_f32_bf16 v5, v16, v16, v5
    v_dot2_f32_bf16 v4, v17, s20, v4
    v_dot2_f32_bf16 v5, v17, v17, v5
    ds_write_b64 v6, v[16:17] offset:19584
    s_waitcnt vmcnt(4)
    v_dot2_f32_bf16 v4, v18, s20, v4
    v_dot2_f32_bf16 v5, v18, v18, v5
    v_dot2_f32_bf16 v4, v19, s20, v4
    v_dot2_f32_bf16 v5, v19, v19, v5
    ds_write_b64 v6, v[18:19] offset:19712
    s_waitcnt vmcnt(3)
    v_dot2_f32_bf16 v4, v20, s20, v4
    v_dot2_f32_bf16 v5, v20, v20, v5
    v_dot2_f32_bf16 v4, v21, s20, v4
    v_dot2_f32_bf16 v5, v21, v21, v5
    ds_write_b64 v6, v[20:21] offset:19840
    s_waitcnt vmcnt(2)
    v_dot2_f32_bf16 v4, v22, s20, v4
    v_dot2_f32_bf16 v5, v22, v22, v5
    v_dot2_f32_bf16 v4, v23, s20, v4
    v_dot2_f32_bf16 v5, v23, v23, v5
    ds_write_b64 v6, v[22:23] offset:19968
    s_waitcnt vmcnt(1)
    v_dot2_f32_bf16 v4, v24, s20, v4
    v_dot2_f32_bf16 v5, v24, v24, v5
    v_dot2_f32_bf16 v4, v25, s20, v4
    v_dot2_f32_bf16 v5, v25, v25, v5
    ds_write_b64 v6, v[24:25] offset:20096
    s_waitcnt vmcnt(0)
    v_dot2_f32_bf16 v4, v26, s20, v4
    v_dot2_f32_bf16 v5, v26, v26, v5
    v_dot2_f32_bf16 v4, v27, s20, v4
    v_dot2_f32_bf16 v5, v27, v27, v5
    ds_write_b64 v6, v[26:27] offset:20224
    s_nop 0
    v_add_f32_dpp v4, v4, v4 row_ror:8 row_mask:0xf bank_mask:0xf
    v_add_f32_dpp v5, v5, v5 row_ror:8 row_mask:0xf bank_mask:0xf
    s_nop 0
    v_add_f32_dpp v4, v4, v4 row_ror:4 row_mask:0xf bank_mask:0xf
    v_add_f32_dpp v5, v5, v5 row_ror:4 row_mask:0xf bank_mask:0xf
    s_nop 0
    v_add_f32_dpp v4, v4, v4 row_ror:2 row_mask:0xf bank_mask:0xf
    v_add_f32_dpp v5, v5, v5 row_ror:2 row_mask:0xf bank_mask:0xf
    s_nop 0
    v_add_f32_dpp v4, v4, v4 row_ror:1 row_mask:0xf bank_mask:0xf
    v_add_f32_dpp v5, v5, v5 row_ror:1 row_mask:0xf bank_mask:0xf
    v_mul_f32 v4, 0x3ae38e39, v4
    v_mul_f32 v5, 0x3ae38e39, v5
    v_fma_f32 v5, -v4, v4, v5
    v_max_f32 v5, 0, v5
    v_cvt_pk_bf16_f32 v7, v4, v5
    v_lshlrev_b32 v30, 16, v7
    v_and_b32 v5, s21, v7
    v_add_f32 v5, 0x3727c5ac, v5
    v_cvt_pk_bf16_f32 v5, 0, v5
    v_sqrt_f32 v5, v5
    s_nop 0
    v_cvt_pk_bf16_f32 v5, 0, v5
    v_rcp_f32 v32, v5
    v_lshlrev_b32 v50, 16, v10
    v_and_b32 v51, s21, v10
    v_pk_add_f32 v[50:51], v[50:51], v[30:31] op_sel_hi:[1,0] neg_lo:[0,1] neg_hi:[0,1]
    v_cvt_pk_bf16_f32 v50, 0, v50
    v_cvt_pk_bf16_f32 v51, 0, v51
    v_pk_mul_f32 v[50:51], v[50:51], v[32:33] op_sel_hi:[1,0]
    v_cvt_pk_bf16_f32 v50, 0, v50
    v_cvt_pk_bf16_f32 v51, 0, v51
    v_cvt_pk_f16_f32 v60, v50, v51
    v_lshlrev_b32 v52, 16, v11
    v_and_b32 v53, s21, v11
    v_pk_add_f32 v[52:53], v[52:53], v[30:31] op_sel_hi:[1,0] neg_lo:[0,1] neg_hi:[0,1]
    v_cvt_pk_bf16_f32 v52, 0, v52
    v_cvt_pk_bf16_f32 v53, 0, v53
    v_pk_mul_f32 v[52:53], v[52:53], v[32:33] op_sel_hi:[1,0]
    v_cvt_pk_bf16_f32 v52, 0, v52
    v_cvt_pk_bf16_f32 v53, 0, v53
    v_cvt_pk_f16_f32 v61, v52, v53
    ds_write_b64 v6, v[60:61] offset:0
    v_lshlrev_b32 v54, 16, v12
    v_and_b32 v55, s21, v12
    v_pk_add_f32 v[54:55], v[54:55], v[30:31] op_sel_hi:[1,0] neg_lo:[0,1] neg_hi:[0,1]
    v_cvt_pk_bf16_f32 v54, 0, v54
    v_cvt_pk_bf16_f32 v55, 0, v55
    v_pk_mul_f32 v[54:55], v[54:55], v[32:33] op_sel_hi:[1,0]
    v_cvt_pk_bf16_f32 v54, 0, v54
    v_cvt_pk_bf16_f32 v55, 0, v55
    v_cvt_pk_f16_f32 v62, v54, v55
    v_lshlrev_b32 v56, 16, v13
    v_and_b32 v57, s21, v13
    v_pk_add_f32 v[56:57], v[56:57], v[30:31] op_sel_hi:[1,0] neg_lo:[0,1] neg_hi:[0,1]
    v_cvt_pk_bf16_f32 v56, 0, v56
    v_cvt_pk_bf16_f32 v57, 0, v57
    v_pk_mul_f32 v[56:57], v[56:57], v[32:33] op_sel_hi:[1,0]
    v_cvt_pk_bf16_f32 v56, 0, v56
    v_cvt_pk_bf16_f32 v57, 0, v57
    v_cvt_pk_f16_f32 v63, v56, v57
    ds_write_b64 v6, v[62:63] offset:128
    v_lshlrev_b32 v50, 16, v14
    v_and_b32 v51, s21, v14
    v_pk_add_f32 v[50:51], v[50:51], v[30:31] op_sel_hi:[1,0] neg_lo:[0,1] neg_hi:[0,1]
    v_cvt_pk_bf16_f32 v50, 0, v50
    v_cvt_pk_bf16_f32 v51, 0, v51
    v_pk_mul_f32 v[50:51], v[50:51], v[32:33] op_sel_hi:[1,0]
    v_cvt_pk_bf16_f32 v50, 0, v50
    v_cvt_pk_bf16_f32 v51, 0, v51
    v_cvt_pk_f16_f32 v64, v50, v51
    v_lshlrev_b32 v52, 16, v15
    v_and_b32 v53, s21, v15
    v_pk_add_f32 v[52:53], v[52:53], v[30:31] op_sel_hi:[1,0] neg_lo:[0,1] neg_hi:[0,1]
    v_cvt_pk_bf16_f32 v52, 0, v52
    v_cvt_pk_bf16_f32 v53, 0, v53
    v_pk_mul_f32 v[52:53], v[52:53], v[32:33] op_sel_hi:[1,0]
    v_cvt_pk_bf16_f32 v52, 0, v52
    v_cvt_pk_bf16_f32 v53, 0, v53
    v_cvt_pk_f16_f32 v65, v52, v53
    ds_write_b64 v6, v[64:65] offset:256
    v_lshlrev_b32 v54, 16, v16
    v_and_b32 v55, s21, v16
    v_pk_add_f32 v[54:55], v[54:55], v[30:31] op_sel_hi:[1,0] neg_lo:[0,1] neg_hi:[0,1]
    v_cvt_pk_bf16_f32 v54, 0, v54
    v_cvt_pk_bf16_f32 v55, 0, v55
    v_pk_mul_f32 v[54:55], v[54:55], v[32:33] op_sel_hi:[1,0]
    v_cvt_pk_bf16_f32 v54, 0, v54
    v_cvt_pk_bf16_f32 v55, 0, v55
    v_cvt_pk_f16_f32 v66, v54, v55
    v_lshlrev_b32 v56, 16, v17
    v_and_b32 v57, s21, v17
    v_pk_add_f32 v[56:57], v[56:57], v[30:31] op_sel_hi:[1,0] neg_lo:[0,1] neg_hi:[0,1]
    v_cvt_pk_bf16_f32 v56, 0, v56
    v_cvt_pk_bf16_f32 v57, 0, v57
    v_pk_mul_f32 v[56:57], v[56:57], v[32:33] op_sel_hi:[1,0]
    v_cvt_pk_bf16_f32 v56, 0, v56
    v_cvt_pk_bf16_f32 v57, 0, v57
    v_cvt_pk_f16_f32 v67, v56, v57
    ds_write_b64 v6, v[66:67] offset:384
    v_lshlrev_b32 v50, 16, v18
    v_and_b32 v51, s21, v18
    v_pk_add_f32 v[50:51], v[50:51], v[30:31] op_sel_hi:[1,0] neg_lo:[0,1] neg_hi:[0,1]
    v_cvt_pk_bf16_f32 v50, 0, v50
    v_cvt_pk_bf16_f32 v51, 0, v51
    v_pk_mul_f32 v[50:51], v[50:51], v[32:33] op_sel_hi:[1,0]
    v_cvt_pk_bf16_f32 v50, 0, v50
    v_cvt_pk_bf16_f32 v51, 0, v51
    v_cvt_pk_f16_f32 v68, v50, v51
    v_lshlrev_b32 v52, 16, v19
    v_and_b32 v53, s21, v19
    v_pk_add_f32 v[52:53], v[52:53], v[30:31] op_sel_hi:[1,0] neg_lo:[0,1] neg_hi:[0,1]
    v_cvt_pk_bf16_f32 v52, 0, v52
    v_cvt_pk_bf16_f32 v53, 0, v53
    v_pk_mul_f32 v[52:53], v[52:53], v[32:33] op_sel_hi:[1,0]
    v_cvt_pk_bf16_f32 v52, 0, v52
    v_cvt_pk_bf16_f32 v53, 0, v53
    v_cvt_pk_f16_f32 v69, v52, v53
    ds_write_b64 v6, v[68:69] offset:512
    v_lshlrev_b32 v54, 16, v20
    v_and_b32 v55, s21, v20
    v_pk_add_f32 v[54:55], v[54:55], v[30:31] op_sel_hi:[1,0] neg_lo:[0,1] neg_hi:[0,1]
    v_cvt_pk_bf16_f32 v54, 0, v54
    v_cvt_pk_bf16_f32 v55, 0, v55
    v_pk_mul_f32 v[54:55], v[54:55], v[32:33] op_sel_hi:[1,0]
    v_cvt_pk_bf16_f32 v54, 0, v54
    v_cvt_pk_bf16_f32 v55, 0, v55
    v_cvt_pk_f16_f32 v70, v54, v55
    v_lshlrev_b32 v56, 16, v21
    v_and_b32 v57, s21, v21
    v_pk_add_f32 v[56:57], v[56:57], v[30:31] op_sel_hi:[1,0] neg_lo:[0,1] neg_hi:[0,1]
    v_cvt_pk_bf16_f32 v56, 0, v56
    v_cvt_pk_bf16_f32 v57, 0, v57
    v_pk_mul_f32 v[56:57], v[56:57], v[32:33] op_sel_hi:[1,0]
    v_cvt_pk_bf16_f32 v56, 0, v56
    v_cvt_pk_bf16_f32 v57, 0, v57
    v_cvt_pk_f16_f32 v71, v56, v57
    ds_write_b64 v6, v[70:71] offset:640
    v_lshlrev_b32 v50, 16, v22
    v_and_b32 v51, s21, v22
    v_pk_add_f32 v[50:51], v[50:51], v[30:31] op_sel_hi:[1,0] neg_lo:[0,1] neg_hi:[0,1]
    v_cvt_pk_bf16_f32 v50, 0, v50
    v_cvt_pk_bf16_f32 v51, 0, v51
    v_pk_mul_f32 v[50:51], v[50:51], v[32:33] op_sel_hi:[1,0]
    v_cvt_pk_bf16_f32 v50, 0, v50
    v_cvt_pk_bf16_f32 v51, 0, v51
    v_cvt_pk_f16_f32 v72, v50, v51
    v_lshlrev_b32 v52, 16, v23
    v_and_b32 v53, s21, v23
    v_pk_add_f32 v[52:53], v[52:53], v[30:31] op_sel_hi:[1,0] neg_lo:[0,1] neg_hi:[0,1]
    v_cvt_pk_bf16_f32 v52, 0, v52
    v_cvt_pk_bf16_f32 v53, 0, v53
    v_pk_mul_f32 v[52:53], v[52:53], v[32:33] op_sel_hi:[1,0]
    v_cvt_pk_bf16_f32 v52, 0, v52
    v_cvt_pk_bf16_f32 v53, 0, v53
    v_cvt_pk_f16_f32 v73, v52, v53
    ds_write_b64 v6, v[72:73] offset:768
    v_lshlrev_b32 v54, 16, v24
    v_and_b32 v55, s21, v24
    v_pk_add_f32 v[54:55], v[54:55], v[30:31] op_sel_hi:[1,0] neg_lo:[0,1] neg_hi:[0,1]
    v_cvt_pk_bf16_f32 v54, 0, v54
    v_cvt_pk_bf16_f32 v55, 0, v55
    v_pk_mul_f32 v[54:55], v[54:55], v[32:33] op_sel_hi:[1,0]
    v_cvt_pk_bf16_f32 v54, 0, v54
    v_cvt_pk_bf16_f32 v55, 0, v55
    v_cvt_pk_f16_f32 v74, v54, v55
    v_lshlrev_b32 v56, 16, v25
    v_and_b32 v57, s21, v25
    v_pk_add_f32 v[56:57], v[56:57], v[30:31] op_sel_hi:[1,0] neg_lo:[0,1] neg_hi:[0,1]
    v_cvt_pk_bf16_f32 v56, 0, v56
    v_cvt_pk_bf16_f32 v57, 0, v57
    v_pk_mul_f32 v[56:57], v[56:57], v[32:33] op_sel_hi:[1,0]
    v_cvt_pk_bf16_f32 v56, 0, v56
    v_cvt_pk_bf16_f32 v57, 0, v57
    v_cvt_pk_f16_f32 v75, v56, v57
    ds_write_b64 v6, v[74:75] offset:896
    v_lshlrev_b32 v50, 16, v26
    v_and_b32 v51, s21, v26
    v_pk_add_f32 v[50:51], v[50:51], v[30:31] op_sel_hi:[1,0] neg_lo:[0,1] neg_hi:[0,1]
    v_cvt_pk_bf16_f32 v50, 0, v50
    v_cvt_pk_bf16_f32 v51, 0, v51
    v_pk_mul_f32 v[50:51], v[50:51], v[32:33] op_sel_hi:[1,0]
    v_cvt_pk_bf16_f32 v50, 0, v50
    v_cvt_pk_bf16_f32 v51, 0, v51
    v_cvt_pk_f16_f32 v76, v50, v51
    v_lshlrev_b32 v52, 16, v27
    v_and_b32 v53, s21, v27
    v_pk_add_f32 v[52:53], v[52:53], v[30:31] op_sel_hi:[1,0] neg_lo:[0,1] neg_hi:[0,1]
    v_cvt_pk_bf16_f32 v52, 0, v52
    v_cvt_pk_bf16_f32 v53, 0, v53
    v_pk_mul_f32 v[52:53], v[52:53], v[32:33] op_sel_hi:[1,0]
    v_cvt_pk_bf16_f32 v52, 0, v52
    v_cvt_pk_bf16_f32 v53, 0, v53
    v_cvt_pk_f16_f32 v77, v52, v53
    ds_write_b64 v6, v[76:77] offset:1024
    s_waitcnt lgkmcnt(0)
    s_barrier
    buffer_load_dword v80, v81, s[24:27], 0 offen sc1
    ds_read_b64_tr_b16 v[12:13], v8 offset:0
    ds_read_b64_tr_b16 v[14:15], v8 offset:4736
    ds_read_b64_tr_b16 v[16:17], v8 offset:128
    ds_read_b64_tr_b16 v[18:19], v8 offset:4864
    ds_read_b64_tr_b16 v[20:21], v8 offset:256
    ds_read_b64_tr_b16 v[22:23], v8 offset:4992
    ds_read_b64_tr_b16 v[24:25], v8 offset:384
    ds_read_b64_tr_b16 v[26:27], v8 offset:5120
    ds_read_b64_tr_b16 v[28:29], v8 offset:512
    ds_read_b64_tr_b16 v[30:31], v8 offset:5248
    ds_read_b64_tr_b16 v[32:33], v8 offset:640
    ds_read_b64_tr_b16 v[34:35], v8 offset:5376
    ds_read_b64_tr_b16 v[36:37], v8 offset:768
    ds_read_b64_tr_b16 v[38:39], v8 offset:5504
    ds_read_b64_tr_b16 v[40:41], v8 offset:896
    ds_read_b64_tr_b16 v[42:43], v8 offset:5632
    ds_read_b64_tr_b16 v[44:45], v8 offset:1024
    ds_read_b64_tr_b16 v[46:47], v8 offset:5760
    s_waitcnt lgkmcnt(15)
    buffer_store_dwordx4 v[12:15], v9, s[12:15], s17 offen sc1
    s_add_u32 s17, s17, 4096
    s_waitcnt lgkmcnt(14)
    buffer_store_dwordx4 v[16:19], v9, s[12:15], s17 offen sc1
    s_add_u32 s17, s17, 4096
    s_waitcnt lgkmcnt(12)
    buffer_store_dwordx4 v[20:23], v9, s[12:15], s17 offen sc1
    s_add_u32 s17, s17, 4096
    s_waitcnt lgkmcnt(10)
    buffer_store_dwordx4 v[24:27], v9, s[12:15], s17 offen sc1
    s_add_u32 s17, s17, 4096
    s_waitcnt lgkmcnt(8)
    buffer_store_dwordx4 v[28:31], v9, s[12:15], s17 offen sc1
    s_add_u32 s17, s17, 4096
    s_waitcnt lgkmcnt(6)
    buffer_store_dwordx4 v[32:35], v9, s[12:15], s17 offen sc1
    s_add_u32 s17, s17, 4096
    s_waitcnt lgkmcnt(4)
    buffer_store_dwordx4 v[36:39], v9, s[12:15], s17 offen sc1
    s_add_u32 s17, s17, 4096
    s_waitcnt lgkmcnt(2)
    buffer_store_dwordx4 v[40:43], v9, s[12:15], s17 offen sc1
    s_add_u32 s17, s17, 4096
    s_waitcnt lgkmcnt(0)
    buffer_store_dwordx4 v[44:47], v9, s[12:15], s17 offen sc1
    s_add_u32 s17, s17, 4096
    v_lshlrev_b32 v1, 16, v0
    v_mov_b32 v2, 1
    s_lshl_b32 s18, s3, 7
    s_mov_b32 s19, 300000
LN_RDY:
    s_waitcnt vmcnt(0)
    v_cmp_ne_u32 vcc, 1, v80
    s_nop 3
    s_cbranch_vccz LN_RDY_OK
    s_sleep 2
    buffer_load_dword v80, v81, s[24:27], 0 offen sc1
    s_sub_u32 s19, s19, 1
    s_cmp_lg_u32 s19, 0
    s_cbranch_scc1 LN_RDY
LN_RDY_OK:
    s_barrier
    buffer_store_dword v2, v1, s[28:31], s18 offen sc1
    s_setprio 0
    s_cmp_lt_u32 s3, 8
    s_cbranch_scc1 ROLE_5
    s_sub_u32 s3, s3, 8
    s_cmp_lt_u32 s3, 72
    s_cbranch_scc1 ROLE_6
    s_cmp_lt_u32 s3, 72
    s_cbranch_scc1 LN_FIN
    s_add_u32 s3, s3, 56
    s_cmp_lt_u32 s3, 144
    s_cbranch_scc1 ROLE_4
LN_FIN:
    s_endpgm
ROLE_4:
    s_load_dwordx4 s[4:7], s[0:1], 64
    s_load_dwordx2 s[14:15], s[0:1], 104
    s_mul_i32 s16, s3, 171
    s_lshr_b32 s16, s16, 12
    s_mul_i32 s17, s16, 24
    s_sub_u32 s17, s3, s17
    v_lshrrev_b32 v1, 3, v0
    v_and_b32 v2, 7, v0
    v_mul_u32_u24 v3, 9216, v1
    v_lshl_add_u32 v3, v2, 4, v3
    s_mul_i32 s18, s16, 884736
    s_mul_i32 s19, s17, 384
    s_add_u32 s18, s18, s19
    s_waitcnt lgkmcnt(0)
    s_mov_b32 s20, s4
    s_and_b32 s21, s5, 0xffff
    s_mov_b32 s22, 5308416
    s_mov_b32 s23, 0x00020000
    s_mov_b32 s24, s6
    s_and_b32 s25, s7, 0xffff
    s_mov_b32 s26, 5308416
    s_mov_b32 s27, 0x00020000
    buffer_load_dwordx4 v[16:19], v3, s[20:23], s18 offen offset:0 nt
    buffer_load_dwordx4 v[20:23], v3, s[24:27], s18 offen offset:0 nt
    buffer_load_dwordx4 v[24:27], v3, s[20:23], s18 offen offset:128 nt
    buffer_load_dwordx4 v[28:31], v3, s[24:27], s18 offen offset:128 nt
    buffer_load_dwordx4 v[32:35], v3, s[20:23], s18 offen offset:256 nt
    buffer_load_dwordx4 v[36:39], v3, s[24:27], s18 offen offset:256 nt
    s_add_u32 s18, s18, 294912
    buffer_load_dwordx4 v[40:43], v3, s[20:23], s18 offen offset:0 nt
    buffer_load_dwordx4 v[44:47], v3, s[24:27], s18 offen offset:0 nt
    buffer_load_dwordx4 v[48:51], v3, s[20:23], s18 offen offset:128 nt
    buffer_load_dwordx4 v[52:55], v3, s[24:27], s18 offen offset:128 nt
    buffer_load_dwordx4 v[56:59], v3, s[20:23], s18 offen offset:256 nt
    buffer_load_dwordx4 v[60:63], v3, s[24:27], s18 offen offset:256 nt
    s_add_u32 s18, s18, 294912
    buffer_load_dwordx4 v[64:67], v3, s[20:23], s18 offen offset:0 nt
    buffer_load_dwordx4 v[68:71], v3, s[24:27], s18 offen offset:0 nt
    buffer_load_dwordx4 v[72:75], v3, s[20:23], s18 offen offset:128 nt
    buffer_load_dwordx4 v[76:79], v3, s[24:27], s18 offen offset:128 nt
    buffer_load_dwordx4 v[80:83], v3, s[20:23], s18 offen offset:256 nt
    buffer_load_dwordx4 v[84:87], v3, s[24:27], s18 offen offset:256 nt
    s_add_u32 s18, s18, 294912
    s_add_u32 s28, s14, 16777216
    s_addc_u32 s29, s15, 0
    s_and_b32 s29, s29, 0xffff
    s_mov_b32 s30, 10616832
    s_mov_b32 s31, 0x00020000
    s_add_u32 s32, s14, 8912896
    s_addc_u32 s33, s15, 0
    s_and_b32 s33, s33, 0xffff
    s_mov_b32 s34, 221184
    s_mov_b32 s35, 0x00020000
    v_and_b32 v7, 7, v1
    v_xor_b32 v7, v7, v2
    v_lshlrev_b32 v4, 8, v1
    v_lshl_add_u32 v4, v7, 5, v4
    v_add_u32 v14, 0x10000, v4
    v_and_b32 v7, 63, v0
    v_lshrrev_b32 v8, 6, v0
    v_lshrrev_b32 v9, 2, v7
    v_lshlrev_b32 v5, 8, v9
    v_and_b32 v9, 7, v9
    v_lshlrev_b32 v12, 1, v8
    v_xor_b32 v9, v9, v12
    v_lshl_add_u32 v5, v9, 5, v5
    v_and_b32 v9, 3, v7
    v_lshl_add_u32 v5, v9, 3, v5
    v_xor_b32 v9, 32, v5
    v_add_u32 v12, 0x10000, v5
    v_add_u32 v13, 0x10000, v9
    v_lshlrev_b32 v6, 4, v7
    v_readfirstlane_b32 s36, v8
    s_mov_b32 s44, 0x3f803f80
    s_mul_i32 s37, s17, 24
    s_lshl_b32 s38, s36, 1
    s_add_u32 s37, s37, s38
    s_add_u32 s37, s37, 0
    s_mul_hi_u32 s38, s37, 1431655766
    s_mul_i32 s39, s38, 3
    s_sub_u32 s39, s37, s39
    s_mul_i32 s38, s38, 18
    s_mul_i32 s45, s16, 3
    s_add_u32 s38, s38, s45
    s_mul_i32 s38, s38, 3072
    s_lshl_b32 s39, s39, 10
    s_add_u32 s46, s38, s39
    s_lshl_b32 s37, s37, 6
    s_mul_i32 s45, s16, 36864
    s_add_u32 s42, s37, s45
    s_mul_i32 s37, s17, 24
    s_lshl_b32 s38, s36, 1
    s_add_u32 s37, s37, s38
    s_add_u32 s37, s37, 1
    s_mul_hi_u32 s38, s37, 1431655766
    s_mul_i32 s39, s38, 3
    s_sub_u32 s39, s37, s39
    s_mul_i32 s38, s38, 18
    s_mul_i32 s45, s16, 3
    s_add_u32 s38, s38, s45
    s_mul_i32 s38, s38, 3072
    s_lshl_b32 s39, s39, 10
    s_add_u32 s47, s38, s39
    s_mul_i32 s37, s17, 24
    s_lshl_b32 s38, s36, 1
    s_add_u32 s37, s37, s38
    s_add_u32 s37, s37, 8
    s_mul_hi_u32 s38, s37, 1431655766
    s_mul_i32 s39, s38, 3
    s_sub_u32 s39, s37, s39
    s_mul_i32 s38, s38, 18
    s_mul_i32 s45, s16, 3
    s_add_u32 s38, s38, s45
    s_mul_i32 s38, s38, 3072
    s_lshl_b32 s39, s39, 10
    s_add_u32 s48, s38, s39
    s_mul_i32 s37, s17, 24
    s_lshl_b32 s38, s36, 1
    s_add_u32 s37, s37, s38
    s_add_u32 s37, s37, 9
    s_mul_hi_u32 s38, s37, 1431655766
    s_mul_i32 s39, s38, 3
    s_sub_u32 s39, s37, s39
    s_mul_i32 s38, s38, 18
    s_mul_i32 s45, s16, 3
    s_add_u32 s38, s38, s45
    s_mul_i32 s38, s38, 3072
    s_lshl_b32 s39, s39, 10
    s_add_u32 s49, s38, s39
    s_mul_i32 s37, s17, 24
    s_lshl_b32 s38, s36, 1
    s_add_u32 s37, s37, s38
    s_add_u32 s37, s37, 16
    s_mul_hi_u32 s38, s37, 1431655766
    s_mul_i32 s39, s38, 3
    s_sub_u32 s39, s37, s39
    s_mul_i32 s38, s38, 18
    s_mul_i32 s45, s16, 3
    s_add_u32 s38, s38, s45
    s_mul_i32 s38, s38, 3072
    s_lshl_b32 s39, s39, 10
    s_add_u32 s50, s38, s39
    s_mul_i32 s37, s17, 24
    s_lshl_b32 s38, s36, 1
    s_add_u32 s37, s37, s38
    s_add_u32 s37, s37, 17
    s_mul_hi_u32 s38, s37, 1431655766
    s_mul_i32 s39, s38, 3
    s_sub_u32 s39, s37, s39
    s_mul_i32 s38, s38, 18
    s_mul_i32 s45, s16, 3
    s_add_u32 s38, s38, s45
    s_mul_i32 s38, s38, 3072
    s_lshl_b32 s39, s39, 10
    s_add_u32 s51, s38, s39
    v_mov_b32 v120, s44
    v_mov_b32 v121, s44
    v_mov_b32 v122, s44
    v_mov_b32 v123, s44
    s_waitcnt vmcnt(16)
    v_swap_b32 v17, v20
    v_swap_b32 v18, v20
    v_swap_b32 v19, v21
    v_swap_b32 v21, v22
    ds_write_b128 v4, v[16:19] offset:0
    ds_write_b128 v4, v[20:23] offset:16
    s_waitcnt vmcnt(14)
    v_swap_b32 v25, v28
    v_swap_b32 v26, v28
    v_swap_b32 v27, v29
    v_swap_b32 v29, v30
    ds_write_b128 v4, v[24:27] offset:8192
    ds_write_b128 v4, v[28:31] offset:8208
    s_waitcnt vmcnt(12)
    v_swap_b32 v33, v36
    v_swap_b32 v34, v36
    v_swap_b32 v35, v37
    v_swap_b32 v37, v38
    ds_write_b128 v4, v[32:35] offset:16384
    ds_write_b128 v4, v[36:39] offset:16400
    s_waitcnt lgkmcnt(0)
    s_barrier
    ds_read_b64_tr_b16 v[128:129], v5 offset:0
    ds_read_b64_tr_b16 v[130:131], v5 offset:4096
    ds_read_b64_tr_b16 v[132:133], v9 offset:0
    ds_read_b64_tr_b16 v[134:135], v9 offset:4096
    ds_read_b64_tr_b16 v[136:137], v5 offset:8192
    ds_read_b64_tr_b16 v[138:139], v5 offset:12288
    ds_read_b64_tr_b16 v[140:141], v9 offset:8192
    ds_read_b64_tr_b16 v[142:143], v9 offset:12288
    ds_read_b64_tr_b16 v[144:145], v5 offset:16384
    ds_read_b64_tr_b16 v[146:147], v5 offset:20480
    ds_read_b64_tr_b16 v[148:149], v9 offset:16384
    ds_read_b64_tr_b16 v[150:151], v9 offset:20480
    s_waitcnt lgkmcnt(10)
    buffer_store_dwordx4 v[128:131], v6, s[28:31], s46 offen sc1
    s_add_u32 s46, s46, 3072
    v_mfma_f32_16x16x32_bf16 v[92:95], v[128:131], v[120:123], 0
    s_waitcnt lgkmcnt(8)
    buffer_store_dwordx4 v[132:135], v6, s[28:31], s47 offen sc1
    s_add_u32 s47, s47, 3072
    v_mfma_f32_16x16x32_bf16 v[96:99], v[132:135], v[120:123], 0
    s_waitcnt lgkmcnt(6)
    buffer_store_dwordx4 v[136:139], v6, s[28:31], s48 offen sc1
    s_add_u32 s48, s48, 3072
    v_mfma_f32_16x16x32_bf16 v[100:103], v[136:139], v[120:123], 0
    s_waitcnt lgkmcnt(4)
    buffer_store_dwordx4 v[140:143], v6, s[28:31], s49 offen sc1
    s_add_u32 s49, s49, 3072
    v_mfma_f32_16x16x32_bf16 v[104:107], v[140:143], v[120:123], 0
    s_waitcnt lgkmcnt(2)
    buffer_store_dwordx4 v[144:147], v6, s[28:31], s50 offen sc1
    s_add_u32 s50, s50, 3072
    v_mfma_f32_16x16x32_bf16 v[108:111], v[144:147], v[120:123], 0
    s_waitcnt lgkmcnt(0)
    buffer_store_dwordx4 v[148:151], v6, s[28:31], s51 offen sc1
    s_add_u32 s51, s51, 3072
    v_mfma_f32_16x16x32_bf16 v[112:115], v[148:151], v[120:123], 0
    s_waitcnt vmcnt(16)
    v_swap_b32 v41, v44
    v_swap_b32 v42, v44
    v_swap_b32 v43, v45
    v_swap_b32 v45, v46
    ds_write_b128 v4, v[40:43] offset:24576
    ds_write_b128 v4, v[44:47] offset:24592
    s_waitcnt vmcnt(14)
    v_swap_b32 v49, v52
    v_swap_b32 v50, v52
    v_swap_b32 v51, v53
    v_swap_b32 v53, v54
    ds_write_b128 v4, v[48:51] offset:32768
    ds_write_b128 v4, v[52:55] offset:32784
    s_waitcnt vmcnt(12)
    v_swap_b32 v57, v60
    v_swap_b32 v58, v60
    v_swap_b32 v59, v61
    v_swap_b32 v61, v62
    ds_write_b128 v4, v[56:59] offset:40960
    ds_write_b128 v4, v[60:63] offset:40976
    s_waitcnt lgkmcnt(0)
    s_barrier
    ds_read_b64_tr_b16 v[152:153], v5 offset:24576
    ds_read_b64_tr_b16 v[154:155], v5 offset:28672
    ds_read_b64_tr_b16 v[156:157], v9 offset:24576
    ds_read_b64_tr_b16 v[158:159], v9 offset:28672
    ds_read_b64_tr_b16 v[160:161], v5 offset:32768
    ds_read_b64_tr_b16 v[162:163], v5 offset:36864
    ds_read_b64_tr_b16 v[164:165], v9 offset:32768
    ds_read_b64_tr_b16 v[166:167], v9 offset:36864
    ds_read_b64_tr_b16 v[168:169], v5 offset:40960
    ds_read_b64_tr_b16 v[170:171], v5 offset:45056
    ds_read_b64_tr_b16 v[172:173], v9 offset:40960
    ds_read_b64_tr_b16 v[174:175], v9 offset:45056
    s_waitcnt lgkmcnt(10)
    buffer_store_dwordx4 v[152:155], v6, s[28:31], s46 offen sc1
    s_add_u32 s46, s46, 3072
    v_mfma_f32_16x16x32_bf16 v[92:95], v[152:155], v[120:123], v[92:95]
    s_waitcnt lgkmcnt(8)
    buffer_store_dwordx4 v[156:159], v6, s[28:31], s47 offen sc1
    s_add_u32 s47, s47, 3072
    v_mfma_f32_16x16x32_bf16 v[96:99], v[156:159], v[120:123], v[96:99]
    s_waitcnt lgkmcnt(6)
    buffer_store_dwordx4 v[160:163], v6, s[28:31], s48 offen sc1
    s_add_u32 s48, s48, 3072
    v_mfma_f32_16x16x32_bf16 v[100:103], v[160:163], v[120:123], v[100:103]
    s_waitcnt lgkmcnt(4)
    buffer_store_dwordx4 v[164:167], v6, s[28:31], s49 offen sc1
    s_add_u32 s49, s49, 3072
    v_mfma_f32_16x16x32_bf16 v[104:107], v[164:167], v[120:123], v[104:107]
    s_waitcnt lgkmcnt(2)
    buffer_store_dwordx4 v[168:171], v6, s[28:31], s50 offen sc1
    s_add_u32 s50, s50, 3072
    v_mfma_f32_16x16x32_bf16 v[108:111], v[168:171], v[120:123], v[108:111]
    s_waitcnt lgkmcnt(0)
    buffer_store_dwordx4 v[172:175], v6, s[28:31], s51 offen sc1
    s_add_u32 s51, s51, 3072
    v_mfma_f32_16x16x32_bf16 v[112:115], v[172:175], v[120:123], v[112:115]
    s_waitcnt vmcnt(16)
    v_swap_b32 v65, v68
    v_swap_b32 v66, v68
    v_swap_b32 v67, v69
    v_swap_b32 v69, v70
    ds_write_b128 v4, v[64:67] offset:49152
    ds_write_b128 v4, v[68:71] offset:49168
    s_waitcnt vmcnt(14)
    v_swap_b32 v73, v76
    v_swap_b32 v74, v76
    v_swap_b32 v75, v77
    v_swap_b32 v77, v78
    ds_write_b128 v4, v[72:75] offset:57344
    ds_write_b128 v4, v[76:79] offset:57360
    s_waitcnt vmcnt(12)
    v_swap_b32 v81, v84
    v_swap_b32 v82, v84
    v_swap_b32 v83, v85
    v_swap_b32 v85, v86
    ds_write_b128 v14, v[80:83] offset:0
    ds_write_b128 v14, v[84:87] offset:16
    s_waitcnt lgkmcnt(0)
    s_barrier
    ds_read_b64_tr_b16 v[176:177], v5 offset:49152
    ds_read_b64_tr_b16 v[178:179], v5 offset:53248
    ds_read_b64_tr_b16 v[180:181], v9 offset:49152
    ds_read_b64_tr_b16 v[182:183], v9 offset:53248
    ds_read_b64_tr_b16 v[184:185], v5 offset:57344
    ds_read_b64_tr_b16 v[186:187], v5 offset:61440
    ds_read_b64_tr_b16 v[188:189], v9 offset:57344
    ds_read_b64_tr_b16 v[190:191], v9 offset:61440
    ds_read_b64_tr_b16 v[192:193], v12 offset:0
    ds_read_b64_tr_b16 v[194:195], v12 offset:4096
    ds_read_b64_tr_b16 v[196:197], v13 offset:0
    ds_read_b64_tr_b16 v[198:199], v13 offset:4096
    s_waitcnt lgkmcnt(10)
    buffer_store_dwordx4 v[176:179], v6, s[28:31], s46 offen sc1
    s_add_u32 s46, s46, 3072
    v_mfma_f32_16x16x32_bf16 v[92:95], v[176:179], v[120:123], v[92:95]
    s_waitcnt lgkmcnt(8)
    buffer_store_dwordx4 v[180:183], v6, s[28:31], s47 offen sc1
    s_add_u32 s47, s47, 3072
    v_mfma_f32_16x16x32_bf16 v[96:99], v[180:183], v[120:123], v[96:99]
    s_waitcnt lgkmcnt(6)
    buffer_store_dwordx4 v[184:187], v6, s[28:31], s48 offen sc1
    s_add_u32 s48, s48, 3072
    v_mfma_f32_16x16x32_bf16 v[100:103], v[184:187], v[120:123], v[100:103]
    s_waitcnt lgkmcnt(4)
    buffer_store_dwordx4 v[188:191], v6, s[28:31], s49 offen sc1
    s_add_u32 s49, s49, 3072
    v_mfma_f32_16x16x32_bf16 v[104:107], v[188:191], v[120:123], v[104:107]
    s_waitcnt lgkmcnt(2)
    buffer_store_dwordx4 v[192:195], v6, s[28:31], s50 offen sc1
    s_add_u32 s50, s50, 3072
    v_mfma_f32_16x16x32_bf16 v[108:111], v[192:195], v[120:123], v[108:111]
    s_waitcnt lgkmcnt(0)
    buffer_store_dwordx4 v[196:199], v6, s[28:31], s51 offen sc1
    s_add_u32 s51, s51, 3072
    v_mfma_f32_16x16x32_bf16 v[112:115], v[196:199], v[120:123], v[112:115]
    v_and_b32 v12, 15, v7
    v_and_b32 v13, 48, v7
    v_lshl_add_u32 v13, v12, 20, v13
    buffer_store_dwordx4 v[92:95], v13, s[32:35], s42 offen offset:0 sc1
    buffer_store_dwordx4 v[96:99], v13, s[32:35], s42 offen offset:64 sc1
    buffer_store_dwordx4 v[100:103], v13, s[32:35], s42 offen offset:512 sc1
    buffer_store_dwordx4 v[104:107], v13, s[32:35], s42 offen offset:576 sc1
    buffer_store_dwordx4 v[108:111], v13, s[32:35], s42 offen offset:1024 sc1
    buffer_store_dwordx4 v[112:115], v13, s[32:35], s42 offen offset:1088 sc1
    s_endpgm
ROLE_6:
    s_load_dwordx2 s[4:5], s[0:1], 80
    s_load_dwordx2 s[6:7], s[0:1], 104
    v_lshrrev_b32 v1, 6, v0
    v_and_b32 v2, 63, v0
    v_readfirstlane_b32 s16, v1
    v_lshlrev_b32 v3, 4, v2
    s_mul_i32 s17, s16, 18432
    s_mul_i32 s18, s3, 73728
    s_add_u32 s18, s18, s17
    s_waitcnt lgkmcnt(0)
    s_mov_b32 s8, s4
    s_and_b32 s9, s5, 0xffff
    s_mov_b32 s10, 5308416
    s_mov_b32 s11, 0x00020000
    s_mov_b32 m0, s17
    s_nop 0
    buffer_load_dwordx4 v3, s[8:11], s18 offen offset:0 nt lds
    buffer_load_dwordx4 v3, s[8:11], s18 offen offset:1024 nt lds
    buffer_load_dwordx4 v3, s[8:11], s18 offen offset:2048 nt lds
    buffer_load_dwordx4 v3, s[8:11], s18 offen offset:3072 nt lds
    s_add_u32 s17, s17, 4096
    s_add_u32 s18, s18, 4096
    s_mov_b32 m0, s17
    s_nop 0
    buffer_load_dwordx4 v3, s[8:11], s18 offen offset:0 nt lds
    buffer_load_dwordx4 v3, s[8:11], s18 offen offset:1024 nt lds
    buffer_load_dwordx4 v3, s[8:11], s18 offen offset:2048 nt lds
    buffer_load_dwordx4 v3, s[8:11], s18 offen offset:3072 nt lds
    s_add_u32 s17, s17, 4096
    s_add_u32 s18, s18, 4096
    s_mov_b32 m0, s17
    s_nop 0
    buffer_load_dwordx4 v3, s[8:11], s18 offen offset:0 nt lds
    buffer_load_dwordx4 v3, s[8:11], s18 offen offset:1024 nt lds
    buffer_load_dwordx4 v3, s[8:11], s18 offen offset:2048 nt lds
    buffer_load_dwordx4 v3, s[8:11], s18 offen offset:3072 nt lds
    s_add_u32 s17, s17, 4096
    s_add_u32 s18, s18, 4096
    s_mov_b32 m0, s17
    s_nop 0
    buffer_load_dwordx4 v3, s[8:11], s18 offen offset:0 nt lds
    buffer_load_dwordx4 v3, s[8:11], s18 offen offset:1024 nt lds
    buffer_load_dwordx4 v3, s[8:11], s18 offen offset:2048 nt lds
    buffer_load_dwordx4 v3, s[8:11], s18 offen offset:3072 nt lds
    s_add_u32 s17, s17, 4096
    s_add_u32 s18, s18, 4096
    s_mov_b32 m0, s17
    s_nop 0
    buffer_load_dwordx4 v3, s[8:11], s18 offen offset:0 nt lds
    buffer_load_dwordx4 v3, s[8:11], s18 offen offset:1024 nt lds
    s_add_u32 s12, s6, 33554432
    s_addc_u32 s13, s7, 0
    s_and_b32 s13, s13, 0xffff
    s_mov_b32 s14, 5308416
    s_mov_b32 s15, 0x00020000
    v_lshrrev_b32 v4, 4, v2
    v_bfe_u32 v5, v2, 2, 2
    v_lshl_add_u32 v4, v4, 3, v5
    v_mul_u32_u24 v4, 1152, v4
    s_mul_i32 s19, s16, 288
    v_add_u32 v4, s19, v4
    v_and_b32 v5, 3, v2
    v_lshl_add_u32 v6, v5, 4, v4
    v_lshrrev_b32 v7, 1, v5
    v_mul_u32_u24 v7, 36864, v7
    v_add_u32 v7, v7, v4
    v_and_b32 v5, 1, v5
    v_lshl_add_u32 v7, v5, 3, v7
    s_mul_i32 s21, s3, 43
    s_lshr_b32 s21, s21, 8
    s_mul_i32 s22, s21, 6
    s_sub_u32 s22, s3, s22
    s_and_b32 s23, s21, 3
    s_mul_i32 s23, s23, 18
    s_add_u32 s22, s22, s23
    s_lshr_b32 s21, s21, 2
    s_mul_i32 s21, s21, 6
    s_add_u32 s22, s22, s21
    s_lshl_b32 s20, s16, 1
    s_mul_i32 s20, s20, 72
    s_add_u32 s20, s20, s22
    s_mul_i32 s20, s20, 9216
    s_waitcnt vmcnt(0)
    s_barrier
    ds_read_b64_tr_b16 v[16:17], v6 offset:0
    ds_read_b64_tr_b16 v[18:19], v6 offset:4608
    ds_read_b64_tr_b16 v[20:21], v6 offset:8
    ds_read_b64_tr_b16 v[22:23], v6 offset:4616
    ds_read_b64_tr_b16 v[24:25], v6 offset:64
    ds_read_b64_tr_b16 v[26:27], v6 offset:4672
    ds_read_b64_tr_b16 v[28:29], v6 offset:72
    ds_read_b64_tr_b16 v[30:31], v6 offset:4680
    ds_read_b64_tr_b16 v[32:33], v6 offset:36864
    ds_read_b64_tr_b16 v[34:35], v6 offset:41472
    ds_read_b64_tr_b16 v[36:37], v6 offset:36872
    ds_read_b64_tr_b16 v[38:39], v6 offset:41480
    ds_read_b64_tr_b16 v[40:41], v6 offset:36928
    ds_read_b64_tr_b16 v[42:43], v6 offset:41536
    s_waitcnt lgkmcnt(12)
    buffer_store_dwordx4 v[16:19], v3, s[12:15], s20 offen sc1
    s_add_u32 s20, s20, 1024
    ds_read_b64_tr_b16 v[44:45], v6 offset:36936
    ds_read_b64_tr_b16 v[46:47], v6 offset:41544
    s_waitcnt lgkmcnt(12)
    buffer_store_dwordx4 v[20:23], v3, s[12:15], s20 offen sc1
    s_add_u32 s20, s20, 1024
    ds_read_b64_tr_b16 v[48:49], v7 offset:128
    ds_read_b64_tr_b16 v[50:51], v7 offset:4736
    s_waitcnt lgkmcnt(12)
    buffer_store_dwordx4 v[24:27], v3, s[12:15], s20 offen sc1
    s_add_u32 s20, s20, 1024
    ds_read_b64_tr_b16 v[52:53], v6 offset:144
    ds_read_b64_tr_b16 v[54:55], v6 offset:4752
    s_waitcnt lgkmcnt(12)
    buffer_store_dwordx4 v[28:31], v3, s[12:15], s20 offen sc1
    s_add_u32 s20, s20, 1024
    ds_read_b64_tr_b16 v[56:57], v6 offset:152
    ds_read_b64_tr_b16 v[58:59], v6 offset:4760
    s_waitcnt lgkmcnt(12)
    buffer_store_dwordx4 v[32:35], v3, s[12:15], s20 offen sc1
    s_add_u32 s20, s20, 1024
    ds_read_b64_tr_b16 v[60:61], v6 offset:208
    ds_read_b64_tr_b16 v[62:63], v6 offset:4816
    s_waitcnt lgkmcnt(12)
    buffer_store_dwordx4 v[36:39], v3, s[12:15], s20 offen sc1
    s_add_u32 s20, s20, 1024
    ds_read_b64_tr_b16 v[64:65], v6 offset:216
    ds_read_b64_tr_b16 v[66:67], v6 offset:4824
    s_waitcnt lgkmcnt(12)
    buffer_store_dwordx4 v[40:43], v3, s[12:15], s20 offen sc1
    s_add_u32 s20, s20, 1024
    ds_read_b64_tr_b16 v[68:69], v6 offset:37008
    ds_read_b64_tr_b16 v[70:71], v6 offset:41616
    s_waitcnt lgkmcnt(12)
    buffer_store_dwordx4 v[44:47], v3, s[12:15], s20 offen sc1
    s_add_u32 s20, s20, 1024
    ds_read_b64_tr_b16 v[72:73], v6 offset:37016
    ds_read_b64_tr_b16 v[74:75], v6 offset:41624
    s_waitcnt lgkmcnt(12)
    buffer_store_dwordx4 v[48:51], v3, s[12:15], s20 offen sc1
    s_add_u32 s20, s20, 655360
    ds_read_b64_tr_b16 v[76:77], v6 offset:37072
    ds_read_b64_tr_b16 v[78:79], v6 offset:41680
    s_waitcnt lgkmcnt(12)
    buffer_store_dwordx4 v[52:55], v3, s[12:15], s20 offen sc1
    s_add_u32 s20, s20, 1024
    ds_read_b64_tr_b16 v[80:81], v6 offset:37080
    ds_read_b64_tr_b16 v[82:83], v6 offset:41688
    s_waitcnt lgkmcnt(12)
    buffer_store_dwordx4 v[56:59], v3, s[12:15], s20 offen sc1
    s_add_u32 s20, s20, 1024
    ds_read_b64_tr_b16 v[84:85], v7 offset:272
    ds_read_b64_tr_b16 v[86:87], v7 offset:4880
    s_waitcnt lgkmcnt(12)
    buffer_store_dwordx4 v[60:63], v3, s[12:15], s20 offen sc1
    s_add_u32 s20, s20, 1024
    s_waitcnt lgkmcnt(10)
    buffer_store_dwordx4 v[64:67], v3, s[12:15], s20 offen sc1
    s_add_u32 s20, s20, 1024
    s_waitcnt lgkmcnt(8)
    buffer_store_dwordx4 v[68:71], v3, s[12:15], s20 offen sc1
    s_add_u32 s20, s20, 1024
    s_waitcnt lgkmcnt(6)
    buffer_store_dwordx4 v[72:75], v3, s[12:15], s20 offen sc1
    s_add_u32 s20, s20, 1024
    s_waitcnt lgkmcnt(4)
    buffer_store_dwordx4 v[76:79], v3, s[12:15], s20 offen sc1
    s_add_u32 s20, s20, 1024
    s_waitcnt lgkmcnt(2)
    buffer_store_dwordx4 v[80:83], v3, s[12:15], s20 offen sc1
    s_add_u32 s20, s20, 1024
    s_waitcnt lgkmcnt(0)
    buffer_store_dwordx4 v[84:87], v3, s[12:15], s20 offen sc1
    s_add_u32 s20, s20, 655360
    s_endpgm
ROLE_5:
    s_getpc_b64 s[4:5]
PF_7:
    s_add_u32 s4, s4, k3_kernel-PF_7
    s_addc_u32 s5, s5, 0
    v_lshlrev_b32 v1, 7, v0
    v_add_u32 v2, 0, v1
    v_min_u32 v2, G2_END-k3_kernel, v2
    global_load_dword v4, v2, s[4:5]
    v_add_u32 v2, 32768, v1
    v_min_u32 v2, G2_END-k3_kernel, v2
    global_load_dword v5, v2, s[4:5]
    s_load_dwordx2 s[6:7], s[0:1], 104
    v_lshlrev_b32 v3, 4, v0
    v_mov_b32 v8, 0
    v_mov_b32 v9, 0
    v_mov_b32 v10, 0
    v_mov_b32 v11, 0
    s_lshl_b32 s12, s3, 12
    s_waitcnt lgkmcnt(0)
    s_add_u32 s8, s6, 9699328
    s_addc_u32 s9, s7, 0
    s_and_b32 s9, s9, 0xffff
    s_mov_b32 s10, 45056
    s_mov_b32 s11, 0x00020000
    buffer_store_dwordx4 v[8:11], v3, s[8:11], s12 offen
    s_add_u32 s12, s12, 32768
    buffer_store_dwordx4 v[8:11], v3, s[8:11], s12 offen
    s_endpgm
K1_END:
.globl k3_kernel
.p2align 8
.type k3_kernel,@function
k3_kernel:
    s_cmp_ge_u32 s2, 256
    s_cbranch_scc0 G1_GO
    s_endpgm
G1_GO:
    s_load_dwordx2 s[4:5], s[0:1], 104
    s_load_dwordx2 s[6:7], s[0:1], 88
    v_lshrrev_b32 v1, 6, v0
    v_and_b32 v2, 63, v0
    v_readfirstlane_b32 s28, v1
    s_and_b32 s30, s2, 7
    s_lshl_b32 s30, s30, 1
    s_bfe_u32 s29, s2, 0x10003
    s_add_u32 s30, s30, s29
    s_lshr_b32 s29, s2, 4
    s_and_b32 s30, s2, 6
    s_lshl_b32 s30, s30, 1
    s_bfe_u32 s29, s2, 0x20003
    s_add_u32 s30, s30, s29
    s_and_b32 s29, s2, 1
    s_lshl_b32 s29, s29, 3
    s_lshr_b32 s31, s2, 5
    s_add_u32 s29, s29, s31
    v_lshrrev_b32 v5, 4, v2
    v_bfe_u32 v6, v2, 1, 3
    v_and_b32 v7, 1, v2
    v_xor_b32 v8, v6, v5
    v_lshl_or_b32 v3, v8, 1, v7
    v_lshlrev_b32 v3, 4, v3
    v_lshl_add_u32 v3, v5, 8, v3
    v_xor_b32 v4, 128, v3
    v_lshlrev_b32 v9, 4, v2
    s_lshl_b32 s33, s28, 11
    s_mul_i32 s32, s29, 147456
    s_add_u32 s32, s32, s33
    s_lshl_b32 s34, s30, 2
    s_add_u32 s34, s34, s28
    s_mul_i32 s35, s34, 3
    s_mul_i32 s31, s34, 55296
    s_waitcnt lgkmcnt(0)
    s_add_u32 s8, s4, 10485760
    s_addc_u32 s9, s5, 0
    s_and_b32 s9, s9, 0xffff
    s_mov_b32 s10, 2359296
    s_mov_b32 s11, 0x00020000
    s_add_u32 s12, s4, 16777216
    s_addc_u32 s13, s5, 0
    s_and_b32 s13, s13, 0xffff
    s_mov_b32 s14, 10616832
    s_mov_b32 s15, 0x00020000
    s_mov_b32 m0, s33
    s_add_u32 s33, s33, 8192
    buffer_load_dwordx4 v3, s[8:11], s32 offen lds
    buffer_load_dwordx4 v4, s[8:11], s32 offen offset:1024 lds
    s_add_u32 s32, s32, 8192
    buffer_load_dwordx4 a[0:3], v9, s[12:15], s31 offen offset:0
    buffer_load_dwordx4 a[4:7], v9, s[12:15], s31 offen offset:1024
    buffer_load_dwordx4 a[8:11], v9, s[12:15], s31 offen offset:2048
    s_add_u32 s31, s31, 3072
    s_mov_b32 m0, s33
    s_add_u32 s33, s33, 8192
    buffer_load_dwordx4 v3, s[8:11], s32 offen lds
    buffer_load_dwordx4 v4, s[8:11], s32 offen offset:1024 lds
    s_add_u32 s32, s32, 8192
    buffer_load_dwordx4 a[12:15], v9, s[12:15], s31 offen offset:0
    buffer_load_dwordx4 a[16:19], v9, s[12:15], s31 offen offset:1024
    buffer_load_dwordx4 a[20:23], v9, s[12:15], s31 offen offset:2048
    s_add_u32 s31, s31, 3072
    v_lshrrev_b32 v5, 2, v2
    v_and_b32 v6, 7, v5
    v_lshlrev_b32 v5, 8, v5
    v_and_b32 v7, 3, v2
    v_lshl_add_u32 v5, v7, 3, v5
    s_lshl_b32 s36, s28, 1
    v_mov_b32 v8, 0x3f803f80
    s_add_u32 s38, s36, 0
    s_and_b32 s38, s38, 7
    v_xor_b32 v7, s38, v6
    v_lshl_add_u32 v10, v7, 5, v5
    s_add_u32 s38, s36, 1
    s_and_b32 s38, s38, 7
    v_xor_b32 v7, s38, v6
    v_lshl_add_u32 v11, v7, 5, v5
    s_add_u32 s38, s36, 2
    s_and_b32 s38, s38, 7
    v_xor_b32 v7, s38, v6
    v_lshl_add_u32 v12, v7, 5, v5
    s_add_u32 s38, s36, 3
    s_and_b32 s38, s38, 7
    v_xor_b32 v7, s38, v6
    v_lshl_add_u32 v13, v7, 5, v5
    s_add_u32 s38, s36, 4
    s_and_b32 s38, s38, 7
    v_xor_b32 v7, s38, v6
    v_lshl_add_u32 v14, v7, 5, v5
    s_add_u32 s38, s36, 5
    s_and_b32 s38, s38, 7
    v_xor_b32 v7, s38, v6
    v_lshl_add_u32 v15, v7, 5, v5
    s_add_u32 s38, s36, 6
    s_and_b32 s38, s38, 7
    v_xor_b32 v7, s38, v6
    v_lshl_add_u32 v16, v7, 5, v5
    s_add_u32 s38, s36, 7
    s_and_b32 s38, s38, 7
    v_xor_b32 v7, s38, v6
    v_lshl_add_u32 v17, v7, 5, v5
    v_accvgpr_write_b32 a156, v8
    v_accvgpr_write_b32 a157, v8
    v_accvgpr_write_b32 a158, v8
    v_accvgpr_write_b32 a159, v8
    s_waitcnt vmcnt(8)
    s_barrier
    ds_read_b64_tr_b16 a[108:109], v10 offset:0
    ds_read_b64_tr_b16 a[110:111], v10 offset:4096
    ds_read_b64_tr_b16 a[112:113], v11 offset:0
    ds_read_b64_tr_b16 a[114:115], v11 offset:4096
    ds_read_b64_tr_b16 a[116:117], v12 offset:0
    ds_read_b64_tr_b16 a[118:119], v12 offset:4096
    ds_read_b64_tr_b16 a[120:121], v13 offset:0
    ds_read_b64_tr_b16 a[122:123], v13 offset:4096
    ds_read_b64_tr_b16 a[124:125], v14 offset:0
    ds_read_b64_tr_b16 a[126:127], v14 offset:4096
    ds_read_b64_tr_b16 a[128:129], v15 offset:0
    ds_read_b64_tr_b16 a[130:131], v15 offset:4096
    ds_read_b64_tr_b16 a[132:133], v16 offset:0
    ds_read_b64_tr_b16 a[134:135], v16 offset:4096
    s_waitcnt lgkmcnt(12)
    s_waitcnt vmcnt(7)
    v_mfma_f32_16x16x32_bf16 v[64:67], a[0:3], a[108:111], 0
    ds_read_b64_tr_b16 a[136:137], v17 offset:0
    s_waitcnt vmcnt(6)
    v_mfma_f32_16x16x32_bf16 v[96:99], a[4:7], a[108:111], 0
    ds_read_b64_tr_b16 a[138:139], v17 offset:4096
    s_waitcnt vmcnt(5)
    v_mfma_f32_16x16x32_bf16 v[128:131], a[8:11], a[108:111], 0
    s_mov_b32 m0, s33
    s_add_u32 s33, s33, 8192
    v_mfma_f32_16x16x32_bf16 a[140:143], a[156:159], a[108:111], 0
    buffer_load_dwordx4 v3, s[8:11], s32 offen lds
    v_mfma_f32_16x16x32_bf16 a[148:151], a[108:111], a[108:111], 0
    s_waitcnt lgkmcnt(12)
    v_mfma_f32_16x16x32_bf16 v[68:71], a[0:3], a[112:115], 0
    s_waitcnt vmcnt(4)
    s_barrier
    v_mfma_f32_16x16x32_bf16 v[100:103], a[4:7], a[112:115], 0
    ds_read_b64_tr_b16 a[108:109], v10 offset:8192
    ds_read_b64_tr_b16 a[110:111], v10 offset:12288
    v_mfma_f32_16x16x32_bf16 v[132:135], a[8:11], a[112:115], 0
    buffer_load_dwordx4 v4, s[8:11], s32 offen offset:1024 lds
    v_mfma_f32_16x16x32_bf16 a[144:147], a[156:159], a[112:115], 0
    s_add_u32 s32, s32, 8192
    v_mfma_f32_16x16x32_bf16 a[152:155], a[112:115], a[112:115], 0
    s_waitcnt lgkmcnt(12)
    v_mfma_f32_16x16x32_bf16 v[72:75], a[0:3], a[116:119], 0
    ds_read_b64_tr_b16 a[112:113], v11 offset:8192
    ds_read_b64_tr_b16 a[114:115], v11 offset:12288
    v_mfma_f32_16x16x32_bf16 v[104:107], a[4:7], a[116:119], 0
    buffer_load_dwordx4 a[24:27], v9, s[12:15], s31 offen offset:0
    v_mfma_f32_16x16x32_bf16 v[136:139], a[8:11], a[116:119], 0
    s_waitcnt lgkmcnt(12)
    v_mfma_f32_16x16x32_bf16 v[76:79], a[0:3], a[120:123], 0
    ds_read_b64_tr_b16 a[116:117], v12 offset:8192
    ds_read_b64_tr_b16 a[118:119], v12 offset:12288
    v_mfma_f32_16x16x32_bf16 v[108:111], a[4:7], a[120:123], 0
    buffer_load_dwordx4 a[28:31], v9, s[12:15], s31 offen offset:1024
    v_mfma_f32_16x16x32_bf16 v[140:143], a[8:11], a[120:123], 0
    s_waitcnt lgkmcnt(12)
    v_mfma_f32_16x16x32_bf16 v[80:83], a[0:3], a[124:127], 0
    ds_read_b64_tr_b16 a[120:121], v13 offset:8192
    ds_read_b64_tr_b16 a[122:123], v13 offset:12288
    v_mfma_f32_16x16x32_bf16 v[112:115], a[4:7], a[124:127], 0
    buffer_load_dwordx4 a[32:35], v9, s[12:15], s31 offen offset:2048
    v_mfma_f32_16x16x32_bf16 v[144:147], a[8:11], a[124:127], 0
    s_add_u32 s31, s31, 3072
    s_waitcnt lgkmcnt(12)
    v_mfma_f32_16x16x32_bf16 v[84:87], a[0:3], a[128:131], 0
    ds_read_b64_tr_b16 a[124:125], v14 offset:8192
    ds_read_b64_tr_b16 a[126:127], v14 offset:12288
    v_mfma_f32_16x16x32_bf16 v[116:119], a[4:7], a[128:131], 0
    s_mov_b32 m0, s33
    s_add_u32 s33, s33, 8192
    v_mfma_f32_16x16x32_bf16 v[148:151], a[8:11], a[128:131], 0
    s_waitcnt lgkmcnt(12)
    v_mfma_f32_16x16x32_bf16 v[88:91], a[0:3], a[132:135], 0
    ds_read_b64_tr_b16 a[128:129], v15 offset:8192
    ds_read_b64_tr_b16 a[130:131], v15 offset:12288
    v_mfma_f32_16x16x32_bf16 v[120:123], a[4:7], a[132:135], 0
    buffer_load_dwordx4 v3, s[8:11], s32 offen lds
    v_mfma_f32_16x16x32_bf16 v[152:155], a[8:11], a[132:135], 0
    s_waitcnt lgkmcnt(12)
    v_mfma_f32_16x16x32_bf16 v[92:95], a[0:3], a[136:139], 0
    ds_read_b64_tr_b16 a[132:133], v16 offset:8192
    ds_read_b64_tr_b16 a[134:135], v16 offset:12288
    v_mfma_f32_16x16x32_bf16 v[124:127], a[4:7], a[136:139], 0
    buffer_load_dwordx4 v4, s[8:11], s32 offen offset:1024 lds
    v_mfma_f32_16x16x32_bf16 v[156:159], a[8:11], a[136:139], 0
    s_waitcnt lgkmcnt(6)
    s_waitcnt vmcnt(9)
    v_mfma_f32_16x16x32_bf16 v[64:67], a[12:15], a[108:111], v[64:67]
    ds_read_b64_tr_b16 a[136:137], v17 offset:8192
    s_waitcnt vmcnt(8)
    v_mfma_f32_16x16x32_bf16 v[96:99], a[16:19], a[108:111], v[96:99]
    ds_read_b64_tr_b16 a[138:139], v17 offset:12288
    s_waitcnt vmcnt(7)
    v_mfma_f32_16x16x32_bf16 v[128:131], a[20:23], a[108:111], v[128:131]
    s_add_u32 s32, s32, 8192
    v_mfma_f32_16x16x32_bf16 a[140:143], a[156:159], a[108:111], a[140:143]
    buffer_load_dwordx4 a[36:39], v9, s[12:15], s31 offen offset:0
    v_mfma_f32_16x16x32_bf16 a[148:151], a[108:111], a[108:111], a[148:151]
    buffer_load_dwordx4 a[40:43], v9, s[12:15], s31 offen offset:1024
    v_mfma_f32_16x16x32_bf16 v[68:71], a[12:15], a[112:115], v[68:71]
    s_waitcnt vmcnt(7)
    s_barrier
    v_mfma_f32_16x16x32_bf16 v[100:103], a[16:19], a[112:115], v[100:103]
    ds_read_b64_tr_b16 a[108:109], v10 offset:16384
    ds_read_b64_tr_b16 a[110:111], v10 offset:20480
    v_mfma_f32_16x16x32_bf16 v[132:135], a[20:23], a[112:115], v[132:135]
    buffer_load_dwordx4 a[44:47], v9, s[12:15], s31 offen offset:2048
    v_mfma_f32_16x16x32_bf16 a[144:147], a[156:159], a[112:115], a[144:147]
    s_add_u32 s31, s31, 3072
    s_mov_b32 m0, s33
    v_mfma_f32_16x16x32_bf16 a[152:155], a[112:115], a[112:115], a[152:155]
    s_add_u32 s33, s33, 8192
    v_mfma_f32_16x16x32_bf16 v[72:75], a[12:15], a[116:119], v[72:75]
    ds_read_b64_tr_b16 a[112:113], v11 offset:16384
    ds_read_b64_tr_b16 a[114:115], v11 offset:20480
    v_mfma_f32_16x16x32_bf16 v[104:107], a[16:19], a[116:119], v[104:107]
    buffer_load_dwordx4 v3, s[8:11], s32 offen lds
    v_mfma_f32_16x16x32_bf16 v[136:139], a[20:23], a[116:119], v[136:139]
    buffer_load_dwordx4 v4, s[8:11], s32 offen offset:1024 lds
    v_mfma_f32_16x16x32_bf16 v[76:79], a[12:15], a[120:123], v[76:79]
    ds_read_b64_tr_b16 a[116:117], v12 offset:16384
    ds_read_b64_tr_b16 a[118:119], v12 offset:20480
    v_mfma_f32_16x16x32_bf16 v[108:111], a[16:19], a[120:123], v[108:111]
    s_add_u32 s32, s32, 8192
    v_mfma_f32_16x16x32_bf16 v[140:143], a[20:23], a[120:123], v[140:143]
    s_waitcnt lgkmcnt(6)
    v_mfma_f32_16x16x32_bf16 v[80:83], a[12:15], a[124:127], v[80:83]
    ds_read_b64_tr_b16 a[120:121], v13 offset:16384
    ds_read_b64_tr_b16 a[122:123], v13 offset:20480
    v_mfma_f32_16x16x32_bf16 v[112:115], a[16:19], a[124:127], v[112:115]
    buffer_load_dwordx4 a[48:51], v9, s[12:15], s31 offen offset:0
    v_mfma_f32_16x16x32_bf16 v[144:147], a[20:23], a[124:127], v[144:147]
    buffer_load_dwordx4 a[52:55], v9, s[12:15], s31 offen offset:1024
    v_mfma_f32_16x16x32_bf16 v[84:87], a[12:15], a[128:131], v[84:87]
    ds_read_b64_tr_b16 a[124:125], v14 offset:16384
    ds_read_b64_tr_b16 a[126:127], v14 offset:20480
    v_mfma_f32_16x16x32_bf16 v[116:119], a[16:19], a[128:131], v[116:119]
    buffer_load_dwordx4 a[56:59], v9, s[12:15], s31 offen offset:2048
    v_mfma_f32_16x16x32_bf16 v[148:151], a[20:23], a[128:131], v[148:151]
    s_add_u32 s31, s31, 3072
    s_mov_b32 m0, s33
    v_mfma_f32_16x16x32_bf16 v[88:91], a[12:15], a[132:135], v[88:91]
    ds_read_b64_tr_b16 a[128:129], v15 offset:16384
    ds_read_b64_tr_b16 a[130:131], v15 offset:20480
    v_mfma_f32_16x16x32_bf16 v[120:123], a[16:19], a[132:135], v[120:123]
    s_add_u32 s33, s33, 8192
    v_mfma_f32_16x16x32_bf16 v[152:155], a[20:23], a[132:135], v[152:155]
    buffer_load_dwordx4 v3, s[8:11], s32 offen lds
    v_mfma_f32_16x16x32_bf16 v[92:95], a[12:15], a[136:139], v[92:95]
    ds_read_b64_tr_b16 a[132:133], v16 offset:16384
    ds_read_b64_tr_b16 a[134:135], v16 offset:20480
    v_mfma_f32_16x16x32_bf16 v[124:127], a[16:19], a[136:139], v[124:127]
    buffer_load_dwordx4 v4, s[8:11], s32 offen offset:1024 lds
    v_mfma_f32_16x16x32_bf16 v[156:159], a[20:23], a[136:139], v[156:159]
    s_waitcnt lgkmcnt(6)
    s_waitcnt vmcnt(14)
    v_mfma_f32_16x16x32_bf16 v[64:67], a[24:27], a[108:111], v[64:67]
    ds_read_b64_tr_b16 a[136:137], v17 offset:16384
    s_waitcnt vmcnt(13)
    v_mfma_f32_16x16x32_bf16 v[96:99], a[28:31], a[108:111], v[96:99]
    ds_read_b64_tr_b16 a[138:139], v17 offset:20480
    s_waitcnt vmcnt(12)
    v_mfma_f32_16x16x32_bf16 v[128:131], a[32:35], a[108:111], v[128:131]
    s_add_u32 s32, s32, 8192
    v_mfma_f32_16x16x32_bf16 a[140:143], a[156:159], a[108:111], a[140:143]
    buffer_load_dwordx4 a[60:63], v9, s[12:15], s31 offen offset:0
    v_mfma_f32_16x16x32_bf16 a[148:151], a[108:111], a[108:111], a[148:151]
    buffer_load_dwordx4 a[64:67], v9, s[12:15], s31 offen offset:1024
    v_mfma_f32_16x16x32_bf16 v[68:71], a[24:27], a[112:115], v[68:71]
    s_waitcnt vmcnt(12)
    s_barrier
    v_mfma_f32_16x16x32_bf16 v[100:103], a[28:31], a[112:115], v[100:103]
    ds_read_b64_tr_b16 a[108:109], v10 offset:24576
    ds_read_b64_tr_b16 a[110:111], v10 offset:28672
    v_mfma_f32_16x16x32_bf16 v[132:135], a[32:35], a[112:115], v[132:135]
    buffer_load_dwordx4 a[68:71], v9, s[12:15], s31 offen offset:2048
    v_mfma_f32_16x16x32_bf16 a[144:147], a[156:159], a[112:115], a[144:147]
    s_add_u32 s31, s31, 3072
    s_mov_b32 m0, s33
    v_mfma_f32_16x16x32_bf16 a[152:155], a[112:115], a[112:115], a[152:155]
    s_add_u32 s33, s33, 8192
    v_mfma_f32_16x16x32_bf16 v[72:75], a[24:27], a[116:119], v[72:75]
    ds_read_b64_tr_b16 a[112:113], v11 offset:24576
    ds_read_b64_tr_b16 a[114:115], v11 offset:28672
    v_mfma_f32_16x16x32_bf16 v[104:107], a[28:31], a[116:119], v[104:107]
    buffer_load_dwordx4 v3, s[8:11], s32 offen lds
    v_mfma_f32_16x16x32_bf16 v[136:139], a[32:35], a[116:119], v[136:139]
    buffer_load_dwordx4 v4, s[8:11], s32 offen offset:1024 lds
    v_mfma_f32_16x16x32_bf16 v[76:79], a[24:27], a[120:123], v[76:79]
    ds_read_b64_tr_b16 a[116:117], v12 offset:24576
    ds_read_b64_tr_b16 a[118:119], v12 offset:28672
    v_mfma_f32_16x16x32_bf16 v[108:111], a[28:31], a[120:123], v[108:111]
    s_add_u32 s32, s32, 8192
    v_mfma_f32_16x16x32_bf16 v[140:143], a[32:35], a[120:123], v[140:143]
    s_waitcnt lgkmcnt(6)
    v_mfma_f32_16x16x32_bf16 v[80:83], a[24:27], a[124:127], v[80:83]
    ds_read_b64_tr_b16 a[120:121], v13 offset:24576
    ds_read_b64_tr_b16 a[122:123], v13 offset:28672
    v_mfma_f32_16x16x32_bf16 v[112:115], a[28:31], a[124:127], v[112:115]
    buffer_load_dwordx4 a[72:75], v9, s[12:15], s31 offen offset:0
    v_mfma_f32_16x16x32_bf16 v[144:147], a[32:35], a[124:127], v[144:147]
    buffer_load_dwordx4 a[76:79], v9, s[12:15], s31 offen offset:1024
    v_mfma_f32_16x16x32_bf16 v[84:87], a[24:27], a[128:131], v[84:87]
    ds_read_b64_tr_b16 a[124:125], v14 offset:24576
    ds_read_b64_tr_b16 a[126:127], v14 offset:28672
    v_mfma_f32_16x16x32_bf16 v[116:119], a[28:31], a[128:131], v[116:119]
    s_add_u32 s20, s4, 8912896
    s_addc_u32 s21, s5, 0
    v_mfma_f32_16x16x32_bf16 v[148:151], a[32:35], a[128:131], v[148:151]
    s_and_b32 s21, s21, 0xffff
    s_mov_b32 s22, 221184
    v_mfma_f32_16x16x32_bf16 v[88:91], a[24:27], a[132:135], v[88:91]
    ds_read_b64_tr_b16 a[128:129], v15 offset:24576
    ds_read_b64_tr_b16 a[130:131], v15 offset:28672
    v_mfma_f32_16x16x32_bf16 v[120:123], a[28:31], a[132:135], v[120:123]
    buffer_load_dwordx4 a[80:83], v9, s[12:15], s31 offen offset:2048
    v_mfma_f32_16x16x32_bf16 v[152:155], a[32:35], a[132:135], v[152:155]
    s_add_u32 s31, s31, 3072
    s_mov_b32 s23, 0x00020000
    v_mfma_f32_16x16x32_bf16 v[92:95], a[24:27], a[136:139], v[92:95]
    ds_read_b64_tr_b16 a[132:133], v16 offset:24576
    ds_read_b64_tr_b16 a[134:135], v16 offset:28672
    v_mfma_f32_16x16x32_bf16 v[124:127], a[28:31], a[136:139], v[124:127]
    v_and_b32 v5, 15, v2
    v_lshrrev_b32 v6, 4, v2
    v_mfma_f32_16x16x32_bf16 v[156:159], a[32:35], a[136:139], v[156:159]
    s_waitcnt lgkmcnt(6)
    s_waitcnt vmcnt(15)
    v_mfma_f32_16x16x32_bf16 v[64:67], a[36:39], a[108:111], v[64:67]
    ds_read_b64_tr_b16 a[136:137], v17 offset:24576
    ds_read_b64_tr_b16 a[138:139], v17 offset:28672
    v_mfma_f32_16x16x32_bf16 v[96:99], a[40:43], a[108:111], v[96:99]
    s_mov_b32 m0, s33
    s_add_u32 s33, s33, 8192
    v_mfma_f32_16x16x32_bf16 v[128:131], a[44:47], a[108:111], v[128:131]
    buffer_load_dwordx4 v3, s[8:11], s32 offen lds
    v_mfma_f32_16x16x32_bf16 a[140:143], a[156:159], a[108:111], a[140:143]
    v_add_u32 v7, s36, v6
    v_and_b32 v8, 3, v7
    v_mfma_f32_16x16x32_bf16 a[148:151], a[108:111], a[108:111], a[148:151]
    v_lshlrev_b32 v18, 10, v8
    v_lshl_add_u32 v18, v5, 4, v18
    v_mfma_f32_16x16x32_bf16 v[68:71], a[36:39], a[112:115], v[68:71]
    s_waitcnt vmcnt(9)
    s_barrier
    v_mfma_f32_16x16x32_bf16 v[100:103], a[40:43], a[112:115], v[100:103]
    ds_read_b64_tr_b16 a[108:109], v10 offset:32768
    ds_read_b64_tr_b16 a[110:111], v10 offset:36864
    v_mfma_f32_16x16x32_bf16 v[132:135], a[44:47], a[112:115], v[132:135]
    buffer_load_dwordx4 v4, s[8:11], s32 offen offset:1024 lds
    v_mfma_f32_16x16x32_bf16 a[144:147], a[156:159], a[112:115], a[144:147]
    s_add_u32 s32, s32, 8192
    v_bfe_u32 v7, v7, 2, 1
    v_mfma_f32_16x16x32_bf16 a[152:155], a[112:115], a[112:115], a[152:155]
    v_xor_b32 v8, 1, v7
    s_mov_b32 s38, 589824
    v_mfma_f32_16x16x32_bf16 v[72:75], a[36:39], a[116:119], v[72:75]
    ds_read_b64_tr_b16 a[112:113], v11 offset:32768
    ds_read_b64_tr_b16 a[114:115], v11 offset:36864
    v_mfma_f32_16x16x32_bf16 v[104:107], a[40:43], a[116:119], v[104:107]
    buffer_load_dwordx4 a[84:87], v9, s[12:15], s31 offen offset:0
    v_mfma_f32_16x16x32_bf16 v[136:139], a[44:47], a[116:119], v[136:139]
    v_mad_u32_u24 v19, v8, s38, v18
    v_mad_u32_u24 v18, v7, s38, v18
    v_mfma_f32_16x16x32_bf16 v[76:79], a[36:39], a[120:123], v[76:79]
    ds_read_b64_tr_b16 a[116:117], v12 offset:32768
    ds_read_b64_tr_b16 a[118:119], v12 offset:36864
    v_mfma_f32_16x16x32_bf16 v[108:111], a[40:43], a[120:123], v[108:111]
    v_and_b32 v7, 7, v2
    v_mul_u32_u24 v25, 36864, v7
    v_mfma_f32_16x16x32_bf16 v[140:143], a[44:47], a[120:123], v[140:143]
    v_lshl_add_u32 v25, v6, 4, v25
    s_waitcnt lgkmcnt(6)
    v_mfma_f32_16x16x32_bf16 v[80:83], a[36:39], a[124:127], v[80:83]
    ds_read_b64_tr_b16 a[120:121], v13 offset:32768
    ds_read_b64_tr_b16 a[122:123], v13 offset:36864
    v_mfma_f32_16x16x32_bf16 v[112:115], a[40:43], a[124:127], v[112:115]
    buffer_load_dwordx4 a[88:91], v9, s[12:15], s31 offen offset:1024
    v_mfma_f32_16x16x32_bf16 v[144:147], a[44:47], a[124:127], v[144:147]
    s_lshl_b32 s38, s28, 7
    s_add_u32 s38, s38, 147456
    v_mfma_f32_16x16x32_bf16 v[84:87], a[36:39], a[128:131], v[84:87]
    ds_read_b64_tr_b16 a[124:125], v14 offset:32768
    ds_read_b64_tr_b16 a[126:127], v14 offset:36864
    v_mfma_f32_16x16x32_bf16 v[116:119], a[40:43], a[128:131], v[116:119]
    v_lshl_add_u32 v26, v5, 2, s38
    s_mul_i32 s37, s29, 1179648
    v_mfma_f32_16x16x32_bf16 v[148:151], a[44:47], a[128:131], v[148:151]
    s_lshl_b32 s51, s35, 6
    v_mfma_f32_16x16x32_bf16 v[88:91], a[36:39], a[132:135], v[88:91]
    ds_read_b64_tr_b16 a[128:129], v15 offset:32768
    ds_read_b64_tr_b16 a[130:131], v15 offset:36864
    v_mfma_f32_16x16x32_bf16 v[120:123], a[40:43], a[132:135], v[120:123]
    buffer_load_dwordx4 a[92:95], v9, s[12:15], s31 offen offset:2048
    v_mfma_f32_16x16x32_bf16 v[152:155], a[44:47], a[132:135], v[152:155]
    s_add_u32 s31, s31, 3072
    v_mfma_f32_16x16x32_bf16 v[92:95], a[36:39], a[136:139], v[92:95]
    ds_read_b64_tr_b16 a[132:133], v16 offset:32768
    ds_read_b64_tr_b16 a[134:135], v16 offset:36864
    v_mfma_f32_16x16x32_bf16 v[124:127], a[40:43], a[136:139], v[124:127]
    s_add_u32 s16, s4, 50331648
    s_addc_u32 s17, s5, 0
    v_mfma_f32_16x16x32_bf16 v[156:159], a[44:47], a[136:139], v[156:159]
    s_and_b32 s17, s17, 0xffff
    s_waitcnt lgkmcnt(6)
    v_mfma_f32_16x16x32_bf16 v[64:67], a[48:51], a[108:111], v[64:67]
    ds_read_b64_tr_b16 a[136:137], v17 offset:32768
    ds_read_b64_tr_b16 a[138:139], v17 offset:36864
    v_mfma_f32_16x16x32_bf16 v[96:99], a[52:55], a[108:111], v[96:99]
    s_mov_b32 m0, s33
    s_add_u32 s33, s33, 8192
    v_mfma_f32_16x16x32_bf16 v[128:131], a[56:59], a[108:111], v[128:131]
    buffer_load_dwordx4 v3, s[8:11], s32 offen lds
    v_mfma_f32_16x16x32_bf16 a[140:143], a[156:159], a[108:111], a[140:143]
    s_mov_b32 s18, 29360128
    s_mov_b32 s19, 0x00020000
    v_mfma_f32_16x16x32_bf16 a[148:151], a[108:111], a[108:111], a[148:151]
    s_add_u32 s24, s4, 9572352
    s_addc_u32 s25, s5, 0
    v_mfma_f32_16x16x32_bf16 v[68:71], a[48:51], a[112:115], v[68:71]
    ds_read_b64_tr_b16 a[108:109], v10 offset:40960
    ds_read_b64_tr_b16 a[110:111], v10 offset:45056
    v_mfma_f32_16x16x32_bf16 v[100:103], a[52:55], a[112:115], v[100:103]
    buffer_load_dwordx4 v4, s[8:11], s32 offen offset:1024 lds
    v_mfma_f32_16x16x32_bf16 v[132:135], a[56:59], a[112:115], v[132:135]
    s_add_u32 s32, s32, 8192
    s_and_b32 s25, s25, 0xffff
    v_mfma_f32_16x16x32_bf16 a[144:147], a[156:159], a[112:115], a[144:147]
    s_mov_b32 s26, 32768
    s_mov_b32 s27, 0x00020000
    v_mfma_f32_16x16x32_bf16 a[152:155], a[112:115], a[112:115], a[152:155]
    s_add_u32 s60, s4, 33554432
    s_addc_u32 s61, s5, 0
    v_mfma_f32_16x16x32_bf16 v[72:75], a[48:51], a[116:119], v[72:75]
    ds_read_b64_tr_b16 a[112:113], v11 offset:40960
    ds_read_b64_tr_b16 a[114:115], v11 offset:45056
    v_mfma_f32_16x16x32_bf16 v[104:107], a[52:55], a[116:119], v[104:107]
    buffer_load_dwordx4 a[96:99], v9, s[12:15], s31 offen offset:0
    v_mfma_f32_16x16x32_bf16 v[136:139], a[56:59], a[116:119], v[136:139]
    s_and_b32 s61, s61, 0xffff
    s_mov_b32 s62, 5308416
    v_mfma_f32_16x16x32_bf16 v[76:79], a[48:51], a[120:123], v[76:79]
    ds_read_b64_tr_b16 a[116:117], v12 offset:40960
    ds_read_b64_tr_b16 a[118:119], v12 offset:45056
    v_mfma_f32_16x16x32_bf16 v[108:111], a[52:55], a[120:123], v[108:111]
    s_mov_b32 s63, 0x00020000
    v_mfma_f32_16x16x32_bf16 v[140:143], a[56:59], a[120:123], v[140:143]
    s_waitcnt lgkmcnt(6)
    v_mfma_f32_16x16x32_bf16 v[80:83], a[48:51], a[124:127], v[80:83]
    ds_read_b64_tr_b16 a[120:121], v13 offset:40960
    ds_read_b64_tr_b16 a[122:123], v13 offset:45056
    v_mfma_f32_16x16x32_bf16 v[112:115], a[52:55], a[124:127], v[112:115]
    buffer_load_dwordx4 a[100:103], v9, s[12:15], s31 offen offset:1024
    v_mfma_f32_16x16x32_bf16 v[144:147], a[56:59], a[124:127], v[144:147]
    s_add_u32 s64, s4, 9699328
    s_addc_u32 s65, s5, 0
    v_mfma_f32_16x16x32_bf16 v[84:87], a[48:51], a[128:131], v[84:87]
    ds_read_b64_tr_b16 a[124:125], v14 offset:40960
    ds_read_b64_tr_b16 a[126:127], v14 offset:45056
    v_mfma_f32_16x16x32_bf16 v[116:119], a[52:55], a[128:131], v[116:119]
    s_and_b32 s65, s65, 0xffff
    s_mov_b32 s66, 45056
    v_mfma_f32_16x16x32_bf16 v[148:151], a[56:59], a[128:131], v[148:151]
    s_mov_b32 s67, 0x00020000
    s_mov_b32 s68, s6
    v_mfma_f32_16x16x32_bf16 v[88:91], a[48:51], a[132:135], v[88:91]
    ds_read_b64_tr_b16 a[128:129], v15 offset:40960
    ds_read_b64_tr_b16 a[130:131], v15 offset:45056
    v_mfma_f32_16x16x32_bf16 v[120:123], a[52:55], a[132:135], v[120:123]
    buffer_load_dwordx4 a[104:107], v9, s[12:15], s31 offen offset:2048
    v_mfma_f32_16x16x32_bf16 v[152:155], a[56:59], a[132:135], v[152:155]
    s_add_u32 s31, s31, 3072
    s_and_b32 s69, s7, 0xffff
    v_mfma_f32_16x16x32_bf16 v[92:95], a[48:51], a[136:139], v[92:95]
    ds_read_b64_tr_b16 a[132:133], v16 offset:40960
    ds_read_b64_tr_b16 a[134:135], v16 offset:45056
    v_mfma_f32_16x16x32_bf16 v[124:127], a[52:55], a[136:139], v[124:127]
    s_mov_b32 s70, 2359296
    s_mov_b32 s71, 0x00020000
    v_mfma_f32_16x16x32_bf16 v[156:159], a[56:59], a[136:139], v[156:159]
    s_waitcnt lgkmcnt(6)
    s_waitcnt vmcnt(15)
    v_mfma_f32_16x16x32_bf16 v[64:67], a[60:63], a[108:111], v[64:67]
    ds_read_b64_tr_b16 a[136:137], v17 offset:40960
    ds_read_b64_tr_b16 a[138:139], v17 offset:45056
    v_mfma_f32_16x16x32_bf16 v[96:99], a[64:67], a[108:111], v[96:99]
    s_mov_b32 m0, s33
    s_add_u32 s33, s33, 8192
    v_mfma_f32_16x16x32_bf16 v[128:131], a[68:71], a[108:111], v[128:131]
    buffer_load_dwordx4 v3, s[8:11], s32 offen lds
    v_mfma_f32_16x16x32_bf16 a[140:143], a[156:159], a[108:111], a[140:143]
    s_add_u32 s38, s35, 0
    s_lshr_b32 s39, s38, 2
    v_mfma_f32_16x16x32_bf16 a[148:151], a[108:111], a[108:111], a[148:151]
    buffer_load_dwordx4 v4, s[8:11], s32 offen offset:1024 lds
    v_mfma_f32_16x16x32_bf16 v[68:71], a[60:63], a[112:115], v[68:71]
    s_waitcnt vmcnt(10)
    s_barrier
    v_mfma_f32_16x16x32_bf16 v[100:103], a[64:67], a[112:115], v[100:103]
    ds_read_b64_tr_b16 a[108:109], v10 offset:49152
    ds_read_b64_tr_b16 a[110:111], v10 offset:53248
    v_mfma_f32_16x16x32_bf16 v[132:135], a[68:71], a[112:115], v[132:135]
    s_add_u32 s32, s32, 8192
    s_lshl_b32 s39, s39, 12
    v_mfma_f32_16x16x32_bf16 a[144:147], a[156:159], a[112:115], a[144:147]
    s_and_b32 s38, s38, 3
    s_lshl_b32 s38, s38, 8
    v_mfma_f32_16x16x32_bf16 a[152:155], a[112:115], a[112:115], a[152:155]
    buffer_load_dwordx4 a[0:3], v9, s[12:15], s31 offen offset:0
    v_mfma_f32_16x16x32_bf16 v[72:75], a[60:63], a[116:119], v[72:75]
    ds_read_b64_tr_b16 a[112:113], v11 offset:49152
    ds_read_b64_tr_b16 a[114:115], v11 offset:53248
    v_mfma_f32_16x16x32_bf16 v[104:107], a[64:67], a[116:119], v[104:107]
    s_add_u32 s39, s39, s38
    s_add_u32 s40, s39, s37
    v_mfma_f32_16x16x32_bf16 v[136:139], a[68:71], a[116:119], v[136:139]
    s_add_u32 s43, s40, 196608
    s_add_u32 s46, s40, 393216
    v_mfma_f32_16x16x32_bf16 v[76:79], a[60:63], a[120:123], v[76:79]
    ds_read_b64_tr_b16 a[116:117], v12 offset:49152
    ds_read_b64_tr_b16 a[118:119], v12 offset:53248
    v_mfma_f32_16x16x32_bf16 v[108:111], a[64:67], a[120:123], v[108:111]
    buffer_load_dwordx4 a[4:7], v9, s[12:15], s31 offen offset:1024
    v_mfma_f32_16x16x32_bf16 v[140:143], a[68:71], a[120:123], v[140:143]
    s_add_u32 s38, s35, 1
    s_waitcnt lgkmcnt(6)
    v_mfma_f32_16x16x32_bf16 v[80:83], a[60:63], a[124:127], v[80:83]
    ds_read_b64_tr_b16 a[120:121], v13 offset:49152
    ds_read_b64_tr_b16 a[122:123], v13 offset:53248
    v_mfma_f32_16x16x32_bf16 v[112:115], a[64:67], a[124:127], v[112:115]
    s_lshr_b32 s39, s38, 2
    s_lshl_b32 s39, s39, 12
    v_mfma_f32_16x16x32_bf16 v[144:147], a[68:71], a[124:127], v[144:147]
    buffer_load_dwordx4 a[8:11], v9, s[12:15], s31 offen offset:2048
    v_mfma_f32_16x16x32_bf16 v[84:87], a[60:63], a[128:131], v[84:87]
    ds_read_b64_tr_b16 a[124:125], v14 offset:49152
    ds_read_b64_tr_b16 a[126:127], v14 offset:53248
    v_mfma_f32_16x16x32_bf16 v[116:119], a[64:67], a[128:131], v[116:119]
    s_add_u32 s31, s31, 3072
    s_and_b32 s38, s38, 3
    v_mfma_f32_16x16x32_bf16 v[148:151], a[68:71], a[128:131], v[148:151]
    s_lshl_b32 s38, s38, 8
    s_add_u32 s39, s39, s38
    v_mfma_f32_16x16x32_bf16 v[88:91], a[60:63], a[132:135], v[88:91]
    ds_read_b64_tr_b16 a[128:129], v15 offset:49152
    ds_read_b64_tr_b16 a[130:131], v15 offset:53248
    v_mfma_f32_16x16x32_bf16 v[120:123], a[64:67], a[132:135], v[120:123]
    buffer_load_dwordx4 v[36:39], v25, s[20:23], s51 offen offset:0
    v_mfma_f32_16x16x32_bf16 v[152:155], a[68:71], a[132:135], v[152:155]
    s_add_u32 s41, s39, s37
    s_add_u32 s44, s41, 196608
    v_mfma_f32_16x16x32_bf16 v[92:95], a[60:63], a[136:139], v[92:95]
    ds_read_b64_tr_b16 a[132:133], v16 offset:49152
    ds_read_b64_tr_b16 a[134:135], v16 offset:53248
    v_mfma_f32_16x16x32_bf16 v[124:127], a[64:67], a[136:139], v[124:127]
    s_add_u32 s47, s41, 393216
    s_add_u32 s38, s35, 2
    v_mfma_f32_16x16x32_bf16 v[156:159], a[68:71], a[136:139], v[156:159]
    s_lshr_b32 s39, s38, 2
    s_waitcnt lgkmcnt(6)
    v_mfma_f32_16x16x32_bf16 v[64:67], a[72:75], a[108:111], v[64:67]
    ds_read_b64_tr_b16 a[136:137], v17 offset:49152
    ds_read_b64_tr_b16 a[138:139], v17 offset:53248
    v_mfma_f32_16x16x32_bf16 v[96:99], a[76:79], a[108:111], v[96:99]
    s_mov_b32 m0, s33
    s_add_u32 s33, s33, 8192
    v_mfma_f32_16x16x32_bf16 v[128:131], a[80:83], a[108:111], v[128:131]
    buffer_load_dwordx4 v3, s[8:11], s32 offen lds
    v_mfma_f32_16x16x32_bf16 a[140:143], a[156:159], a[108:111], a[140:143]
    s_lshl_b32 s39, s39, 12
    s_and_b32 s38, s38, 3
    v_mfma_f32_16x16x32_bf16 a[148:151], a[108:111], a[108:111], a[148:151]
    buffer_load_dwordx4 v4, s[8:11], s32 offen offset:1024 lds
    v_mfma_f32_16x16x32_bf16 v[68:71], a[72:75], a[112:115], v[68:71]
    ds_read_b64_tr_b16 a[108:109], v10 offset:57344
    ds_read_b64_tr_b16 a[110:111], v10 offset:61440
    v_mfma_f32_16x16x32_bf16 v[100:103], a[76:79], a[112:115], v[100:103]
    v_add_u32 v10, 0x10000, v10
    s_add_u32 s32, s32, 8192
    v_mfma_f32_16x16x32_bf16 v[132:135], a[80:83], a[112:115], v[132:135]
    s_lshl_b32 s38, s38, 8
    s_add_u32 s39, s39, s38
    v_mfma_f32_16x16x32_bf16 a[144:147], a[156:159], a[112:115], a[144:147]
    s_add_u32 s42, s39, s37
    s_add_u32 s45, s42, 196608
    v_mfma_f32_16x16x32_bf16 a[152:155], a[112:115], a[112:115], a[152:155]
    buffer_load_dwordx4 a[12:15], v9, s[12:15], s31 offen offset:0
    v_mfma_f32_16x16x32_bf16 v[72:75], a[72:75], a[116:119], v[72:75]
    ds_read_b64_tr_b16 a[112:113], v11 offset:57344
    ds_read_b64_tr_b16 a[114:115], v11 offset:61440
    v_mfma_f32_16x16x32_bf16 v[104:107], a[76:79], a[116:119], v[104:107]
    v_add_u32 v11, 0x10000, v11
    s_add_u32 s48, s42, 393216
    v_mfma_f32_16x16x32_bf16 v[136:139], a[80:83], a[116:119], v[136:139]
    s_lshl_b32 s58, s29, 9
    s_lshl_b32 s39, s28, 7
    v_mfma_f32_16x16x32_bf16 v[76:79], a[72:75], a[120:123], v[76:79]
    ds_read_b64_tr_b16 a[116:117], v12 offset:57344
    ds_read_b64_tr_b16 a[118:119], v12 offset:61440
    v_mfma_f32_16x16x32_bf16 v[108:111], a[76:79], a[120:123], v[108:111]
    v_add_u32 v12, 0x10000, v12
    s_add_u32 s58, s58, s39
    v_mfma_f32_16x16x32_bf16 v[140:143], a[80:83], a[120:123], v[140:143]
    s_lshl_b32 s39, s30, 11
    s_waitcnt lgkmcnt(6)
    v_mfma_f32_16x16x32_bf16 v[80:83], a[72:75], a[124:127], v[80:83]
    ds_read_b64_tr_b16 a[120:121], v13 offset:57344
    ds_read_b64_tr_b16 a[122:123], v13 offset:61440
    v_mfma_f32_16x16x32_bf16 v[112:115], a[76:79], a[124:127], v[112:115]
    v_add_u32 v13, 0x10000, v13
    s_add_u32 s58, s58, s39
    v_mfma_f32_16x16x32_bf16 v[144:147], a[80:83], a[124:127], v[144:147]
    buffer_load_dwordx4 a[16:19], v9, s[12:15], s31 offen offset:1024
    v_mfma_f32_16x16x32_bf16 v[84:87], a[72:75], a[128:131], v[84:87]
    ds_read_b64_tr_b16 a[124:125], v14 offset:57344
    ds_read_b64_tr_b16 a[126:127], v14 offset:61440
    v_mfma_f32_16x16x32_bf16 v[116:119], a[76:79], a[128:131], v[116:119]
    v_add_u32 v14, 0x10000, v14
    s_and_b32 s39, s30, 3
    v_mfma_f32_16x16x32_bf16 v[148:151], a[80:83], a[128:131], v[148:151]
    buffer_load_dwordx4 a[20:23], v9, s[12:15], s31 offen offset:2048
    v_mfma_f32_16x16x32_bf16 v[88:91], a[72:75], a[132:135], v[88:91]
    ds_read_b64_tr_b16 a[128:129], v15 offset:57344
    ds_read_b64_tr_b16 a[130:131], v15 offset:61440
    v_mfma_f32_16x16x32_bf16 v[120:123], a[76:79], a[132:135], v[120:123]
    v_add_u32 v15, 0x10000, v15
    s_add_u32 s31, s31, 3072
    v_mfma_f32_16x16x32_bf16 v[152:155], a[80:83], a[132:135], v[152:155]
    buffer_load_dwordx4 v[40:43], v25, s[20:23], s51 offen offset:64
    v_mfma_f32_16x16x32_bf16 v[92:95], a[72:75], a[136:139], v[92:95]
    ds_read_b64_tr_b16 a[132:133], v16 offset:57344
    ds_read_b64_tr_b16 a[134:135], v16 offset:61440
    v_mfma_f32_16x16x32_bf16 v[124:127], a[76:79], a[136:139], v[124:127]
    v_add_u32 v16, 0x10000, v16
    v_mfma_f32_16x16x32_bf16 v[156:159], a[80:83], a[136:139], v[156:159]
    s_waitcnt lgkmcnt(6)
    s_waitcnt vmcnt(17)
    v_mfma_f32_16x16x32_bf16 v[64:67], a[84:87], a[108:111], v[64:67]
    ds_read_b64_tr_b16 a[136:137], v17 offset:57344
    ds_read_b64_tr_b16 a[138:139], v17 offset:61440
    v_mfma_f32_16x16x32_bf16 v[96:99], a[88:91], a[108:111], v[96:99]
    v_add_u32 v17, 0x10000, v17
    s_mov_b32 m0, s33
    v_mfma_f32_16x16x32_bf16 v[128:131], a[92:95], a[108:111], v[128:131]
    s_add_u32 s33, s33, 8192
    v_mfma_f32_16x16x32_bf16 a[140:143], a[156:159], a[108:111], a[140:143]
    buffer_load_dwordx4 v3, s[8:11], s32 offen lds
    v_mfma_f32_16x16x32_bf16 a[148:151], a[108:111], a[108:111], a[148:151]
    buffer_load_dwordx4 v4, s[8:11], s32 offen offset:1024 lds
    v_mfma_f32_16x16x32_bf16 v[68:71], a[84:87], a[112:115], v[68:71]
    s_waitcnt vmcnt(12)
    s_barrier
    v_mfma_f32_16x16x32_bf16 v[100:103], a[88:91], a[112:115], v[100:103]
    ds_read_b64_tr_b16 a[108:109], v10 offset:0
    ds_read_b64_tr_b16 a[110:111], v10 offset:4096
    v_mfma_f32_16x16x32_bf16 v[132:135], a[92:95], a[112:115], v[132:135]
    s_add_u32 s32, s32, 8192
    v_mfma_f32_16x16x32_bf16 a[144:147], a[156:159], a[112:115], a[144:147]
    s_cmp_eq_u32 s39, 0
    s_cselect_b32 s58, s58, 32768
    v_mfma_f32_16x16x32_bf16 a[152:155], a[112:115], a[112:115], a[152:155]
    buffer_load_dwordx4 a[24:27], v9, s[12:15], s31 offen offset:0
    v_mfma_f32_16x16x32_bf16 v[72:75], a[84:87], a[116:119], v[72:75]
    ds_read_b64_tr_b16 a[112:113], v11 offset:0
    ds_read_b64_tr_b16 a[114:115], v11 offset:4096
    v_mfma_f32_16x16x32_bf16 v[104:107], a[88:91], a[116:119], v[104:107]
    s_mul_i32 s49, s29, 768
    s_lshl_b32 s39, s34, 2
    v_mfma_f32_16x16x32_bf16 v[136:139], a[92:95], a[116:119], v[136:139]
    s_add_u32 s49, s49, s39
    s_bfe_u32 s74, s2, 0x20001
    v_mfma_f32_16x16x32_bf16 v[76:79], a[84:87], a[120:123], v[76:79]
    ds_read_b64_tr_b16 a[116:117], v12 offset:0
    ds_read_b64_tr_b16 a[118:119], v12 offset:4096
    v_mfma_f32_16x16x32_bf16 v[108:111], a[88:91], a[120:123], v[108:111]
    buffer_load_dwordx4 a[28:31], v9, s[12:15], s31 offen offset:1024
    v_mfma_f32_16x16x32_bf16 v[140:143], a[92:95], a[120:123], v[140:143]
    s_and_b32 s72, s2, 1
    s_waitcnt lgkmcnt(6)
    v_mfma_f32_16x16x32_bf16 v[80:83], a[84:87], a[124:127], v[80:83]
    ds_read_b64_tr_b16 a[120:121], v13 offset:0
    ds_read_b64_tr_b16 a[122:123], v13 offset:4096
    v_mfma_f32_16x16x32_bf16 v[112:115], a[88:91], a[124:127], v[112:115]
    s_lshl_b32 s72, s72, 2
    s_bfe_u32 s39, s2, 0x20003
    v_mfma_f32_16x16x32_bf16 v[144:147], a[92:95], a[124:127], v[144:147]
    buffer_load_dwordx4 a[32:35], v9, s[12:15], s31 offen offset:2048
    v_mfma_f32_16x16x32_bf16 v[84:87], a[84:87], a[128:131], v[84:87]
    ds_read_b64_tr_b16 a[124:125], v14 offset:0
    ds_read_b64_tr_b16 a[126:127], v14 offset:4096
    v_mfma_f32_16x16x32_bf16 v[116:119], a[88:91], a[128:131], v[116:119]
    s_add_u32 s31, s31, 3072
    s_add_u32 s72, s72, s39
    v_mfma_f32_16x16x32_bf16 v[148:151], a[92:95], a[128:131], v[148:151]
    s_lshl_b32 s72, s72, 2
    s_add_u32 s72, s72, s28
    v_mfma_f32_16x16x32_bf16 v[88:91], a[84:87], a[132:135], v[88:91]
    ds_read_b64_tr_b16 a[128:129], v15 offset:0
    ds_read_b64_tr_b16 a[130:131], v15 offset:4096
    v_mfma_f32_16x16x32_bf16 v[120:123], a[88:91], a[132:135], v[120:123]
    buffer_load_dwordx4 v[44:47], v25, s[20:23], s51 offen offset:128
    v_mfma_f32_16x16x32_bf16 v[152:155], a[92:95], a[132:135], v[152:155]
    s_add_u32 s51, s51, 12288
    s_lshr_b32 s73, s2, 5
    v_mfma_f32_16x16x32_bf16 v[92:95], a[84:87], a[136:139], v[92:95]
    ds_read_b64_tr_b16 a[132:133], v16 offset:0
    ds_read_b64_tr_b16 a[134:135], v16 offset:4096
    v_mfma_f32_16x16x32_bf16 v[124:127], a[88:91], a[136:139], v[124:127]
    s_lshr_b32 s50, s72, 1
    s_mul_i32 s50, s50, 768
    v_mfma_f32_16x16x32_bf16 v[156:159], a[92:95], a[136:139], v[156:159]
    s_lshl_b32 s39, s74, 6
    s_waitcnt lgkmcnt(6)
    v_mfma_f32_16x16x32_bf16 v[64:67], a[96:99], a[108:111], v[64:67]
    ds_read_b64_tr_b16 a[136:137], v17 offset:0
    ds_read_b64_tr_b16 a[138:139], v17 offset:4096
    v_mfma_f32_16x16x32_bf16 v[96:99], a[100:103], a[108:111], v[96:99]
    s_mov_b32 m0, s33
    s_add_u32 s33, s33, 8192
    v_mfma_f32_16x16x32_bf16 v[128:131], a[104:107], a[108:111], v[128:131]
    buffer_load_dwordx4 v3, s[8:11], s32 offen lds
    v_mfma_f32_16x16x32_bf16 a[140:143], a[156:159], a[108:111], a[140:143]
    s_add_u32 s50, s50, s39
    s_mul_i32 s97, s72, 589824
    v_mfma_f32_16x16x32_bf16 a[148:151], a[108:111], a[108:111], a[148:151]
    s_mul_i32 s39, s74, 49152
    s_add_u32 s97, s97, s39
    v_mfma_f32_16x16x32_bf16 v[68:71], a[96:99], a[112:115], v[68:71]
    ds_read_b64_tr_b16 a[108:109], v10 offset:8192
    ds_read_b64_tr_b16 a[110:111], v10 offset:12288
    v_mfma_f32_16x16x32_bf16 v[100:103], a[100:103], a[112:115], v[100:103]
    buffer_load_dwordx4 v4, s[8:11], s32 offen offset:1024 lds
    v_mfma_f32_16x16x32_bf16 v[132:135], a[104:107], a[112:115], v[132:135]
    s_add_u32 s32, s32, 8192
    s_add_u32 s98, s97, 4096
    v_mfma_f32_16x16x32_bf16 a[144:147], a[156:159], a[112:115], a[144:147]
    s_add_u32 s100, s97, 40960
    s_add_u32 s101, s100, 4096
    v_mfma_f32_16x16x32_bf16 a[152:155], a[112:115], a[112:115], a[152:155]
    s_lshl_b32 s99, s73, 2
    s_add_u32 s99, s99, s74
    v_mfma_f32_16x16x32_bf16 v[72:75], a[96:99], a[116:119], v[72:75]
    ds_read_b64_tr_b16 a[112:113], v11 offset:8192
    ds_read_b64_tr_b16 a[114:115], v11 offset:12288
    v_mfma_f32_16x16x32_bf16 v[104:107], a[100:103], a[116:119], v[104:107]
    buffer_load_dwordx4 a[36:39], v9, s[12:15], s31 offen offset:0
    v_mfma_f32_16x16x32_bf16 v[136:139], a[104:107], a[116:119], v[136:139]
    s_mul_i32 s99, s99, 165888
    s_lshl_b32 s75, s28, 12
    v_mfma_f32_16x16x32_bf16 v[76:79], a[96:99], a[120:123], v[76:79]
    ds_read_b64_tr_b16 a[116:117], v12 offset:8192
    ds_read_b64_tr_b16 a[118:119], v12 offset:12288
    v_mfma_f32_16x16x32_bf16 v[108:111], a[100:103], a[120:123], v[108:111]
    s_add_u32 s99, s99, s75
    s_lshl_b32 s35, s72, 3
    v_mfma_f32_16x16x32_bf16 v[140:143], a[104:107], a[120:123], v[140:143]
    s_add_u32 s35, s35, s73
    s_waitcnt lgkmcnt(6)
    v_mfma_f32_16x16x32_bf16 v[80:83], a[96:99], a[124:127], v[80:83]
    ds_read_b64_tr_b16 a[120:121], v13 offset:8192
    ds_read_b64_tr_b16 a[122:123], v13 offset:12288
    v_mfma_f32_16x16x32_bf16 v[112:115], a[100:103], a[124:127], v[112:115]
    buffer_load_dwordx4 a[40:43], v9, s[12:15], s31 offen offset:1024
    v_mfma_f32_16x16x32_bf16 v[144:147], a[104:107], a[124:127], v[144:147]
    s_lshl_b32 s36, s35, 7
    s_lshl_b32 s39, s74, 2
    v_mfma_f32_16x16x32_bf16 v[84:87], a[96:99], a[128:131], v[84:87]
    ds_read_b64_tr_b16 a[124:125], v14 offset:8192
    ds_read_b64_tr_b16 a[126:127], v14 offset:12288
    v_mfma_f32_16x16x32_bf16 v[116:119], a[100:103], a[128:131], v[116:119]
    s_add_u32 s36, s36, s39
    s_add_u32 s36, s36, 12288
    v_mfma_f32_16x16x32_bf16 v[148:151], a[104:107], a[128:131], v[148:151]
    s_lshl_b32 s34, s35, 2
    s_add_u32 s34, s34, s74
    v_mfma_f32_16x16x32_bf16 v[88:91], a[96:99], a[132:135], v[88:91]
    ds_read_b64_tr_b16 a[128:129], v15 offset:8192
    ds_read_b64_tr_b16 a[130:131], v15 offset:12288
    v_mfma_f32_16x16x32_bf16 v[120:123], a[100:103], a[132:135], v[120:123]
    buffer_load_dwordx4 a[44:47], v9, s[12:15], s31 offen offset:2048
    v_mfma_f32_16x16x32_bf16 v[152:155], a[104:107], a[132:135], v[152:155]
    s_add_u32 s31, s31, 3072
    s_lshl_b32 s34, s34, 13
    v_mfma_f32_16x16x32_bf16 v[92:95], a[96:99], a[136:139], v[92:95]
    ds_read_b64_tr_b16 a[132:133], v16 offset:8192
    ds_read_b64_tr_b16 a[134:135], v16 offset:12288
    v_mfma_f32_16x16x32_bf16 v[124:127], a[100:103], a[136:139], v[124:127]
    s_add_u32 s34, s34, 20971520
    s_add_u32 s35, s34, 4096
    v_mfma_f32_16x16x32_bf16 v[156:159], a[104:107], a[136:139], v[156:159]
    s_waitcnt lgkmcnt(6)
    s_waitcnt vmcnt(18)
    v_mfma_f32_16x16x32_bf16 v[64:67], a[0:3], a[108:111], v[64:67]
    ds_read_b64_tr_b16 a[136:137], v17 offset:8192
    ds_read_b64_tr_b16 a[138:139], v17 offset:12288
    v_mfma_f32_16x16x32_bf16 v[96:99], a[4:7], a[108:111], v[96:99]
    s_mov_b32 m0, s33
    s_add_u32 s33, s33, 8192
    v_mfma_f32_16x16x32_bf16 v[128:131], a[8:11], a[108:111], v[128:131]
    buffer_load_dwordx4 v3, s[8:11], s32 offen lds
    v_mfma_f32_16x16x32_bf16 a[140:143], a[156:159], a[108:111], a[140:143]
    v_accvgpr_write_b32 a252, -1
    v_accvgpr_write_b32 a253, -1
    v_mfma_f32_16x16x32_bf16 a[148:151], a[108:111], a[108:111], a[148:151]
    v_accvgpr_write_b32 a254, -1
    v_accvgpr_write_b32 a255, -1
    v_mfma_f32_16x16x32_bf16 v[68:71], a[0:3], a[112:115], v[68:71]
    s_waitcnt vmcnt(10)
    s_barrier
    v_mfma_f32_16x16x32_bf16 v[100:103], a[4:7], a[112:115], v[100:103]
    ds_read_b64_tr_b16 a[108:109], v10 offset:16384
    ds_read_b64_tr_b16 a[110:111], v10 offset:20480
    v_mfma_f32_16x16x32_bf16 v[132:135], a[8:11], a[112:115], v[132:135]
    buffer_load_dwordx4 v4, s[8:11], s32 offen offset:1024 lds
    v_mfma_f32_16x16x32_bf16 a[144:147], a[156:159], a[112:115], a[144:147]
    s_add_u32 s32, s32, 8192
    s_add_u32 s39, s74, 0
    v_mfma_f32_16x16x32_bf16 a[152:155], a[112:115], a[112:115], a[152:155]
    s_and_b32 s39, s39, 3
    s_lshl_b32 s39, s39, 10
    v_mfma_f32_16x16x32_bf16 v[72:75], a[0:3], a[116:119], v[72:75]
    ds_read_b64_tr_b16 a[112:113], v11 offset:16384
    ds_read_b64_tr_b16 a[114:115], v11 offset:20480
    v_mfma_f32_16x16x32_bf16 v[104:107], a[4:7], a[116:119], v[104:107]
    buffer_load_dwordx4 a[48:51], v9, s[12:15], s31 offen offset:0
    v_mfma_f32_16x16x32_bf16 v[136:139], a[8:11], a[116:119], v[136:139]
    v_add_u32 v1, s39, v9
    s_add_u32 s39, s74, 1
    v_mfma_f32_16x16x32_bf16 v[76:79], a[0:3], a[120:123], v[76:79]
    ds_read_b64_tr_b16 a[116:117], v12 offset:16384
    ds_read_b64_tr_b16 a[118:119], v12 offset:20480
    v_mfma_f32_16x16x32_bf16 v[108:111], a[4:7], a[120:123], v[108:111]
    s_and_b32 s39, s39, 3
    s_lshl_b32 s39, s39, 10
    v_mfma_f32_16x16x32_bf16 v[140:143], a[8:11], a[120:123], v[140:143]
    v_add_u32 v24, s39, v9
    s_waitcnt lgkmcnt(6)
    v_mfma_f32_16x16x32_bf16 v[80:83], a[0:3], a[124:127], v[80:83]
    ds_read_b64_tr_b16 a[120:121], v13 offset:16384
    ds_read_b64_tr_b16 a[122:123], v13 offset:20480
    v_mfma_f32_16x16x32_bf16 v[112:115], a[4:7], a[124:127], v[112:115]
    buffer_load_dwordx4 a[52:55], v9, s[12:15], s31 offen offset:1024
    v_mfma_f32_16x16x32_bf16 v[144:147], a[8:11], a[124:127], v[144:147]
    s_add_u32 s39, s74, 2
    s_and_b32 s39, s39, 3
    v_mfma_f32_16x16x32_bf16 v[84:87], a[0:3], a[128:131], v[84:87]
    ds_read_b64_tr_b16 a[124:125], v14 offset:16384
    ds_read_b64_tr_b16 a[126:127], v14 offset:20480
    v_mfma_f32_16x16x32_bf16 v[116:119], a[4:7], a[128:131], v[116:119]
    s_lshl_b32 s39, s39, 10
    v_add_u32 v27, s39, v9
    v_mfma_f32_16x16x32_bf16 v[148:151], a[8:11], a[128:131], v[148:151]
    s_add_u32 s39, s74, 3
    s_and_b32 s39, s39, 3
    v_mfma_f32_16x16x32_bf16 v[88:91], a[0:3], a[132:135], v[88:91]
    ds_read_b64_tr_b16 a[128:129], v15 offset:16384
    ds_read_b64_tr_b16 a[130:131], v15 offset:20480
    v_mfma_f32_16x16x32_bf16 v[120:123], a[4:7], a[132:135], v[120:123]
    buffer_load_dwordx4 a[56:59], v9, s[12:15], s31 offen offset:2048
    v_mfma_f32_16x16x32_bf16 v[152:155], a[8:11], a[132:135], v[152:155]
    s_add_u32 s31, s31, 3072
    s_lshl_b32 s59, s39, 10
    v_mfma_f32_16x16x32_bf16 v[92:95], a[0:3], a[136:139], v[92:95]
    ds_read_b64_tr_b16 a[132:133], v16 offset:16384
    ds_read_b64_tr_b16 a[134:135], v16 offset:20480
    v_mfma_f32_16x16x32_bf16 v[124:127], a[4:7], a[136:139], v[124:127]
    v_and_b32 v5, 3, v2
    v_cmp_eq_u32 s[52:53], 1, v5
    v_mfma_f32_16x16x32_bf16 v[156:159], a[8:11], a[136:139], v[156:159]
    v_cmp_eq_u32 s[54:55], 2, v5
    s_waitcnt lgkmcnt(6)
    v_mfma_f32_16x16x32_bf16 v[64:67], a[12:15], a[108:111], v[64:67]
    ds_read_b64_tr_b16 a[136:137], v17 offset:16384
    ds_read_b64_tr_b16 a[138:139], v17 offset:20480
    v_mfma_f32_16x16x32_bf16 v[96:99], a[16:19], a[108:111], v[96:99]
    s_mov_b32 m0, s33
    s_add_u32 s33, s33, 8192
    v_mfma_f32_16x16x32_bf16 v[128:131], a[20:23], a[108:111], v[128:131]
    buffer_load_dwordx4 v3, s[8:11], s32 offen lds
    v_mfma_f32_16x16x32_bf16 a[140:143], a[156:159], a[108:111], a[140:143]
    v_cmp_eq_u32 s[56:57], 3, v5
    v_bfe_u32 v5, v2, 2, 2
    v_mfma_f32_16x16x32_bf16 a[148:151], a[108:111], a[108:111], a[148:151]
    v_lshrrev_b32 v6, 4, v2
    v_cmp_eq_u32 vcc, v5, v6
    v_mfma_f32_16x16x32_bf16 v[68:71], a[12:15], a[112:115], v[68:71]
    ds_read_b64_tr_b16 a[108:109], v10 offset:24576
    ds_read_b64_tr_b16 a[110:111], v10 offset:28672
    v_mfma_f32_16x16x32_bf16 v[100:103], a[16:19], a[112:115], v[100:103]
    buffer_load_dwordx4 v4, s[8:11], s32 offen offset:1024 lds
    v_mfma_f32_16x16x32_bf16 v[132:135], a[20:23], a[112:115], v[132:135]
    s_add_u32 s32, s32, 8192
    v_and_b32 v5, 15, v2
    v_mfma_f32_16x16x32_bf16 a[144:147], a[156:159], a[112:115], a[144:147]
    v_lshlrev_b32 v5, 2, v5
    v_mov_b32 v6, 0x10000
    v_mfma_f32_16x16x32_bf16 a[152:155], a[112:115], a[112:115], a[152:155]
    v_cndmask_b32 v5, v6, v5, vcc
    v_mfma_f32_16x16x32_bf16 v[72:75], a[12:15], a[116:119], v[72:75]
    ds_read_b64_tr_b16 a[112:113], v11 offset:24576
    ds_read_b64_tr_b16 a[114:115], v11 offset:28672
    v_mfma_f32_16x16x32_bf16 v[104:107], a[16:19], a[116:119], v[104:107]
    buffer_load_dwordx4 a[60:63], v9, s[12:15], s31 offen offset:0
    v_mfma_f32_16x16x32_bf16 v[136:139], a[20:23], a[116:119], v[136:139]
    v_mfma_f32_16x16x32_bf16 v[76:79], a[12:15], a[120:123], v[76:79]
    ds_read_b64_tr_b16 a[116:117], v12 offset:24576
    ds_read_b64_tr_b16 a[118:119], v12 offset:28672
    v_mfma_f32_16x16x32_bf16 v[108:111], a[16:19], a[120:123], v[108:111]
    v_mfma_f32_16x16x32_bf16 v[140:143], a[20:23], a[120:123], v[140:143]
    s_waitcnt lgkmcnt(6)
    v_mfma_f32_16x16x32_bf16 v[80:83], a[12:15], a[124:127], v[80:83]
    ds_read_b64_tr_b16 a[120:121], v13 offset:24576
    ds_read_b64_tr_b16 a[122:123], v13 offset:28672
    v_mfma_f32_16x16x32_bf16 v[112:115], a[16:19], a[124:127], v[112:115]
    buffer_load_dwordx4 a[64:67], v9, s[12:15], s31 offen offset:1024
    v_mfma_f32_16x16x32_bf16 v[144:147], a[20:23], a[124:127], v[144:147]
    v_mfma_f32_16x16x32_bf16 v[84:87], a[12:15], a[128:131], v[84:87]
    ds_read_b64_tr_b16 a[124:125], v14 offset:24576
    ds_read_b64_tr_b16 a[126:127], v14 offset:28672
    v_mfma_f32_16x16x32_bf16 v[116:119], a[16:19], a[128:131], v[116:119]
    v_mfma_f32_16x16x32_bf16 v[148:151], a[20:23], a[128:131], v[148:151]
    v_mfma_f32_16x16x32_bf16 v[88:91], a[12:15], a[132:135], v[88:91]
    ds_read_b64_tr_b16 a[128:129], v15 offset:24576
    ds_read_b64_tr_b16 a[130:131], v15 offset:28672
    v_mfma_f32_16x16x32_bf16 v[120:123], a[16:19], a[132:135], v[120:123]
    buffer_load_dwordx4 a[68:71], v9, s[12:15], s31 offen offset:2048
    v_mfma_f32_16x16x32_bf16 v[152:155], a[20:23], a[132:135], v[152:155]
    s_add_u32 s31, s31, 3072
    v_mfma_f32_16x16x32_bf16 v[92:95], a[12:15], a[136:139], v[92:95]
    ds_read_b64_tr_b16 a[132:133], v16 offset:24576
    ds_read_b64_tr_b16 a[134:135], v16 offset:28672
    v_mfma_f32_16x16x32_bf16 v[124:127], a[16:19], a[136:139], v[124:127]
    v_mfma_f32_16x16x32_bf16 v[156:159], a[20:23], a[136:139], v[156:159]
    s_waitcnt lgkmcnt(6)
    s_waitcnt vmcnt(16)
    v_mfma_f32_16x16x32_bf16 v[64:67], a[24:27], a[108:111], v[64:67]
    ds_read_b64_tr_b16 a[136:137], v17 offset:24576
    ds_read_b64_tr_b16 a[138:139], v17 offset:28672
    v_mfma_f32_16x16x32_bf16 v[96:99], a[28:31], a[108:111], v[96:99]
    s_mov_b32 m0, s33
    s_add_u32 s33, s33, 8192
    v_mfma_f32_16x16x32_bf16 v[128:131], a[32:35], a[108:111], v[128:131]
    buffer_load_dwordx4 v3, s[8:11], s32 offen lds
    v_mfma_f32_16x16x32_bf16 a[140:143], a[156:159], a[108:111], a[140:143]
    v_mfma_f32_16x16x32_bf16 a[148:151], a[108:111], a[108:111], a[148:151]
    v_mfma_f32_16x16x32_bf16 v[68:71], a[24:27], a[112:115], v[68:71]
    s_waitcnt vmcnt(9)
    s_barrier
    v_mfma_f32_16x16x32_bf16 v[100:103], a[28:31], a[112:115], v[100:103]
    ds_read_b64_tr_b16 a[108:109], v10 offset:32768
    ds_read_b64_tr_b16 a[110:111], v10 offset:36864
    v_mfma_f32_16x16x32_bf16 v[132:135], a[32:35], a[112:115], v[132:135]
    buffer_load_dwordx4 v4, s[8:11], s32 offen offset:1024 lds
    v_mfma_f32_16x16x32_bf16 a[144:147], a[156:159], a[112:115], a[144:147]
    s_add_u32 s32, s32, 8192
    v_mfma_f32_16x16x32_bf16 a[152:155], a[112:115], a[112:115], a[152:155]
    v_mfma_f32_16x16x32_bf16 v[72:75], a[24:27], a[116:119], v[72:75]
    ds_read_b64_tr_b16 a[112:113], v11 offset:32768
    ds_read_b64_tr_b16 a[114:115], v11 offset:36864
    v_mfma_f32_16x16x32_bf16 v[104:107], a[28:31], a[116:119], v[104:107]
    buffer_load_dwordx4 a[72:75], v9, s[12:15], s31 offen offset:0
    v_mfma_f32_16x16x32_bf16 v[136:139], a[32:35], a[116:119], v[136:139]
    v_mfma_f32_16x16x32_bf16 v[76:79], a[24:27], a[120:123], v[76:79]
    ds_read_b64_tr_b16 a[116:117], v12 offset:32768
    ds_read_b64_tr_b16 a[118:119], v12 offset:36864
    v_mfma_f32_16x16x32_bf16 v[108:111], a[28:31], a[120:123], v[108:111]
    v_mfma_f32_16x16x32_bf16 v[140:143], a[32:35], a[120:123], v[140:143]
    s_waitcnt lgkmcnt(6)
    v_mfma_f32_16x16x32_bf16 v[80:83], a[24:27], a[124:127], v[80:83]
    ds_read_b64_tr_b16 a[120:121], v13 offset:32768
    ds_read_b64_tr_b16 a[122:123], v13 offset:36864
    v_mfma_f32_16x16x32_bf16 v[112:115], a[28:31], a[124:127], v[112:115]
    buffer_load_dwordx4 a[76:79], v9, s[12:15], s31 offen offset:1024
    v_mfma_f32_16x16x32_bf16 v[144:147], a[32:35], a[124:127], v[144:147]
    v_mfma_f32_16x16x32_bf16 v[84:87], a[24:27], a[128:131], v[84:87]
    ds_read_b64_tr_b16 a[124:125], v14 offset:32768
    ds_read_b64_tr_b16 a[126:127], v14 offset:36864
    v_mfma_f32_16x16x32_bf16 v[116:119], a[28:31], a[128:131], v[116:119]
    v_mfma_f32_16x16x32_bf16 v[148:151], a[32:35], a[128:131], v[148:151]
    v_mfma_f32_16x16x32_bf16 v[88:91], a[24:27], a[132:135], v[88:91]
    ds_read_b64_tr_b16 a[128:129], v15 offset:32768
    ds_read_b64_tr_b16 a[130:131], v15 offset:36864
    v_mfma_f32_16x16x32_bf16 v[120:123], a[28:31], a[132:135], v[120:123]
    buffer_load_dwordx4 a[80:83], v9, s[12:15], s31 offen offset:2048
    v_mfma_f32_16x16x32_bf16 v[152:155], a[32:35], a[132:135], v[152:155]
    s_add_u32 s31, s31, 3072
    v_mfma_f32_16x16x32_bf16 v[92:95], a[24:27], a[136:139], v[92:95]
    ds_read_b64_tr_b16 a[132:133], v16 offset:32768
    ds_read_b64_tr_b16 a[134:135], v16 offset:36864
    v_mfma_f32_16x16x32_bf16 v[124:127], a[28:31], a[136:139], v[124:127]
    v_mfma_f32_16x16x32_bf16 v[156:159], a[32:35], a[136:139], v[156:159]
    s_waitcnt lgkmcnt(6)
    v_mfma_f32_16x16x32_bf16 v[64:67], a[36:39], a[108:111], v[64:67]
    ds_read_b64_tr_b16 a[136:137], v17 offset:32768
    ds_read_b64_tr_b16 a[138:139], v17 offset:36864
    v_mfma_f32_16x16x32_bf16 v[96:99], a[40:43], a[108:111], v[96:99]
    s_mov_b32 m0, s33
    s_add_u32 s33, s33, 8192
    v_mfma_f32_16x16x32_bf16 v[128:131], a[44:47], a[108:111], v[128:131]
    buffer_load_dwordx4 v3, s[8:11], s32 offen lds
    v_mfma_f32_16x16x32_bf16 a[140:143], a[156:159], a[108:111], a[140:143]
    v_add_f32_dpp v36, v36, v36 quad_perm:[1,0,3,2] row_mask:0xf bank_mask:0xf
    v_add_f32_dpp v37, v37, v37 quad_perm:[1,0,3,2] row_mask:0xf bank_mask:0xf
    v_mfma_f32_16x16x32_bf16 a[148:151], a[108:111], a[108:111], a[148:151]
    v_add_f32_dpp v38, v38, v38 quad_perm:[1,0,3,2] row_mask:0xf bank_mask:0xf
    v_add_f32_dpp v39, v39, v39 quad_perm:[1,0,3,2] row_mask:0xf bank_mask:0xf
    v_mfma_f32_16x16x32_bf16 v[68:71], a[36:39], a[112:115], v[68:71]
    ds_read_b64_tr_b16 a[108:109], v10 offset:40960
    ds_read_b64_tr_b16 a[110:111], v10 offset:45056
    v_mfma_f32_16x16x32_bf16 v[100:103], a[40:43], a[112:115], v[100:103]
    buffer_load_dwordx4 v4, s[8:11], s32 offen offset:1024 lds
    v_mfma_f32_16x16x32_bf16 v[132:135], a[44:47], a[112:115], v[132:135]
    s_add_u32 s32, s32, 8192
    v_add_f32_dpp v40, v40, v40 quad_perm:[1,0,3,2] row_mask:0xf bank_mask:0xf
    v_mfma_f32_16x16x32_bf16 a[144:147], a[156:159], a[112:115], a[144:147]
    v_add_f32_dpp v41, v41, v41 quad_perm:[1,0,3,2] row_mask:0xf bank_mask:0xf
    v_add_f32_dpp v42, v42, v42 quad_perm:[1,0,3,2] row_mask:0xf bank_mask:0xf
    v_mfma_f32_16x16x32_bf16 a[152:155], a[112:115], a[112:115], a[152:155]
    v_add_f32_dpp v43, v43, v43 quad_perm:[1,0,3,2] row_mask:0xf bank_mask:0xf
    v_add_f32_dpp v44, v44, v44 quad_perm:[1,0,3,2] row_mask:0xf bank_mask:0xf
    v_mfma_f32_16x16x32_bf16 v[72:75], a[36:39], a[116:119], v[72:75]
    ds_read_b64_tr_b16 a[112:113], v11 offset:40960
    ds_read_b64_tr_b16 a[114:115], v11 offset:45056
    v_mfma_f32_16x16x32_bf16 v[104:107], a[40:43], a[116:119], v[104:107]
    buffer_load_dwordx4 a[84:87], v9, s[12:15], s31 offen offset:0
    v_mfma_f32_16x16x32_bf16 v[136:139], a[44:47], a[116:119], v[136:139]
    v_add_f32_dpp v45, v45, v45 quad_perm:[1,0,3,2] row_mask:0xf bank_mask:0xf
    v_add_f32_dpp v46, v46, v46 quad_perm:[1,0,3,2] row_mask:0xf bank_mask:0xf
    v_mfma_f32_16x16x32_bf16 v[76:79], a[36:39], a[120:123], v[76:79]
    ds_read_b64_tr_b16 a[116:117], v12 offset:40960
    ds_read_b64_tr_b16 a[118:119], v12 offset:45056
    v_mfma_f32_16x16x32_bf16 v[108:111], a[40:43], a[120:123], v[108:111]
    v_add_f32_dpp v47, v47, v47 quad_perm:[1,0,3,2] row_mask:0xf bank_mask:0xf
    v_add_f32_dpp v36, v36, v36 quad_perm:[2,3,0,1] row_mask:0xf bank_mask:0xf
    v_mfma_f32_16x16x32_bf16 v[140:143], a[44:47], a[120:123], v[140:143]
    v_add_f32_dpp v37, v37, v37 quad_perm:[2,3,0,1] row_mask:0xf bank_mask:0xf
    s_waitcnt lgkmcnt(6)
    v_mfma_f32_16x16x32_bf16 v[80:83], a[36:39], a[124:127], v[80:83]
    ds_read_b64_tr_b16 a[120:121], v13 offset:40960
    ds_read_b64_tr_b16 a[122:123], v13 offset:45056
    v_mfma_f32_16x16x32_bf16 v[112:115], a[40:43], a[124:127], v[112:115]
    buffer_load_dwordx4 a[88:91], v9, s[12:15], s31 offen offset:1024
    v_mfma_f32_16x16x32_bf16 v[144:147], a[44:47], a[124:127], v[144:147]
    v_add_f32_dpp v38, v38, v38 quad_perm:[2,3,0,1] row_mask:0xf bank_mask:0xf
    v_add_f32_dpp v39, v39, v39 quad_perm:[2,3,0,1] row_mask:0xf bank_mask:0xf
    v_mfma_f32_16x16x32_bf16 v[84:87], a[36:39], a[128:131], v[84:87]
    ds_read_b64_tr_b16 a[124:125], v14 offset:40960
    ds_read_b64_tr_b16 a[126:127], v14 offset:45056
    v_mfma_f32_16x16x32_bf16 v[116:119], a[40:43], a[128:131], v[116:119]
    v_add_f32_dpp v40, v40, v40 quad_perm:[2,3,0,1] row_mask:0xf bank_mask:0xf
    v_add_f32_dpp v41, v41, v41 quad_perm:[2,3,0,1] row_mask:0xf bank_mask:0xf
    v_mfma_f32_16x16x32_bf16 v[148:151], a[44:47], a[128:131], v[148:151]
    v_add_f32_dpp v42, v42, v42 quad_perm:[2,3,0,1] row_mask:0xf bank_mask:0xf
    v_add_f32_dpp v43, v43, v43 quad_perm:[2,3,0,1] row_mask:0xf bank_mask:0xf
    v_mfma_f32_16x16x32_bf16 v[88:91], a[36:39], a[132:135], v[88:91]
    ds_read_b64_tr_b16 a[128:129], v15 offset:40960
    ds_read_b64_tr_b16 a[130:131], v15 offset:45056
    v_mfma_f32_16x16x32_bf16 v[120:123], a[40:43], a[132:135], v[120:123]
    buffer_load_dwordx4 a[92:95], v9, s[12:15], s31 offen offset:2048
    v_mfma_f32_16x16x32_bf16 v[152:155], a[44:47], a[132:135], v[152:155]
    s_add_u32 s31, s31, 3072
    v_add_f32_dpp v44, v44, v44 quad_perm:[2,3,0,1] row_mask:0xf bank_mask:0xf
    v_mfma_f32_16x16x32_bf16 v[92:95], a[36:39], a[136:139], v[92:95]
    ds_read_b64_tr_b16 a[132:133], v16 offset:40960
    ds_read_b64_tr_b16 a[134:135], v16 offset:45056
    v_mfma_f32_16x16x32_bf16 v[124:127], a[40:43], a[136:139], v[124:127]
    v_add_f32_dpp v45, v45, v45 quad_perm:[2,3,0,1] row_mask:0xf bank_mask:0xf
    v_add_f32_dpp v46, v46, v46 quad_perm:[2,3,0,1] row_mask:0xf bank_mask:0xf
    v_mfma_f32_16x16x32_bf16 v[156:159], a[44:47], a[136:139], v[156:159]
    s_waitcnt lgkmcnt(6)
    s_waitcnt vmcnt(15)
    v_mfma_f32_16x16x32_bf16 v[64:67], a[48:51], a[108:111], v[64:67]
    ds_read_b64_tr_b16 a[136:137], v17 offset:40960
    ds_read_b64_tr_b16 a[138:139], v17 offset:45056
    v_mfma_f32_16x16x32_bf16 v[96:99], a[52:55], a[108:111], v[96:99]
    s_mov_b32 m0, s33
    s_add_u32 s33, s33, 8192
    v_mfma_f32_16x16x32_bf16 v[128:131], a[56:59], a[108:111], v[128:131]
    buffer_load_dwordx4 v3, s[8:11], s32 offen lds
    v_mfma_f32_16x16x32_bf16 a[140:143], a[156:159], a[108:111], a[140:143]
    v_add_f32_dpp v47, v47, v47 quad_perm:[2,3,0,1] row_mask:0xf bank_mask:0xf
    v_add_f32_dpp v36, v36, v36 row_half_mirror row_mask:0xf bank_mask:0xf
    v_mfma_f32_16x16x32_bf16 a[148:151], a[108:111], a[108:111], a[148:151]
    v_add_f32_dpp v37, v37, v37 row_half_mirror row_mask:0xf bank_mask:0xf
    v_add_f32_dpp v38, v38, v38 row_half_mirror row_mask:0xf bank_mask:0xf
    v_mfma_f32_16x16x32_bf16 v[68:71], a[48:51], a[112:115], v[68:71]
    s_waitcnt vmcnt(9)
    s_barrier
    v_mfma_f32_16x16x32_bf16 v[100:103], a[52:55], a[112:115], v[100:103]
    ds_read_b64_tr_b16 a[108:109], v10 offset:49152
    ds_read_b64_tr_b16 a[110:111], v10 offset:53248
    v_mfma_f32_16x16x32_bf16 v[132:135], a[56:59], a[112:115], v[132:135]
    buffer_load_dwordx4 v4, s[8:11], s32 offen offset:1024 lds
    v_mfma_f32_16x16x32_bf16 a[144:147], a[156:159], a[112:115], a[144:147]
    s_add_u32 s32, s32, 8192
    v_add_f32_dpp v39, v39, v39 row_half_mirror row_mask:0xf bank_mask:0xf
    v_mfma_f32_16x16x32_bf16 a[152:155], a[112:115], a[112:115], a[152:155]
    v_add_f32_dpp v40, v40, v40 row_half_mirror row_mask:0xf bank_mask:0xf
    v_add_f32_dpp v41, v41, v41 row_half_mirror row_mask:0xf bank_mask:0xf
    v_mfma_f32_16x16x32_bf16 v[72:75], a[48:51], a[116:119], v[72:75]
    ds_read_b64_tr_b16 a[112:113], v11 offset:49152
    ds_read_b64_tr_b16 a[114:115], v11 offset:53248
    v_mfma_f32_16x16x32_bf16 v[104:107], a[52:55], a[116:119], v[104:107]
    buffer_load_dwordx4 a[96:99], v9, s[12:15], s31 offen offset:0
    v_mfma_f32_16x16x32_bf16 v[136:139], a[56:59], a[116:119], v[136:139]
    v_add_f32_dpp v42, v42, v42 row_half_mirror row_mask:0xf bank_mask:0xf
    v_add_f32_dpp v43, v43, v43 row_half_mirror row_mask:0xf bank_mask:0xf
    v_mfma_f32_16x16x32_bf16 v[76:79], a[48:51], a[120:123], v[76:79]
    ds_read_b64_tr_b16 a[116:117], v12 offset:49152
    ds_read_b64_tr_b16 a[118:119], v12 offset:53248
    v_mfma_f32_16x16x32_bf16 v[108:111], a[52:55], a[120:123], v[108:111]
    v_add_f32_dpp v44, v44, v44 row_half_mirror row_mask:0xf bank_mask:0xf
    v_add_f32_dpp v45, v45, v45 row_half_mirror row_mask:0xf bank_mask:0xf
    v_mfma_f32_16x16x32_bf16 v[140:143], a[56:59], a[120:123], v[140:143]
    v_add_f32_dpp v46, v46, v46 row_half_mirror row_mask:0xf bank_mask:0xf
    s_waitcnt lgkmcnt(6)
    v_mfma_f32_16x16x32_bf16 v[80:83], a[48:51], a[124:127], v[80:83]
    ds_read_b64_tr_b16 a[120:121], v13 offset:49152
    ds_read_b64_tr_b16 a[122:123], v13 offset:53248
    v_mfma_f32_16x16x32_bf16 v[112:115], a[52:55], a[124:127], v[112:115]
    buffer_load_dwordx4 a[100:103], v9, s[12:15], s31 offen offset:1024
    v_mfma_f32_16x16x32_bf16 v[144:147], a[56:59], a[124:127], v[144:147]
    v_add_f32_dpp v47, v47, v47 row_half_mirror row_mask:0xf bank_mask:0xf
    v_mfma_f32_16x16x32_bf16 v[84:87], a[48:51], a[128:131], v[84:87]
    ds_read_b64_tr_b16 a[124:125], v14 offset:49152
    ds_read_b64_tr_b16 a[126:127], v14 offset:53248
    v_mfma_f32_16x16x32_bf16 v[116:119], a[52:55], a[128:131], v[116:119]
    v_mfma_f32_16x16x32_bf16 v[148:151], a[56:59], a[128:131], v[148:151]
    v_mfma_f32_16x16x32_bf16 v[88:91], a[48:51], a[132:135], v[88:91]
    ds_read_b64_tr_b16 a[128:129], v15 offset:49152
    ds_read_b64_tr_b16 a[130:131], v15 offset:53248
    v_mfma_f32_16x16x32_bf16 v[120:123], a[52:55], a[132:135], v[120:123]
    buffer_load_dwordx4 a[104:107], v9, s[12:15], s31 offen offset:2048
    v_mfma_f32_16x16x32_bf16 v[152:155], a[56:59], a[132:135], v[152:155]
    s_add_u32 s31, s31, 3486720
    v_mfma_f32_16x16x32_bf16 v[92:95], a[48:51], a[136:139], v[92:95]
    ds_read_b64_tr_b16 a[132:133], v16 offset:49152
    ds_read_b64_tr_b16 a[134:135], v16 offset:53248
    v_mfma_f32_16x16x32_bf16 v[124:127], a[52:55], a[136:139], v[124:127]
    v_mfma_f32_16x16x32_bf16 v[156:159], a[56:59], a[136:139], v[156:159]
    s_waitcnt lgkmcnt(6)
    v_mfma_f32_16x16x32_bf16 v[64:67], a[60:63], a[108:111], v[64:67]
    ds_read_b64_tr_b16 a[136:137], v17 offset:49152
    ds_read_b64_tr_b16 a[138:139], v17 offset:53248
    v_mfma_f32_16x16x32_bf16 v[96:99], a[64:67], a[108:111], v[96:99]
    buffer_load_dwordx4 a[0:3], v9, s[12:15], s31 offen offset:0
    v_mfma_f32_16x16x32_bf16 v[128:131], a[68:71], a[108:111], v[128:131]
    v_mfma_f32_16x16x32_bf16 a[140:143], a[156:159], a[108:111], a[140:143]
    v_mfma_f32_16x16x32_bf16 a[148:151], a[108:111], a[108:111], a[148:151]
    buffer_load_dwordx4 a[4:7], v9, s[12:15], s31 offen offset:1024
    v_mfma_f32_16x16x32_bf16 v[68:71], a[60:63], a[112:115], v[68:71]
    ds_read_b64_tr_b16 a[108:109], v10 offset:57344
    ds_read_b64_tr_b16 a[110:111], v10 offset:61440
    v_mfma_f32_16x16x32_bf16 v[100:103], a[64:67], a[112:115], v[100:103]
    v_add_u32 v10, 0x10000, v10
    v_mfma_f32_16x16x32_bf16 v[132:135], a[68:71], a[112:115], v[132:135]
    v_mfma_f32_16x16x32_bf16 a[144:147], a[156:159], a[112:115], a[144:147]
    v_mfma_f32_16x16x32_bf16 a[152:155], a[112:115], a[112:115], a[152:155]
    buffer_load_dwordx4 a[8:11], v9, s[12:15], s31 offen offset:2048
    v_mfma_f32_16x16x32_bf16 v[72:75], a[60:63], a[116:119], v[72:75]
    ds_read_b64_tr_b16 a[112:113], v11 offset:57344
    ds_read_b64_tr_b16 a[114:115], v11 offset:61440
    v_mfma_f32_16x16x32_bf16 v[104:107], a[64:67], a[116:119], v[104:107]
    v_add_u32 v11, 0x10000, v11
    s_add_u32 s31, s31, 3072
    v_mfma_f32_16x16x32_bf16 v[136:139], a[68:71], a[116:119], v[136:139]
    v_mfma_f32_16x16x32_bf16 v[76:79], a[60:63], a[120:123], v[76:79]
    ds_read_b64_tr_b16 a[116:117], v12 offset:57344
    ds_read_b64_tr_b16 a[118:119], v12 offset:61440
    v_mfma_f32_16x16x32_bf16 v[108:111], a[64:67], a[120:123], v[108:111]
    v_add_u32 v12, 0x10000, v12
    v_mfma_f32_16x16x32_bf16 v[140:143], a[68:71], a[120:123], v[140:143]
    s_waitcnt lgkmcnt(6)
    v_mfma_f32_16x16x32_bf16 v[80:83], a[60:63], a[124:127], v[80:83]
    ds_read_b64_tr_b16 a[120:121], v13 offset:57344
    ds_read_b64_tr_b16 a[122:123], v13 offset:61440
    v_mfma_f32_16x16x32_bf16 v[112:115], a[64:67], a[124:127], v[112:115]
    v_add_u32 v13, 0x10000, v13
    v_mfma_f32_16x16x32_bf16 v[144:147], a[68:71], a[124:127], v[144:147]
    buffer_load_dwordx4 a[12:15], v9, s[12:15], s31 offen offset:0
    v_mfma_f32_16x16x32_bf16 v[84:87], a[60:63], a[128:131], v[84:87]
    ds_read_b64_tr_b16 a[124:125], v14 offset:57344
    ds_read_b64_tr_b16 a[126:127], v14 offset:61440
    v_mfma_f32_16x16x32_bf16 v[116:119], a[64:67], a[128:131], v[116:119]
    v_add_u32 v14, 0x10000, v14
    v_mfma_f32_16x16x32_bf16 v[148:151], a[68:71], a[128:131], v[148:151]
    buffer_load_dwordx4 a[16:19], v9, s[12:15], s31 offen offset:1024
    v_mfma_f32_16x16x32_bf16 v[88:91], a[60:63], a[132:135], v[88:91]
    ds_read_b64_tr_b16 a[128:129], v15 offset:57344
    ds_read_b64_tr_b16 a[130:131], v15 offset:61440
    v_mfma_f32_16x16x32_bf16 v[120:123], a[64:67], a[132:135], v[120:123]
    v_add_u32 v15, 0x10000, v15
    v_mfma_f32_16x16x32_bf16 v[152:155], a[68:71], a[132:135], v[152:155]
    buffer_load_dwordx4 a[20:23], v9, s[12:15], s31 offen offset:2048
    v_mfma_f32_16x16x32_bf16 v[92:95], a[60:63], a[136:139], v[92:95]
    ds_read_b64_tr_b16 a[132:133], v16 offset:57344
    ds_read_b64_tr_b16 a[134:135], v16 offset:61440
    v_mfma_f32_16x16x32_bf16 v[124:127], a[64:67], a[136:139], v[124:127]
    v_add_u32 v16, 0x10000, v16
    s_add_u32 s31, s31, 3072
    v_mfma_f32_16x16x32_bf16 v[156:159], a[68:71], a[136:139], v[156:159]
    s_waitcnt lgkmcnt(6)
    s_waitcnt vmcnt(16)
    v_mfma_f32_16x16x32_bf16 v[64:67], a[72:75], a[108:111], v[64:67]
    ds_read_b64_tr_b16 a[136:137], v17 offset:57344
    ds_read_b64_tr_b16 a[138:139], v17 offset:61440
    v_mfma_f32_16x16x32_bf16 v[96:99], a[76:79], a[108:111], v[96:99]
    v_add_u32 v17, 0x10000, v17
    v_mfma_f32_16x16x32_bf16 v[128:131], a[80:83], a[108:111], v[128:131]
    buffer_load_dwordx4 a[24:27], v9, s[12:15], s31 offen offset:0
    v_mfma_f32_16x16x32_bf16 a[140:143], a[156:159], a[108:111], a[140:143]
    v_mfma_f32_16x16x32_bf16 a[148:151], a[108:111], a[108:111], a[148:151]
    buffer_load_dwordx4 a[28:31], v9, s[12:15], s31 offen offset:1024
    v_mfma_f32_16x16x32_bf16 v[68:71], a[72:75], a[112:115], v[68:71]
    s_waitcnt vmcnt(11)
    s_barrier
    v_mfma_f32_16x16x32_bf16 v[100:103], a[76:79], a[112:115], v[100:103]
    ds_read_b64_tr_b16 a[108:109], v10 offset:0
    ds_read_b64_tr_b16 a[110:111], v10 offset:4096
    v_mfma_f32_16x16x32_bf16 v[132:135], a[80:83], a[112:115], v[132:135]
    v_mfma_f32_16x16x32_bf16 a[144:147], a[156:159], a[112:115], a[144:147]
    v_mfma_f32_16x16x32_bf16 a[152:155], a[112:115], a[112:115], a[152:155]
    buffer_load_dwordx4 a[32:35], v9, s[12:15], s31 offen offset:2048
    v_mfma_f32_16x16x32_bf16 v[72:75], a[72:75], a[116:119], v[72:75]
    ds_read_b64_tr_b16 a[112:113], v11 offset:0
    ds_read_b64_tr_b16 a[114:115], v11 offset:4096
    v_mfma_f32_16x16x32_bf16 v[104:107], a[76:79], a[116:119], v[104:107]
    s_add_u32 s31, s31, 3072
    v_mfma_f32_16x16x32_bf16 v[136:139], a[80:83], a[116:119], v[136:139]
    v_mfma_f32_16x16x32_bf16 v[76:79], a[72:75], a[120:123], v[76:79]
    ds_read_b64_tr_b16 a[116:117], v12 offset:0
    ds_read_b64_tr_b16 a[118:119], v12 offset:4096
    v_mfma_f32_16x16x32_bf16 v[108:111], a[76:79], a[120:123], v[108:111]
    buffer_load_dwordx4 a[36:39], v9, s[12:15], s31 offen offset:0
    v_mfma_f32_16x16x32_bf16 v[140:143], a[80:83], a[120:123], v[140:143]
    s_waitcnt lgkmcnt(6)
    v_mfma_f32_16x16x32_bf16 v[80:83], a[72:75], a[124:127], v[80:83]
    ds_read_b64_tr_b16 a[120:121], v13 offset:0
    ds_read_b64_tr_b16 a[122:123], v13 offset:4096
    v_mfma_f32_16x16x32_bf16 v[112:115], a[76:79], a[124:127], v[112:115]
    v_mfma_f32_16x16x32_bf16 v[144:147], a[80:83], a[124:127], v[144:147]
    buffer_load_dwordx4 a[40:43], v9, s[12:15], s31 offen offset:1024
    v_mfma_f32_16x16x32_bf16 v[84:87], a[72:75], a[128:131], v[84:87]
    ds_read_b64_tr_b16 a[124:125], v14 offset:0
    ds_read_b64_tr_b16 a[126:127], v14 offset:4096
    v_mfma_f32_16x16x32_bf16 v[116:119], a[76:79], a[128:131], v[116:119]
    v_mfma_f32_16x16x32_bf16 v[148:151], a[80:83], a[128:131], v[148:151]
    v_mfma_f32_16x16x32_bf16 v[88:91], a[72:75], a[132:135], v[88:91]
    ds_read_b64_tr_b16 a[128:129], v15 offset:0
    ds_read_b64_tr_b16 a[130:131], v15 offset:4096
    v_mfma_f32_16x16x32_bf16 v[120:123], a[76:79], a[132:135], v[120:123]
    buffer_load_dwordx4 a[44:47], v9, s[12:15], s31 offen offset:2048
    v_mfma_f32_16x16x32_bf16 v[152:155], a[80:83], a[132:135], v[152:155]
    s_add_u32 s31, s31, 3072
    v_mfma_f32_16x16x32_bf16 v[92:95], a[72:75], a[136:139], v[92:95]
    ds_read_b64_tr_b16 a[132:133], v16 offset:0
    ds_read_b64_tr_b16 a[134:135], v16 offset:4096
    v_mfma_f32_16x16x32_bf16 v[124:127], a[76:79], a[136:139], v[124:127]
    v_mfma_f32_16x16x32_bf16 v[156:159], a[80:83], a[136:139], v[156:159]
    s_waitcnt lgkmcnt(6)
    v_mfma_f32_16x16x32_bf16 v[64:67], a[84:87], a[108:111], v[64:67]
    ds_read_b64_tr_b16 a[136:137], v17 offset:0
    ds_read_b64_tr_b16 a[138:139], v17 offset:4096
    v_mfma_f32_16x16x32_bf16 v[96:99], a[88:91], a[108:111], v[96:99]
    buffer_load_dwordx4 a[48:51], v9, s[12:15], s31 offen offset:0
    v_mfma_f32_16x16x32_bf16 v[128:131], a[92:95], a[108:111], v[128:131]
    v_mfma_f32_16x16x32_bf16 a[140:143], a[156:159], a[108:111], a[140:143]
    v_mfma_f32_16x16x32_bf16 a[148:151], a[108:111], a[108:111], a[148:151]
    buffer_load_dwordx4 a[52:55], v9, s[12:15], s31 offen offset:1024
    v_mfma_f32_16x16x32_bf16 v[68:71], a[84:87], a[112:115], v[68:71]
    ds_read_b64_tr_b16 a[108:109], v10 offset:8192
    ds_read_b64_tr_b16 a[110:111], v10 offset:12288
    v_mfma_f32_16x16x32_bf16 v[100:103], a[88:91], a[112:115], v[100:103]
    v_subrev_u32 v10, 0x20000, v10
    v_mfma_f32_16x16x32_bf16 v[132:135], a[92:95], a[112:115], v[132:135]
    v_mfma_f32_16x16x32_bf16 a[144:147], a[156:159], a[112:115], a[144:147]
    v_mfma_f32_16x16x32_bf16 a[152:155], a[112:115], a[112:115], a[152:155]
    buffer_load_dwordx4 a[56:59], v9, s[12:15], s31 offen offset:2048
    v_mfma_f32_16x16x32_bf16 v[72:75], a[84:87], a[116:119], v[72:75]
    ds_read_b64_tr_b16 a[112:113], v11 offset:8192
    ds_read_b64_tr_b16 a[114:115], v11 offset:12288
    v_mfma_f32_16x16x32_bf16 v[104:107], a[88:91], a[116:119], v[104:107]
    v_subrev_u32 v11, 0x20000, v11
    s_add_u32 s31, s31, 3072
    v_mfma_f32_16x16x32_bf16 v[136:139], a[92:95], a[116:119], v[136:139]
    v_mfma_f32_16x16x32_bf16 v[76:79], a[84:87], a[120:123], v[76:79]
    ds_read_b64_tr_b16 a[116:117], v12 offset:8192
    ds_read_b64_tr_b16 a[118:119], v12 offset:12288
    v_mfma_f32_16x16x32_bf16 v[108:111], a[88:91], a[120:123], v[108:111]
    v_subrev_u32 v12, 0x20000, v12
    v_mfma_f32_16x16x32_bf16 v[140:143], a[92:95], a[120:123], v[140:143]
    s_waitcnt lgkmcnt(6)
    v_mfma_f32_16x16x32_bf16 v[80:83], a[84:87], a[124:127], v[80:83]
    ds_read_b64_tr_b16 a[120:121], v13 offset:8192
    ds_read_b64_tr_b16 a[122:123], v13 offset:12288
    v_mfma_f32_16x16x32_bf16 v[112:115], a[88:91], a[124:127], v[112:115]
    v_subrev_u32 v13, 0x20000, v13
    v_mfma_f32_16x16x32_bf16 v[144:147], a[92:95], a[124:127], v[144:147]
    buffer_load_dwordx4 a[60:63], v9, s[12:15], s31 offen offset:0
    v_mfma_f32_16x16x32_bf16 v[84:87], a[84:87], a[128:131], v[84:87]
    ds_read_b64_tr_b16 a[124:125], v14 offset:8192
    ds_read_b64_tr_b16 a[126:127], v14 offset:12288
    v_mfma_f32_16x16x32_bf16 v[116:119], a[88:91], a[128:131], v[116:119]
    v_subrev_u32 v14, 0x20000, v14
    v_mfma_f32_16x16x32_bf16 v[148:151], a[92:95], a[128:131], v[148:151]
    buffer_load_dwordx4 a[64:67], v9, s[12:15], s31 offen offset:1024
    v_mfma_f32_16x16x32_bf16 v[88:91], a[84:87], a[132:135], v[88:91]
    ds_read_b64_tr_b16 a[128:129], v15 offset:8192
    ds_read_b64_tr_b16 a[130:131], v15 offset:12288
    v_mfma_f32_16x16x32_bf16 v[120:123], a[88:91], a[132:135], v[120:123]
    v_subrev_u32 v15, 0x20000, v15
    v_mfma_f32_16x16x32_bf16 v[152:155], a[92:95], a[132:135], v[152:155]
    buffer_load_dwordx4 a[68:71], v9, s[12:15], s31 offen offset:2048
    v_mfma_f32_16x16x32_bf16 v[92:95], a[84:87], a[136:139], v[92:95]
    ds_read_b64_tr_b16 a[132:133], v16 offset:8192
    ds_read_b64_tr_b16 a[134:135], v16 offset:12288
    v_mfma_f32_16x16x32_bf16 v[124:127], a[88:91], a[136:139], v[124:127]
    v_subrev_u32 v16, 0x20000, v16
    s_add_u32 s31, s31, 3072
    v_mfma_f32_16x16x32_bf16 v[156:159], a[92:95], a[136:139], v[156:159]
    s_waitcnt lgkmcnt(6)
    s_waitcnt vmcnt(18)
    v_mfma_f32_16x16x32_bf16 v[64:67], a[96:99], a[108:111], v[64:67]
    ds_read_b64_tr_b16 a[136:137], v17 offset:8192
    ds_read_b64_tr_b16 a[138:139], v17 offset:12288
    v_mfma_f32_16x16x32_bf16 v[96:99], a[100:103], a[108:111], v[96:99]
    v_subrev_u32 v17, 0x20000, v17
    v_mfma_f32_16x16x32_bf16 v[128:131], a[104:107], a[108:111], v[128:131]
    buffer_load_dwordx4 a[72:75], v9, s[12:15], s31 offen offset:0
    v_mfma_f32_16x16x32_bf16 a[140:143], a[156:159], a[108:111], a[140:143]
    v_mfma_f32_16x16x32_bf16 a[148:151], a[108:111], a[108:111], a[148:151]
    buffer_load_dwordx4 a[76:79], v9, s[12:15], s31 offen offset:1024
    v_mfma_f32_16x16x32_bf16 v[68:71], a[96:99], a[112:115], v[68:71]
    ds_read_b64_tr_b16 a[108:109], v10 offset:0
    ds_read_b64_tr_b16 a[110:111], v10 offset:4096
    v_mfma_f32_16x16x32_bf16 v[100:103], a[100:103], a[112:115], v[100:103]
    v_mfma_f32_16x16x32_bf16 v[132:135], a[104:107], a[112:115], v[132:135]
    v_mfma_f32_16x16x32_bf16 a[144:147], a[156:159], a[112:115], a[144:147]
    buffer_load_dwordx4 a[80:83], v9, s[12:15], s31 offen offset:2048
    v_mfma_f32_16x16x32_bf16 a[152:155], a[112:115], a[112:115], a[152:155]
    s_add_u32 s31, s31, 3072
    v_mfma_f32_16x16x32_bf16 v[72:75], a[96:99], a[116:119], v[72:75]
    ds_read_b64_tr_b16 a[112:113], v11 offset:0
    ds_read_b64_tr_b16 a[114:115], v11 offset:4096
    v_mfma_f32_16x16x32_bf16 v[104:107], a[100:103], a[116:119], v[104:107]
    v_mfma_f32_16x16x32_bf16 v[136:139], a[104:107], a[116:119], v[136:139]
    buffer_load_dwordx4 a[84:87], v9, s[12:15], s31 offen offset:0
    v_mfma_f32_16x16x32_bf16 v[76:79], a[96:99], a[120:123], v[76:79]
    ds_read_b64_tr_b16 a[116:117], v12 offset:0
    ds_read_b64_tr_b16 a[118:119], v12 offset:4096
    v_mfma_f32_16x16x32_bf16 v[108:111], a[100:103], a[120:123], v[108:111]
    v_mfma_f32_16x16x32_bf16 v[140:143], a[104:107], a[120:123], v[140:143]
    s_waitcnt lgkmcnt(6)
    v_mfma_f32_16x16x32_bf16 v[80:83], a[96:99], a[124:127], v[80:83]
    ds_read_b64_tr_b16 a[120:121], v13 offset:0
    ds_read_b64_tr_b16 a[122:123], v13 offset:4096
    v_mfma_f32_16x16x32_bf16 v[112:115], a[100:103], a[124:127], v[112:115]
    buffer_load_dwordx4 a[88:91], v9, s[12:15], s31 offen offset:1024
    v_mfma_f32_16x16x32_bf16 v[144:147], a[104:107], a[124:127], v[144:147]
    v_mfma_f32_16x16x32_bf16 v[84:87], a[96:99], a[128:131], v[84:87]
    ds_read_b64_tr_b16 a[124:125], v14 offset:0
    ds_read_b64_tr_b16 a[126:127], v14 offset:4096
    v_mfma_f32_16x16x32_bf16 v[116:119], a[100:103], a[128:131], v[116:119]
    buffer_load_dwordx4 a[92:95], v9, s[12:15], s31 offen offset:2048
    v_mfma_f32_16x16x32_bf16 v[148:151], a[104:107], a[128:131], v[148:151]
    s_add_u32 s31, s31, 3072
    v_mfma_f32_16x16x32_bf16 v[88:91], a[96:99], a[132:135], v[88:91]
    ds_read_b64_tr_b16 a[128:129], v15 offset:0
    ds_read_b64_tr_b16 a[130:131], v15 offset:4096
    v_mfma_f32_16x16x32_bf16 v[120:123], a[100:103], a[132:135], v[120:123]
    v_mfma_f32_16x16x32_bf16 v[152:155], a[104:107], a[132:135], v[152:155]
    buffer_store_dwordx4 a[252:255], v9, s[16:19], s34 offen offset:0 sc1
    v_mfma_f32_16x16x32_bf16 v[92:95], a[96:99], a[136:139], v[92:95]
    ds_read_b64_tr_b16 a[132:133], v16 offset:0
    ds_read_b64_tr_b16 a[134:135], v16 offset:4096
    v_mfma_f32_16x16x32_bf16 v[124:127], a[100:103], a[136:139], v[124:127]
    v_mfma_f32_16x16x32_bf16 v[156:159], a[104:107], a[136:139], v[156:159]
    s_waitcnt lgkmcnt(6)
    s_waitcnt vmcnt(22)
    v_mfma_f32_16x16x32_bf16 v[160:163], a[0:3], a[108:111], 0
    ds_read_b64_tr_b16 a[136:137], v17 offset:0
    ds_read_b64_tr_b16 a[138:139], v17 offset:4096
    v_accvgpr_read_b32 v48, a140
    v_mfma_f32_16x16x32_bf16 v[192:195], a[4:7], a[108:111], 0
    buffer_load_dwordx4 a[96:99], v9, s[12:15], s31 offen offset:0
    v_mfma_f32_16x16x32_bf16 v[224:227], a[8:11], a[108:111], 0
    v_accvgpr_read_b32 v49, a144
    v_mul_f32 v48, 0xbae38e39, v48
    v_mfma_f32_16x16x32_bf16 v[164:167], a[0:3], a[112:115], 0
    ds_read_b64_tr_b16 a[108:109], v10 offset:8192
    ds_read_b64_tr_b16 a[110:111], v10 offset:12288
    v_mfma_f32_16x16x32_bf16 v[196:199], a[4:7], a[112:115], 0
    v_mul_f32 v49, 0xbae38e39, v49
    v_cvt_pk_bf16_f32 v50, 0, v48
    v_mfma_f32_16x16x32_bf16 v[228:231], a[8:11], a[112:115], 0
    v_cvt_pk_bf16_f32 v51, 0, v49
    ds_write2st64_b32 v26, v50, v50 offset0:0 offset1:2
    v_mfma_f32_16x16x32_bf16 v[168:171], a[0:3], a[116:119], 0
    ds_read_b64_tr_b16 a[112:113], v11 offset:8192
    ds_read_b64_tr_b16 a[114:115], v11 offset:12288
    v_mfma_f32_16x16x32_bf16 v[200:203], a[4:7], a[116:119], 0
    ds_write_b32 v26, v51 offset:64
    ds_write_b32 v26, v51 offset:576
    v_mfma_f32_16x16x32_bf16 v[232:235], a[8:11], a[116:119], 0
    buffer_load_dwordx4 a[100:103], v9, s[12:15], s31 offen offset:1024
    v_mfma_f32_16x16x32_bf16 v[172:175], a[0:3], a[120:123], 0
    ds_read_b64_tr_b16 a[116:117], v12 offset:8192
    ds_read_b64_tr_b16 a[118:119], v12 offset:12288
    v_mfma_f32_16x16x32_bf16 v[204:207], a[4:7], a[120:123], 0
    s_waitcnt lgkmcnt(2)
    s_barrier
    v_mfma_f32_16x16x32_bf16 v[236:239], a[8:11], a[120:123], 0
    ds_read2_b32 v[28:29], v26 offset0:0 offset1:16
    ds_read2_b32 v[30:31], v26 offset0:32 offset1:48
    v_mfma_f32_16x16x32_bf16 v[176:179], a[0:3], a[124:127], 0
    ds_read_b64_tr_b16 a[120:121], v13 offset:8192
    ds_read_b64_tr_b16 a[122:123], v13 offset:12288
    ds_read2_b32 v[32:33], v26 offset0:64 offset1:80
    v_mfma_f32_16x16x32_bf16 v[208:211], a[4:7], a[124:127], 0
    ds_read2_b32 v[34:35], v26 offset0:96 offset1:112
    s_waitcnt lgkmcnt(0)
    v_mfma_f32_16x16x32_bf16 v[240:243], a[8:11], a[124:127], 0
    v_fmac_f32 v64, v36, v28
    v_fmac_f32 v65, v37, v28
    v_mfma_f32_16x16x32_bf16 v[180:183], a[0:3], a[128:131], 0
    ds_read_b64_tr_b16 a[124:125], v14 offset:8192
    ds_read_b64_tr_b16 a[126:127], v14 offset:12288
    v_mfma_f32_16x16x32_bf16 v[212:215], a[4:7], a[128:131], 0
    buffer_load_dwordx4 a[104:107], v9, s[12:15], s31 offen offset:2048
    v_mfma_f32_16x16x32_bf16 v[244:247], a[8:11], a[128:131], 0
    s_add_u32 s31, s31, 3072
    v_fmac_f32 v66, v38, v28
    v_mfma_f32_16x16x32_bf16 v[184:187], a[0:3], a[132:135], 0
    ds_read_b64_tr_b16 a[128:129], v15 offset:8192
    ds_read_b64_tr_b16 a[130:131], v15 offset:12288
    v_mfma_f32_16x16x32_bf16 v[216:219], a[4:7], a[132:135], 0
    v_fmac_f32 v67, v39, v28
    v_mul_f32 v64, v64, v66
    v_mfma_f32_16x16x32_bf16 v[248:251], a[8:11], a[132:135], 0
    v_mul_f32 v65, v65, v67
    v_cvt_pk_bf16_f32 v48, v64, v65
    v_mfma_f32_16x16x32_bf16 v[188:191], a[0:3], a[136:139], 0
    ds_read_b64_tr_b16 a[132:133], v16 offset:8192
    ds_read_b64_tr_b16 a[134:135], v16 offset:12288
    v_mfma_f32_16x16x32_bf16 v[220:223], a[4:7], a[136:139], 0
    v_fmac_f32 v68, v36, v29
    v_fmac_f32 v69, v37, v29
    v_mfma_f32_16x16x32_bf16 v[252:255], a[8:11], a[136:139], 0
    v_fmac_f32 v70, v38, v29
    s_waitcnt vmcnt(22)
    v_mfma_f32_16x16x32_bf16 v[160:163], a[12:15], a[108:111], v[160:163]
    ds_read_b64_tr_b16 a[136:137], v17 offset:8192
    ds_read_b64_tr_b16 a[138:139], v17 offset:12288
    v_fmac_f32 v71, v39, v29
    v_mfma_f32_16x16x32_bf16 v[192:195], a[16:19], a[108:111], v[192:195]
    buffer_load_dwordx4 a[0:3], v9, s[12:15], s31 offen offset:0
    v_mfma_f32_16x16x32_bf16 v[224:227], a[20:23], a[108:111], v[224:227]
    v_mul_f32 v68, v68, v70
    v_mul_f32 v69, v69, v71
    v_mfma_f32_16x16x32_bf16 v[164:167], a[12:15], a[112:115], v[164:167]
    ds_read_b64_tr_b16 a[108:109], v10 offset:16384
    ds_read_b64_tr_b16 a[110:111], v10 offset:20480
    v_mfma_f32_16x16x32_bf16 v[196:199], a[16:19], a[112:115], v[196:199]
    v_cvt_pk_bf16_f32 v49, v68, v69
    v_fmac_f32 v72, v36, v30
    v_mfma_f32_16x16x32_bf16 v[228:231], a[20:23], a[112:115], v[228:231]
    v_fmac_f32 v73, v37, v30
    v_fmac_f32 v74, v38, v30
    v_mfma_f32_16x16x32_bf16 v[168:171], a[12:15], a[116:119], v[168:171]
    ds_read_b64_tr_b16 a[112:113], v11 offset:16384
    ds_read_b64_tr_b16 a[114:115], v11 offset:20480
    v_mfma_f32_16x16x32_bf16 v[200:203], a[16:19], a[116:119], v[200:203]
    buffer_load_dwordx4 a[4:7], v9, s[12:15], s31 offen offset:1024
    v_mfma_f32_16x16x32_bf16 v[232:235], a[20:23], a[116:119], v[232:235]
    v_fmac_f32 v75, v39, v30
    v_mul_f32 v72, v72, v74
    v_mfma_f32_16x16x32_bf16 v[172:175], a[12:15], a[120:123], v[172:175]
    ds_read_b64_tr_b16 a[116:117], v12 offset:16384
    ds_read_b64_tr_b16 a[118:119], v12 offset:20480
    v_mfma_f32_16x16x32_bf16 v[204:207], a[16:19], a[120:123], v[204:207]
    v_mul_f32 v73, v73, v75
    v_cvt_pk_bf16_f32 v50, v72, v73
    v_mfma_f32_16x16x32_bf16 v[236:239], a[20:23], a[120:123], v[236:239]
    v_fmac_f32 v76, v36, v31
    s_waitcnt lgkmcnt(6)
    v_mfma_f32_16x16x32_bf16 v[176:179], a[12:15], a[124:127], v[176:179]
    ds_read_b64_tr_b16 a[120:121], v13 offset:16384
    ds_read_b64_tr_b16 a[122:123], v13 offset:20480
    v_fmac_f32 v77, v37, v31
    v_mfma_f32_16x16x32_bf16 v[208:211], a[16:19], a[124:127], v[208:211]
    buffer_load_dwordx4 a[8:11], v9, s[12:15], s31 offen offset:2048
    v_mfma_f32_16x16x32_bf16 v[240:243], a[20:23], a[124:127], v[240:243]
    s_add_u32 s31, s31, 3072
    v_fmac_f32 v78, v38, v31
    v_mfma_f32_16x16x32_bf16 v[180:183], a[12:15], a[128:131], v[180:183]
    ds_read_b64_tr_b16 a[124:125], v14 offset:16384
    ds_read_b64_tr_b16 a[126:127], v14 offset:20480
    v_mfma_f32_16x16x32_bf16 v[212:215], a[16:19], a[128:131], v[212:215]
    v_fmac_f32 v79, v39, v31
    v_mul_f32 v76, v76, v78
    v_mfma_f32_16x16x32_bf16 v[244:247], a[20:23], a[128:131], v[244:247]
    v_mul_f32 v77, v77, v79
    v_cvt_pk_bf16_f32 v51, v76, v77
    v_mfma_f32_16x16x32_bf16 v[184:187], a[12:15], a[132:135], v[184:187]
    ds_read_b64_tr_b16 a[128:129], v15 offset:16384
    ds_read_b64_tr_b16 a[130:131], v15 offset:20480
    v_mfma_f32_16x16x32_bf16 v[216:219], a[16:19], a[132:135], v[216:219]
    buffer_store_dwordx4 a[252:255], v9, s[16:19], s34 offen offset:1024 sc1
    v_mfma_f32_16x16x32_bf16 v[248:251], a[20:23], a[132:135], v[248:251]
    v_permlane32_swap_b32 v48, v50
    v_mfma_f32_16x16x32_bf16 v[188:191], a[12:15], a[136:139], v[188:191]
    ds_read_b64_tr_b16 a[132:133], v16 offset:16384
    ds_read_b64_tr_b16 a[134:135], v16 offset:20480
    v_mfma_f32_16x16x32_bf16 v[220:223], a[16:19], a[136:139], v[220:223]
    v_permlane32_swap_b32 v49, v51
    v_mfma_f32_16x16x32_bf16 v[252:255], a[20:23], a[136:139], v[252:255]
    s_waitcnt lgkmcnt(6)
    s_waitcnt vmcnt(23)
    v_mfma_f32_16x16x32_bf16 v[160:163], a[24:27], a[108:111], v[160:163]
    ds_read_b64_tr_b16 a[136:137], v17 offset:16384
    ds_read_b64_tr_b16 a[138:139], v17 offset:20480
    v_accvgpr_read_b32 v8, a140
    v_mfma_f32_16x16x32_bf16 v[192:195], a[28:31], a[108:111], v[192:195]
    buffer_load_dwordx4 a[12:15], v9, s[12:15], s31 offen offset:0
    v_mfma_f32_16x16x32_bf16 v[224:227], a[32:35], a[108:111], v[224:227]
    v_permlane16_swap_b32 v48, v49
    v_mfma_f32_16x16x32_bf16 v[164:167], a[24:27], a[112:115], v[164:167]
    ds_read_b64_tr_b16 a[108:109], v10 offset:24576
    ds_read_b64_tr_b16 a[110:111], v10 offset:28672
    v_mfma_f32_16x16x32_bf16 v[196:199], a[28:31], a[112:115], v[196:199]
    v_permlane16_swap_b32 v50, v51
    v_mfma_f32_16x16x32_bf16 v[228:231], a[32:35], a[112:115], v[228:231]
    buffer_store_dwordx4 v[48:51], v18, s[16:19], s40 offen sc1
    v_mfma_f32_16x16x32_bf16 v[168:171], a[24:27], a[116:119], v[168:171]
    ds_read_b64_tr_b16 a[112:113], v11 offset:24576
    ds_read_b64_tr_b16 a[114:115], v11 offset:28672
    v_mfma_f32_16x16x32_bf16 v[200:203], a[28:31], a[116:119], v[200:203]
    v_fmac_f32 v96, v40, v28
    v_fmac_f32 v97, v41, v28
    v_mfma_f32_16x16x32_bf16 v[232:235], a[32:35], a[116:119], v[232:235]
    buffer_load_dwordx4 a[16:19], v9, s[12:15], s31 offen offset:1024
    v_mfma_f32_16x16x32_bf16 v[172:175], a[24:27], a[120:123], v[172:175]
    ds_read_b64_tr_b16 a[116:117], v12 offset:24576
    ds_read_b64_tr_b16 a[118:119], v12 offset:28672
    v_mfma_f32_16x16x32_bf16 v[204:207], a[28:31], a[120:123], v[204:207]
    v_fmac_f32 v98, v42, v28
    v_fmac_f32 v99, v43, v28
    v_mfma_f32_16x16x32_bf16 v[236:239], a[32:35], a[120:123], v[236:239]
    v_mul_f32 v96, v96, v98
    s_waitcnt lgkmcnt(6)
    v_mfma_f32_16x16x32_bf16 v[176:179], a[24:27], a[124:127], v[176:179]
    ds_read_b64_tr_b16 a[120:121], v13 offset:24576
    ds_read_b64_tr_b16 a[122:123], v13 offset:28672
    v_mul_f32 v97, v97, v99
    v_mfma_f32_16x16x32_bf16 v[208:211], a[28:31], a[124:127], v[208:211]
    v_cvt_pk_bf16_f32 v48, v96, v97
    v_fmac_f32 v100, v40, v29
    v_mfma_f32_16x16x32_bf16 v[240:243], a[32:35], a[124:127], v[240:243]
    v_fmac_f32 v101, v41, v29
    v_fmac_f32 v102, v42, v29
    v_mfma_f32_16x16x32_bf16 v[180:183], a[24:27], a[128:131], v[180:183]
    ds_read_b64_tr_b16 a[124:125], v14 offset:24576
    ds_read_b64_tr_b16 a[126:127], v14 offset:28672
    v_mfma_f32_16x16x32_bf16 v[212:215], a[28:31], a[128:131], v[212:215]
    buffer_load_dwordx4 a[20:23], v9, s[12:15], s31 offen offset:2048
    v_mfma_f32_16x16x32_bf16 v[244:247], a[32:35], a[128:131], v[244:247]
    s_add_u32 s31, s31, 3072
    v_fmac_f32 v103, v43, v29
    v_mfma_f32_16x16x32_bf16 v[184:187], a[24:27], a[132:135], v[184:187]
    ds_read_b64_tr_b16 a[128:129], v15 offset:24576
    ds_read_b64_tr_b16 a[130:131], v15 offset:28672
    v_mfma_f32_16x16x32_bf16 v[216:219], a[28:31], a[132:135], v[216:219]
    v_mul_f32 v100, v100, v102
    v_mul_f32 v101, v101, v103
    v_mfma_f32_16x16x32_bf16 v[248:251], a[32:35], a[132:135], v[248:251]
    v_cvt_pk_bf16_f32 v49, v100, v101
    v_fmac_f32 v104, v40, v30
    v_mfma_f32_16x16x32_bf16 v[188:191], a[24:27], a[136:139], v[188:191]
    ds_read_b64_tr_b16 a[132:133], v16 offset:24576
    ds_read_b64_tr_b16 a[134:135], v16 offset:28672
    v_mfma_f32_16x16x32_bf16 v[220:223], a[28:31], a[136:139], v[220:223]
    v_fmac_f32 v105, v41, v30
    v_fmac_f32 v106, v42, v30
    v_mfma_f32_16x16x32_bf16 v[252:255], a[32:35], a[136:139], v[252:255]
    s_waitcnt lgkmcnt(6)
    s_waitcnt vmcnt(24)
    v_mfma_f32_16x16x32_bf16 v[160:163], a[36:39], a[108:111], v[160:163]
    ds_read_b64_tr_b16 a[136:137], v17 offset:24576
    ds_read_b64_tr_b16 a[138:139], v17 offset:28672
    v_fmac_f32 v107, v43, v30
    v_mfma_f32_16x16x32_bf16 v[192:195], a[40:43], a[108:111], v[192:195]
    buffer_load_dwordx4 a[24:27], v9, s[12:15], s31 offen offset:0
    v_mfma_f32_16x16x32_bf16 v[224:227], a[44:47], a[108:111], v[224:227]
    v_mul_f32 v104, v104, v106
    v_mul_f32 v105, v105, v107
    v_mfma_f32_16x16x32_bf16 v[164:167], a[36:39], a[112:115], v[164:167]
    ds_read_b64_tr_b16 a[108:109], v10 offset:32768
    ds_read_b64_tr_b16 a[110:111], v10 offset:36864
    v_mfma_f32_16x16x32_bf16 v[196:199], a[40:43], a[112:115], v[196:199]
    v_cvt_pk_bf16_f32 v50, v104, v105
    v_fmac_f32 v108, v40, v31
    v_mfma_f32_16x16x32_bf16 v[228:231], a[44:47], a[112:115], v[228:231]
    v_fmac_f32 v109, v41, v31
    v_fmac_f32 v110, v42, v31
    v_mfma_f32_16x16x32_bf16 v[168:171], a[36:39], a[116:119], v[168:171]
    ds_read_b64_tr_b16 a[112:113], v11 offset:32768
    ds_read_b64_tr_b16 a[114:115], v11 offset:36864
    v_mfma_f32_16x16x32_bf16 v[200:203], a[40:43], a[116:119], v[200:203]
    buffer_load_dwordx4 a[28:31], v9, s[12:15], s31 offen offset:1024
    v_mfma_f32_16x16x32_bf16 v[232:235], a[44:47], a[116:119], v[232:235]
    v_fmac_f32 v111, v43, v31
    v_mul_f32 v108, v108, v110
    v_mfma_f32_16x16x32_bf16 v[172:175], a[36:39], a[120:123], v[172:175]
    ds_read_b64_tr_b16 a[116:117], v12 offset:32768
    ds_read_b64_tr_b16 a[118:119], v12 offset:36864
    v_mfma_f32_16x16x32_bf16 v[204:207], a[40:43], a[120:123], v[204:207]
    v_mul_f32 v109, v109, v111
    v_cvt_pk_bf16_f32 v51, v108, v109
    v_mfma_f32_16x16x32_bf16 v[236:239], a[44:47], a[120:123], v[236:239]
    v_accvgpr_read_b32 v52, a148
    s_waitcnt lgkmcnt(6)
    v_mfma_f32_16x16x32_bf16 v[176:179], a[36:39], a[124:127], v[176:179]
    ds_read_b64_tr_b16 a[120:121], v13 offset:32768
    ds_read_b64_tr_b16 a[122:123], v13 offset:36864
    v_accvgpr_read_b32 v53, a149
    v_mfma_f32_16x16x32_bf16 v[208:211], a[40:43], a[124:127], v[208:211]
    buffer_load_dwordx4 a[32:35], v9, s[12:15], s31 offen offset:2048
    v_mfma_f32_16x16x32_bf16 v[240:243], a[44:47], a[124:127], v[240:243]
    s_add_u32 s31, s31, 3072
    v_accvgpr_read_b32 v54, a150
    v_mfma_f32_16x16x32_bf16 v[180:183], a[36:39], a[128:131], v[180:183]
    ds_read_b64_tr_b16 a[124:125], v14 offset:32768
    ds_read_b64_tr_b16 a[126:127], v14 offset:36864
    v_mfma_f32_16x16x32_bf16 v[212:215], a[40:43], a[128:131], v[212:215]
    v_permlane32_swap_b32 v48, v50
    v_mfma_f32_16x16x32_bf16 v[244:247], a[44:47], a[128:131], v[244:247]
    v_permlane32_swap_b32 v49, v51
    v_mfma_f32_16x16x32_bf16 v[184:187], a[36:39], a[132:135], v[184:187]
    ds_read_b64_tr_b16 a[128:129], v15 offset:32768
    ds_read_b64_tr_b16 a[130:131], v15 offset:36864
    v_mfma_f32_16x16x32_bf16 v[216:219], a[40:43], a[132:135], v[216:219]
    buffer_store_dwordx4 a[252:255], v9, s[16:19], s34 offen offset:2048 sc1
    v_mfma_f32_16x16x32_bf16 v[248:251], a[44:47], a[132:135], v[248:251]
    v_permlane16_swap_b32 v48, v49
    v_mfma_f32_16x16x32_bf16 v[188:191], a[36:39], a[136:139], v[188:191]
    ds_read_b64_tr_b16 a[132:133], v16 offset:32768
    ds_read_b64_tr_b16 a[134:135], v16 offset:36864
    v_mfma_f32_16x16x32_bf16 v[220:223], a[40:43], a[136:139], v[220:223]
    v_permlane16_swap_b32 v50, v51
    v_mfma_f32_16x16x32_bf16 v[252:255], a[44:47], a[136:139], v[252:255]
    s_waitcnt lgkmcnt(6)
    s_waitcnt vmcnt(25)
    v_mfma_f32_16x16x32_bf16 v[160:163], a[48:51], a[108:111], v[160:163]
    ds_read_b64_tr_b16 a[136:137], v17 offset:32768
    ds_read_b64_tr_b16 a[138:139], v17 offset:36864
    v_accvgpr_read_b32 v55, a151
    v_mfma_f32_16x16x32_bf16 v[192:195], a[52:55], a[108:111], v[192:195]
    buffer_load_dwordx4 a[36:39], v9, s[12:15], s31 offen offset:0
    v_mfma_f32_16x16x32_bf16 v[224:227], a[56:59], a[108:111], v[224:227]
    buffer_store_dwordx4 v[48:51], v18, s[16:19], s41 offen sc1
    v_mfma_f32_16x16x32_bf16 v[164:167], a[48:51], a[112:115], v[164:167]
    ds_read_b64_tr_b16 a[108:109], v10 offset:40960
    ds_read_b64_tr_b16 a[110:111], v10 offset:45056
    v_mfma_f32_16x16x32_bf16 v[196:199], a[52:55], a[112:115], v[196:199]
    v_fmac_f32 v128, v44, v28
    v_fmac_f32 v129, v45, v28
    v_mfma_f32_16x16x32_bf16 v[228:231], a[56:59], a[112:115], v[228:231]
    v_fmac_f32 v130, v46, v28
    v_fmac_f32 v131, v47, v28
    v_mfma_f32_16x16x32_bf16 v[168:171], a[48:51], a[116:119], v[168:171]
    ds_read_b64_tr_b16 a[112:113], v11 offset:40960
    ds_read_b64_tr_b16 a[114:115], v11 offset:45056
    v_mfma_f32_16x16x32_bf16 v[200:203], a[52:55], a[116:119], v[200:203]
    v_mul_f32 v128, v128, v130
    v_mul_f32 v129, v129, v131
    v_mfma_f32_16x16x32_bf16 v[232:235], a[56:59], a[116:119], v[232:235]
    buffer_load_dwordx4 a[40:43], v9, s[12:15], s31 offen offset:1024
    v_mfma_f32_16x16x32_bf16 v[172:175], a[48:51], a[120:123], v[172:175]
    ds_read_b64_tr_b16 a[116:117], v12 offset:40960
    ds_read_b64_tr_b16 a[118:119], v12 offset:45056
    v_mfma_f32_16x16x32_bf16 v[204:207], a[52:55], a[120:123], v[204:207]
    v_cvt_pk_bf16_f32 v48, v128, v129
    v_fmac_f32 v132, v44, v29
    v_mfma_f32_16x16x32_bf16 v[236:239], a[56:59], a[120:123], v[236:239]
    v_fmac_f32 v133, v45, v29
    s_waitcnt lgkmcnt(6)
    v_mfma_f32_16x16x32_bf16 v[176:179], a[48:51], a[124:127], v[176:179]
    ds_read_b64_tr_b16 a[120:121], v13 offset:40960
    ds_read_b64_tr_b16 a[122:123], v13 offset:45056
    v_fmac_f32 v134, v46, v29
    v_mfma_f32_16x16x32_bf16 v[208:211], a[52:55], a[124:127], v[208:211]
    v_fmac_f32 v135, v47, v29
    v_mul_f32 v132, v132, v134
    v_mfma_f32_16x16x32_bf16 v[240:243], a[56:59], a[124:127], v[240:243]
    v_mul_f32 v133, v133, v135
    v_cvt_pk_bf16_f32 v49, v132, v133
    v_mfma_f32_16x16x32_bf16 v[180:183], a[48:51], a[128:131], v[180:183]
    ds_read_b64_tr_b16 a[124:125], v14 offset:40960
    ds_read_b64_tr_b16 a[126:127], v14 offset:45056
    v_mfma_f32_16x16x32_bf16 v[212:215], a[52:55], a[128:131], v[212:215]
    buffer_load_dwordx4 a[44:47], v9, s[12:15], s31 offen offset:2048
    v_mfma_f32_16x16x32_bf16 v[244:247], a[56:59], a[128:131], v[244:247]
    s_add_u32 s31, s31, 3072
    v_fmac_f32 v136, v44, v30
    v_mfma_f32_16x16x32_bf16 v[184:187], a[48:51], a[132:135], v[184:187]
    ds_read_b64_tr_b16 a[128:129], v15 offset:40960
    ds_read_b64_tr_b16 a[130:131], v15 offset:45056
    v_mfma_f32_16x16x32_bf16 v[216:219], a[52:55], a[132:135], v[216:219]
    v_fmac_f32 v137, v45, v30
    v_fmac_f32 v138, v46, v30
    v_mfma_f32_16x16x32_bf16 v[248:251], a[56:59], a[132:135], v[248:251]
    v_fmac_f32 v139, v47, v30
    v_mul_f32 v136, v136, v138
    v_mfma_f32_16x16x32_bf16 v[188:191], a[48:51], a[136:139], v[188:191]
    ds_read_b64_tr_b16 a[132:133], v16 offset:40960
    ds_read_b64_tr_b16 a[134:135], v16 offset:45056
    v_mfma_f32_16x16x32_bf16 v[220:223], a[52:55], a[136:139], v[220:223]
    v_mul_f32 v137, v137, v139
    v_cvt_pk_bf16_f32 v50, v136, v137
    v_mfma_f32_16x16x32_bf16 v[252:255], a[56:59], a[136:139], v[252:255]
    s_waitcnt lgkmcnt(6)
    s_waitcnt vmcnt(26)
    v_mfma_f32_16x16x32_bf16 v[160:163], a[60:63], a[108:111], v[160:163]
    ds_read_b64_tr_b16 a[136:137], v17 offset:40960
    ds_read_b64_tr_b16 a[138:139], v17 offset:45056
    v_fmac_f32 v140, v44, v31
    v_mfma_f32_16x16x32_bf16 v[192:195], a[64:67], a[108:111], v[192:195]
    buffer_load_dwordx4 a[48:51], v9, s[12:15], s31 offen offset:0
    v_mfma_f32_16x16x32_bf16 v[224:227], a[68:71], a[108:111], v[224:227]
    v_fmac_f32 v141, v45, v31
    v_fmac_f32 v142, v46, v31
    v_mfma_f32_16x16x32_bf16 v[164:167], a[60:63], a[112:115], v[164:167]
    ds_read_b64_tr_b16 a[108:109], v10 offset:49152
    ds_read_b64_tr_b16 a[110:111], v10 offset:53248
    v_mfma_f32_16x16x32_bf16 v[196:199], a[64:67], a[112:115], v[196:199]
    buffer_load_dwordx4 a[52:55], v9, s[12:15], s31 offen offset:1024
    v_mfma_f32_16x16x32_bf16 v[228:231], a[68:71], a[112:115], v[228:231]
    v_fmac_f32 v143, v47, v31
    v_mul_f32 v140, v140, v142
    v_mfma_f32_16x16x32_bf16 v[168:171], a[60:63], a[116:119], v[168:171]
    ds_read_b64_tr_b16 a[112:113], v11 offset:49152
    ds_read_b64_tr_b16 a[114:115], v11 offset:53248
    v_mfma_f32_16x16x32_bf16 v[200:203], a[64:67], a[116:119], v[200:203]
    v_mul_f32 v141, v141, v143
    v_cvt_pk_bf16_f32 v51, v140, v141
    v_mfma_f32_16x16x32_bf16 v[232:235], a[68:71], a[116:119], v[232:235]
    v_permlane32_swap_b32 v48, v50
    v_mfma_f32_16x16x32_bf16 v[172:175], a[60:63], a[120:123], v[172:175]
    ds_read_b64_tr_b16 a[116:117], v12 offset:49152
    ds_read_b64_tr_b16 a[118:119], v12 offset:53248
    v_mfma_f32_16x16x32_bf16 v[204:207], a[64:67], a[120:123], v[204:207]
    buffer_load_dwordx4 a[56:59], v9, s[12:15], s31 offen offset:2048
    v_mfma_f32_16x16x32_bf16 v[236:239], a[68:71], a[120:123], v[236:239]
    s_add_u32 s31, s31, 3072
    s_waitcnt lgkmcnt(6)
    v_mfma_f32_16x16x32_bf16 v[176:179], a[60:63], a[124:127], v[176:179]
    ds_read_b64_tr_b16 a[120:121], v13 offset:49152
    ds_read_b64_tr_b16 a[122:123], v13 offset:53248
    v_mul_f32 v8, 0x3ae38e39, v8
    v_mfma_f32_16x16x32_bf16 v[208:211], a[64:67], a[124:127], v[208:211]
    v_permlane32_swap_b32 v49, v51
    v_mfma_f32_16x16x32_bf16 v[240:243], a[68:71], a[124:127], v[240:243]
    buffer_load_dwordx4 v[56:59], v25, s[20:23], s51 offen offset:0
    v_mfma_f32_16x16x32_bf16 v[180:183], a[60:63], a[128:131], v[180:183]
    ds_read_b64_tr_b16 a[124:125], v14 offset:49152
    ds_read_b64_tr_b16 a[126:127], v14 offset:53248
    v_mfma_f32_16x16x32_bf16 v[212:215], a[64:67], a[128:131], v[212:215]
    v_permlane16_swap_b32 v48, v49
    v_mfma_f32_16x16x32_bf16 v[244:247], a[68:71], a[128:131], v[244:247]
    v_permlane16_swap_b32 v50, v51
    v_mfma_f32_16x16x32_bf16 v[184:187], a[60:63], a[132:135], v[184:187]
    ds_read_b64_tr_b16 a[128:129], v15 offset:49152
    ds_read_b64_tr_b16 a[130:131], v15 offset:53248
    v_mfma_f32_16x16x32_bf16 v[216:219], a[64:67], a[132:135], v[216:219]
    buffer_store_dwordx4 a[252:255], v9, s[16:19], s34 offen offset:3072 sc1
    v_mfma_f32_16x16x32_bf16 v[248:251], a[68:71], a[132:135], v[248:251]
    buffer_store_dwordx4 v[48:51], v18, s[16:19], s42 offen sc1
    v_mfma_f32_16x16x32_bf16 v[188:191], a[60:63], a[136:139], v[188:191]
    ds_read_b64_tr_b16 a[132:133], v16 offset:49152
    ds_read_b64_tr_b16 a[134:135], v16 offset:53248
    v_mfma_f32_16x16x32_bf16 v[220:223], a[64:67], a[136:139], v[220:223]
    v_cndmask_b32 v52, v52, v53, s[52:53]
    v_cndmask_b32 v52, v52, v54, s[54:55]
    v_mfma_f32_16x16x32_bf16 v[252:255], a[68:71], a[136:139], v[252:255]
    s_waitcnt lgkmcnt(6)
    s_waitcnt vmcnt(29)
    v_mfma_f32_16x16x32_bf16 v[160:163], a[72:75], a[108:111], v[160:163]
    ds_read_b64_tr_b16 a[136:137], v17 offset:49152
    ds_read_b64_tr_b16 a[138:139], v17 offset:53248
    v_cndmask_b32 v52, v52, v55, s[56:57]
    v_mfma_f32_16x16x32_bf16 v[192:195], a[76:79], a[108:111], v[192:195]
    buffer_load_dwordx4 a[60:63], v9, s[12:15], s31 offen offset:0
    v_mfma_f32_16x16x32_bf16 v[224:227], a[80:83], a[108:111], v[224:227]
    v_mul_f32 v52, 0x3ae38e39, v52
    v_fma_f32 v52, -v8, v8, v52
    v_mfma_f32_16x16x32_bf16 v[164:167], a[72:75], a[112:115], v[164:167]
    ds_read_b64_tr_b16 a[108:109], v10 offset:57344
    ds_read_b64_tr_b16 a[110:111], v10 offset:61440
    v_mfma_f32_16x16x32_bf16 v[196:199], a[76:79], a[112:115], v[196:199]
    v_add_u32 v10, 0x10000, v10
    v_max_f32 v52, 0, v52
    v_mfma_f32_16x16x32_bf16 v[228:231], a[80:83], a[112:115], v[228:231]
    v_cvt_pk_bf16_f32 v52, 0, v52
    v_add_f32 v52, 0x3727c5ac, v52
    v_mfma_f32_16x16x32_bf16 v[168:171], a[72:75], a[116:119], v[168:171]
    ds_read_b64_tr_b16 a[112:113], v11 offset:57344
    ds_read_b64_tr_b16 a[114:115], v11 offset:61440
    v_mfma_f32_16x16x32_bf16 v[200:203], a[76:79], a[116:119], v[200:203]
    v_add_u32 v11, 0x10000, v11
    v_cvt_pk_bf16_f32 v52, 0, v52
    v_mfma_f32_16x16x32_bf16 v[232:235], a[80:83], a[116:119], v[232:235]
    buffer_load_dwordx4 a[64:67], v9, s[12:15], s31 offen offset:1024
    v_mfma_f32_16x16x32_bf16 v[172:175], a[72:75], a[120:123], v[172:175]
    ds_read_b64_tr_b16 a[116:117], v12 offset:57344
    ds_read_b64_tr_b16 a[118:119], v12 offset:61440
    v_mfma_f32_16x16x32_bf16 v[204:207], a[76:79], a[120:123], v[204:207]
    v_add_u32 v12, 0x10000, v12
    v_mfma_f32_16x16x32_bf16 v[236:239], a[80:83], a[120:123], v[236:239]
    s_waitcnt lgkmcnt(6)
    v_mfma_f32_16x16x32_bf16 v[176:179], a[72:75], a[124:127], v[176:179]
    ds_read_b64_tr_b16 a[120:121], v13 offset:57344
    ds_read_b64_tr_b16 a[122:123], v13 offset:61440
    v_mfma_f32_16x16x32_bf16 v[208:211], a[76:79], a[124:127], v[208:211]
    v_add_u32 v13, 0x10000, v13
    v_mfma_f32_16x16x32_bf16 v[240:243], a[80:83], a[124:127], v[240:243]
    buffer_load_dwordx4 a[68:71], v9, s[12:15], s31 offen offset:2048
    v_mfma_f32_16x16x32_bf16 v[180:183], a[72:75], a[128:131], v[180:183]
    ds_read_b64_tr_b16 a[124:125], v14 offset:57344
    ds_read_b64_tr_b16 a[126:127], v14 offset:61440
    v_mfma_f32_16x16x32_bf16 v[212:215], a[76:79], a[128:131], v[212:215]
    v_add_u32 v14, 0x10000, v14
    s_add_u32 s31, s31, 3072
    v_mfma_f32_16x16x32_bf16 v[244:247], a[80:83], a[128:131], v[244:247]
    v_sqrt_f32 v52, v52
    v_mfma_f32_16x16x32_bf16 v[184:187], a[72:75], a[132:135], v[184:187]
    ds_read_b64_tr_b16 a[128:129], v15 offset:57344
    ds_read_b64_tr_b16 a[130:131], v15 offset:61440
    v_mfma_f32_16x16x32_bf16 v[216:219], a[76:79], a[132:135], v[216:219]
    v_add_u32 v15, 0x10000, v15
    v_cvt_pk_bf16_f32 v52, 0, v52
    v_mfma_f32_16x16x32_bf16 v[248:251], a[80:83], a[132:135], v[248:251]
    buffer_load_dwordx4 v[60:63], v25, s[20:23], s51 offen offset:64
    v_mfma_f32_16x16x32_bf16 v[188:191], a[72:75], a[136:139], v[188:191]
    ds_read_b64_tr_b16 a[132:133], v16 offset:57344
    ds_read_b64_tr_b16 a[134:135], v16 offset:61440
    v_mfma_f32_16x16x32_bf16 v[220:223], a[76:79], a[136:139], v[220:223]
    v_add_u32 v16, 0x10000, v16
    v_mul_f32 v52, v52, v52
    v_mfma_f32_16x16x32_bf16 v[252:255], a[80:83], a[136:139], v[252:255]
    s_waitcnt lgkmcnt(6)
    s_waitcnt vmcnt(30)
    v_mfma_f32_16x16x32_bf16 v[160:163], a[84:87], a[108:111], v[160:163]
    ds_read_b64_tr_b16 a[136:137], v17 offset:57344
    ds_read_b64_tr_b16 a[138:139], v17 offset:61440
    v_mfma_f32_16x16x32_bf16 v[192:195], a[88:91], a[108:111], v[192:195]
    v_add_u32 v17, 0x10000, v17
    v_mfma_f32_16x16x32_bf16 v[224:227], a[92:95], a[108:111], v[224:227]
    buffer_load_dwordx4 a[72:75], v9, s[12:15], s31 offen offset:0
    v_mfma_f32_16x16x32_bf16 v[164:167], a[84:87], a[112:115], v[164:167]
    ds_read_b64_tr_b16 a[108:109], v10 offset:0
    ds_read_b64_tr_b16 a[110:111], v10 offset:4096
    v_mfma_f32_16x16x32_bf16 v[196:199], a[88:91], a[112:115], v[196:199]
    buffer_load_dwordx4 a[76:79], v9, s[12:15], s31 offen offset:1024
    v_mfma_f32_16x16x32_bf16 v[228:231], a[92:95], a[112:115], v[228:231]
    v_rcp_f32 v6, v52
    v_mfma_f32_16x16x32_bf16 v[168:171], a[84:87], a[116:119], v[168:171]
    ds_read_b64_tr_b16 a[112:113], v11 offset:0
    ds_read_b64_tr_b16 a[114:115], v11 offset:4096
    v_mfma_f32_16x16x32_bf16 v[200:203], a[88:91], a[116:119], v[200:203]
    buffer_store_dword v6, v5, s[24:27], s58 offen offset:0 sc1
    v_mfma_f32_16x16x32_bf16 v[232:235], a[92:95], a[116:119], v[232:235]
    v_accvgpr_read_b32 v8, a144
    v_accvgpr_read_b32 v52, a152
    v_mfma_f32_16x16x32_bf16 v[172:175], a[84:87], a[120:123], v[172:175]
    ds_read_b64_tr_b16 a[116:117], v12 offset:0
    ds_read_b64_tr_b16 a[118:119], v12 offset:4096
    v_mfma_f32_16x16x32_bf16 v[204:207], a[88:91], a[120:123], v[204:207]
    buffer_load_dwordx4 a[80:83], v9, s[12:15], s31 offen offset:2048
    v_mfma_f32_16x16x32_bf16 v[236:239], a[92:95], a[120:123], v[236:239]
    s_add_u32 s31, s31, 3072
    s_waitcnt lgkmcnt(6)
    v_mfma_f32_16x16x32_bf16 v[176:179], a[84:87], a[124:127], v[176:179]
    ds_read_b64_tr_b16 a[120:121], v13 offset:0
    ds_read_b64_tr_b16 a[122:123], v13 offset:4096
    v_accvgpr_read_b32 v53, a153
    v_mfma_f32_16x16x32_bf16 v[208:211], a[88:91], a[124:127], v[208:211]
    v_accvgpr_read_b32 v54, a154
    v_accvgpr_read_b32 v55, a155
    v_mfma_f32_16x16x32_bf16 v[240:243], a[92:95], a[124:127], v[240:243]
    buffer_load_dwordx4 v[20:23], v25, s[20:23], s51 offen offset:128
    v_mfma_f32_16x16x32_bf16 v[180:183], a[84:87], a[128:131], v[180:183]
    ds_read_b64_tr_b16 a[124:125], v14 offset:0
    ds_read_b64_tr_b16 a[126:127], v14 offset:4096
    v_mfma_f32_16x16x32_bf16 v[212:215], a[88:91], a[128:131], v[212:215]
    s_add_u32 s51, s51, 12288
    v_mul_f32 v8, 0x3ae38e39, v8
    v_mfma_f32_16x16x32_bf16 v[244:247], a[92:95], a[128:131], v[244:247]
    v_cndmask_b32 v52, v52, v53, s[52:53]
    v_cndmask_b32 v52, v52, v54, s[54:55]
    v_mfma_f32_16x16x32_bf16 v[184:187], a[84:87], a[132:135], v[184:187]
    ds_read_b64_tr_b16 a[128:129], v15 offset:0
    ds_read_b64_tr_b16 a[130:131], v15 offset:4096
    v_mfma_f32_16x16x32_bf16 v[216:219], a[88:91], a[132:135], v[216:219]
    buffer_store_dwordx4 a[252:255], v9, s[16:19], s35 offen offset:0 sc1
    v_mfma_f32_16x16x32_bf16 v[248:251], a[92:95], a[132:135], v[248:251]
    v_cndmask_b32 v52, v52, v55, s[56:57]
    v_mul_f32 v52, 0x3ae38e39, v52
    v_mfma_f32_16x16x32_bf16 v[188:191], a[84:87], a[136:139], v[188:191]
    ds_read_b64_tr_b16 a[132:133], v16 offset:0
    ds_read_b64_tr_b16 a[134:135], v16 offset:4096
    v_mfma_f32_16x16x32_bf16 v[220:223], a[88:91], a[136:139], v[220:223]
    v_fma_f32 v52, -v8, v8, v52
    v_max_f32 v52, 0, v52
    v_mfma_f32_16x16x32_bf16 v[252:255], a[92:95], a[136:139], v[252:255]
    s_waitcnt lgkmcnt(6)
    s_waitcnt vmcnt(32)
    v_mfma_f32_16x16x32_bf16 v[160:163], a[96:99], a[108:111], v[160:163]
    ds_read_b64_tr_b16 a[136:137], v17 offset:0
    ds_read_b64_tr_b16 a[138:139], v17 offset:4096
    v_cvt_pk_bf16_f32 v52, 0, v52
    v_mfma_f32_16x16x32_bf16 v[192:195], a[100:103], a[108:111], v[192:195]
    buffer_load_dwordx4 a[84:87], v9, s[12:15], s31 offen offset:0
    v_mfma_f32_16x16x32_bf16 v[224:227], a[104:107], a[108:111], v[224:227]
    v_add_f32 v52, 0x3727c5ac, v52
    v_cvt_pk_bf16_f32 v52, 0, v52
    v_mfma_f32_16x16x32_bf16 v[164:167], a[96:99], a[112:115], v[164:167]
    ds_read_b64_tr_b16 a[108:109], v10 offset:8192
    ds_read_b64_tr_b16 a[110:111], v10 offset:12288
    v_mfma_f32_16x16x32_bf16 v[196:199], a[100:103], a[112:115], v[196:199]
    v_sqrt_f32 v52, v52
    v_mfma_f32_16x16x32_bf16 v[228:231], a[104:107], a[112:115], v[228:231]
    v_cvt_pk_bf16_f32 v52, 0, v52
    v_mul_f32 v52, v52, v52
    v_mfma_f32_16x16x32_bf16 v[168:171], a[96:99], a[116:119], v[168:171]
    ds_read_b64_tr_b16 a[112:113], v11 offset:8192
    ds_read_b64_tr_b16 a[114:115], v11 offset:12288
    v_mfma_f32_16x16x32_bf16 v[200:203], a[100:103], a[116:119], v[200:203]
    v_rcp_f32 v7, v52
    v_mfma_f32_16x16x32_bf16 v[232:235], a[104:107], a[116:119], v[232:235]
    buffer_load_dwordx4 a[88:91], v9, s[12:15], s31 offen offset:1024
    v_mfma_f32_16x16x32_bf16 v[172:175], a[96:99], a[120:123], v[172:175]
    ds_read_b64_tr_b16 a[116:117], v12 offset:8192
    ds_read_b64_tr_b16 a[118:119], v12 offset:12288
    v_mfma_f32_16x16x32_bf16 v[204:207], a[100:103], a[120:123], v[204:207]
    buffer_store_dword v7, v5, s[24:27], s58 offen offset:64 sc1
    v_mfma_f32_16x16x32_bf16 v[236:239], a[104:107], a[120:123], v[236:239]
    v_fmac_f32 v80, v36, v32
    s_waitcnt lgkmcnt(6)
    v_mfma_f32_16x16x32_bf16 v[176:179], a[96:99], a[124:127], v[176:179]
    ds_read_b64_tr_b16 a[120:121], v13 offset:8192
    ds_read_b64_tr_b16 a[122:123], v13 offset:12288
    v_fmac_f32 v81, v37, v32
    v_mfma_f32_16x16x32_bf16 v[208:211], a[100:103], a[124:127], v[208:211]
    v_fmac_f32 v82, v38, v32
    v_fmac_f32 v83, v39, v32
    v_mfma_f32_16x16x32_bf16 v[240:243], a[104:107], a[124:127], v[240:243]
    v_mul_f32 v80, v80, v82
    v_mul_f32 v81, v81, v83
    v_mfma_f32_16x16x32_bf16 v[180:183], a[96:99], a[128:131], v[180:183]
    ds_read_b64_tr_b16 a[124:125], v14 offset:8192
    ds_read_b64_tr_b16 a[126:127], v14 offset:12288
    v_mfma_f32_16x16x32_bf16 v[212:215], a[100:103], a[128:131], v[212:215]
    buffer_load_dwordx4 a[92:95], v9, s[12:15], s31 offen offset:2048
    v_mfma_f32_16x16x32_bf16 v[244:247], a[104:107], a[128:131], v[244:247]
    s_add_u32 s31, s31, 3072
    v_cvt_pk_bf16_f32 v52, v80, v81
    v_mfma_f32_16x16x32_bf16 v[184:187], a[96:99], a[132:135], v[184:187]
    ds_read_b64_tr_b16 a[128:129], v15 offset:8192
    ds_read_b64_tr_b16 a[130:131], v15 offset:12288
    v_mfma_f32_16x16x32_bf16 v[216:219], a[100:103], a[132:135], v[216:219]
    v_fmac_f32 v84, v36, v33
    v_fmac_f32 v85, v37, v33
    v_mfma_f32_16x16x32_bf16 v[248:251], a[104:107], a[132:135], v[248:251]
    v_fmac_f32 v86, v38, v33
    v_fmac_f32 v87, v39, v33
    v_mfma_f32_16x16x32_bf16 v[188:191], a[96:99], a[136:139], v[188:191]
    ds_read_b64_tr_b16 a[132:133], v16 offset:8192
    ds_read_b64_tr_b16 a[134:135], v16 offset:12288
    v_mfma_f32_16x16x32_bf16 v[220:223], a[100:103], a[136:139], v[220:223]
    v_mul_f32 v84, v84, v86
    v_mul_f32 v85, v85, v87
    v_mfma_f32_16x16x32_bf16 v[252:255], a[104:107], a[136:139], v[252:255]
    s_waitcnt lgkmcnt(6)
    s_waitcnt vmcnt(33)
    v_mfma_f32_16x16x32_bf16 v[160:163], a[0:3], a[108:111], v[160:163]
    ds_read_b64_tr_b16 a[136:137], v17 offset:8192
    ds_read_b64_tr_b16 a[138:139], v17 offset:12288
    v_cvt_pk_bf16_f32 v53, v84, v85
    v_mfma_f32_16x16x32_bf16 v[192:195], a[4:7], a[108:111], v[192:195]
    buffer_load_dwordx4 a[96:99], v9, s[12:15], s31 offen offset:0
    v_mfma_f32_16x16x32_bf16 v[224:227], a[8:11], a[108:111], v[224:227]
    v_fmac_f32 v88, v36, v34
    v_fmac_f32 v89, v37, v34
    v_mfma_f32_16x16x32_bf16 v[164:167], a[0:3], a[112:115], v[164:167]
    ds_read_b64_tr_b16 a[108:109], v10 offset:16384
    ds_read_b64_tr_b16 a[110:111], v10 offset:20480
    v_mfma_f32_16x16x32_bf16 v[196:199], a[4:7], a[112:115], v[196:199]
    v_fmac_f32 v90, v38, v34
    v_fmac_f32 v91, v39, v34
    v_mfma_f32_16x16x32_bf16 v[228:231], a[8:11], a[112:115], v[228:231]
    v_mul_f32 v88, v88, v90
    v_mul_f32 v89, v89, v91
    v_mfma_f32_16x16x32_bf16 v[168:171], a[0:3], a[116:119], v[168:171]
    ds_read_b64_tr_b16 a[112:113], v11 offset:16384
    ds_read_b64_tr_b16 a[114:115], v11 offset:20480
    v_mfma_f32_16x16x32_bf16 v[200:203], a[4:7], a[116:119], v[200:203]
    buffer_load_dwordx4 a[100:103], v9, s[12:15], s31 offen offset:1024
    v_mfma_f32_16x16x32_bf16 v[232:235], a[8:11], a[116:119], v[232:235]
    v_cvt_pk_bf16_f32 v54, v88, v89
    v_fmac_f32 v92, v36, v35
    v_mfma_f32_16x16x32_bf16 v[172:175], a[0:3], a[120:123], v[172:175]
    ds_read_b64_tr_b16 a[116:117], v12 offset:16384
    ds_read_b64_tr_b16 a[118:119], v12 offset:20480
    v_mfma_f32_16x16x32_bf16 v[204:207], a[4:7], a[120:123], v[204:207]
    v_fmac_f32 v93, v37, v35
    v_fmac_f32 v94, v38, v35
    v_mfma_f32_16x16x32_bf16 v[236:239], a[8:11], a[120:123], v[236:239]
    v_fmac_f32 v95, v39, v35
    s_waitcnt lgkmcnt(6)
    v_mfma_f32_16x16x32_bf16 v[176:179], a[0:3], a[124:127], v[176:179]
    ds_read_b64_tr_b16 a[120:121], v13 offset:16384
    ds_read_b64_tr_b16 a[122:123], v13 offset:20480
    v_mul_f32 v92, v92, v94
    v_mfma_f32_16x16x32_bf16 v[208:211], a[4:7], a[124:127], v[208:211]
    buffer_load_dwordx4 a[104:107], v9, s[12:15], s31 offen offset:2048
    v_mfma_f32_16x16x32_bf16 v[240:243], a[8:11], a[124:127], v[240:243]
    s_add_u32 s31, s31, 3486720
    v_mul_f32 v93, v93, v95
    v_mfma_f32_16x16x32_bf16 v[180:183], a[0:3], a[128:131], v[180:183]
    ds_read_b64_tr_b16 a[124:125], v14 offset:16384
    ds_read_b64_tr_b16 a[126:127], v14 offset:20480
    v_mfma_f32_16x16x32_bf16 v[212:215], a[4:7], a[128:131], v[212:215]
    v_cvt_pk_bf16_f32 v55, v92, v93
    v_mfma_f32_16x16x32_bf16 v[244:247], a[8:11], a[128:131], v[244:247]
    v_permlane32_swap_b32 v52, v54
    v_mfma_f32_16x16x32_bf16 v[184:187], a[0:3], a[132:135], v[184:187]
    ds_read_b64_tr_b16 a[128:129], v15 offset:16384
    ds_read_b64_tr_b16 a[130:131], v15 offset:20480
    v_mfma_f32_16x16x32_bf16 v[216:219], a[4:7], a[132:135], v[216:219]
    buffer_store_dwordx4 a[252:255], v9, s[16:19], s35 offen offset:1024 sc1
    v_mfma_f32_16x16x32_bf16 v[248:251], a[8:11], a[132:135], v[248:251]
    v_permlane32_swap_b32 v53, v55
    v_mfma_f32_16x16x32_bf16 v[188:191], a[0:3], a[136:139], v[188:191]
    ds_read_b64_tr_b16 a[132:133], v16 offset:16384
    ds_read_b64_tr_b16 a[134:135], v16 offset:20480
    v_mfma_f32_16x16x32_bf16 v[220:223], a[4:7], a[136:139], v[220:223]
    v_permlane16_swap_b32 v52, v53
    v_mfma_f32_16x16x32_bf16 v[252:255], a[8:11], a[136:139], v[252:255]
    s_waitcnt lgkmcnt(6)
    s_waitcnt vmcnt(32)
    v_mfma_f32_16x16x32_bf16 v[160:163], a[12:15], a[108:111], v[160:163]
    ds_read_b64_tr_b16 a[136:137], v17 offset:16384
    ds_read_b64_tr_b16 a[138:139], v17 offset:20480
    v_mfma_f32_16x16x32_bf16 v[192:195], a[16:19], a[108:111], v[192:195]
    buffer_load_dwordx4 a[0:3], v9, s[12:15], s31 offen offset:0
    v_mfma_f32_16x16x32_bf16 v[224:227], a[20:23], a[108:111], v[224:227]
    v_permlane16_swap_b32 v54, v55
    v_mfma_f32_16x16x32_bf16 v[164:167], a[12:15], a[112:115], v[164:167]
    ds_read_b64_tr_b16 a[108:109], v10 offset:24576
    ds_read_b64_tr_b16 a[110:111], v10 offset:28672
    v_mfma_f32_16x16x32_bf16 v[196:199], a[16:19], a[112:115], v[196:199]
    buffer_store_dwordx4 v[52:55], v19, s[16:19], s40 offen sc1
    v_mfma_f32_16x16x32_bf16 v[228:231], a[20:23], a[112:115], v[228:231]
    v_fmac_f32 v112, v40, v32
    v_fmac_f32 v113, v41, v32
    v_mfma_f32_16x16x32_bf16 v[168:171], a[12:15], a[116:119], v[168:171]
    ds_read_b64_tr_b16 a[112:113], v11 offset:24576
    ds_read_b64_tr_b16 a[114:115], v11 offset:28672
    v_mfma_f32_16x16x32_bf16 v[200:203], a[16:19], a[116:119], v[200:203]
    v_fmac_f32 v114, v42, v32
    v_fmac_f32 v115, v43, v32
    v_mfma_f32_16x16x32_bf16 v[232:235], a[20:23], a[116:119], v[232:235]
    buffer_load_dwordx4 a[4:7], v9, s[12:15], s31 offen offset:1024
    v_mfma_f32_16x16x32_bf16 v[172:175], a[12:15], a[120:123], v[172:175]
    ds_read_b64_tr_b16 a[116:117], v12 offset:24576
    ds_read_b64_tr_b16 a[118:119], v12 offset:28672
    v_mfma_f32_16x16x32_bf16 v[204:207], a[16:19], a[120:123], v[204:207]
    v_mul_f32 v112, v112, v114
    v_mul_f32 v113, v113, v115
    v_mfma_f32_16x16x32_bf16 v[236:239], a[20:23], a[120:123], v[236:239]
    v_cvt_pk_bf16_f32 v52, v112, v113
    s_waitcnt lgkmcnt(6)
    v_mfma_f32_16x16x32_bf16 v[176:179], a[12:15], a[124:127], v[176:179]
    ds_read_b64_tr_b16 a[120:121], v13 offset:24576
    ds_read_b64_tr_b16 a[122:123], v13 offset:28672
    v_fmac_f32 v116, v40, v33
    v_mfma_f32_16x16x32_bf16 v[208:211], a[16:19], a[124:127], v[208:211]
    v_fmac_f32 v117, v41, v33
    v_fmac_f32 v118, v42, v33
    v_mfma_f32_16x16x32_bf16 v[240:243], a[20:23], a[124:127], v[240:243]
    v_fmac_f32 v119, v43, v33
    v_mul_f32 v116, v116, v118
    v_mfma_f32_16x16x32_bf16 v[180:183], a[12:15], a[128:131], v[180:183]
    ds_read_b64_tr_b16 a[124:125], v14 offset:24576
    ds_read_b64_tr_b16 a[126:127], v14 offset:28672
    v_mfma_f32_16x16x32_bf16 v[212:215], a[16:19], a[128:131], v[212:215]
    buffer_load_dwordx4 a[8:11], v9, s[12:15], s31 offen offset:2048
    v_mfma_f32_16x16x32_bf16 v[244:247], a[20:23], a[128:131], v[244:247]
    s_add_u32 s31, s31, 3072
    v_mul_f32 v117, v117, v119
    v_mfma_f32_16x16x32_bf16 v[184:187], a[12:15], a[132:135], v[184:187]
    ds_read_b64_tr_b16 a[128:129], v15 offset:24576
    ds_read_b64_tr_b16 a[130:131], v15 offset:28672
    v_mfma_f32_16x16x32_bf16 v[216:219], a[16:19], a[132:135], v[216:219]
    v_cvt_pk_bf16_f32 v53, v116, v117
    v_fmac_f32 v120, v40, v34
    v_mfma_f32_16x16x32_bf16 v[248:251], a[20:23], a[132:135], v[248:251]
    v_fmac_f32 v121, v41, v34
    v_fmac_f32 v122, v42, v34
    v_mfma_f32_16x16x32_bf16 v[188:191], a[12:15], a[136:139], v[188:191]
    ds_read_b64_tr_b16 a[132:133], v16 offset:24576
    ds_read_b64_tr_b16 a[134:135], v16 offset:28672
    v_mfma_f32_16x16x32_bf16 v[220:223], a[16:19], a[136:139], v[220:223]
    v_fmac_f32 v123, v43, v34
    v_mul_f32 v120, v120, v122
    v_mfma_f32_16x16x32_bf16 v[252:255], a[20:23], a[136:139], v[252:255]
    s_waitcnt lgkmcnt(6)
    s_waitcnt vmcnt(33)
    v_mfma_f32_16x16x32_bf16 v[160:163], a[24:27], a[108:111], v[160:163]
    ds_read_b64_tr_b16 a[136:137], v17 offset:24576
    ds_read_b64_tr_b16 a[138:139], v17 offset:28672
    v_mul_f32 v121, v121, v123
    v_mfma_f32_16x16x32_bf16 v[192:195], a[28:31], a[108:111], v[192:195]
    buffer_load_dwordx4 a[12:15], v9, s[12:15], s31 offen offset:0
    v_mfma_f32_16x16x32_bf16 v[224:227], a[32:35], a[108:111], v[224:227]
    v_cvt_pk_bf16_f32 v54, v120, v121
    v_fmac_f32 v124, v40, v35
    v_mfma_f32_16x16x32_bf16 v[164:167], a[24:27], a[112:115], v[164:167]
    ds_read_b64_tr_b16 a[108:109], v10 offset:32768
    ds_read_b64_tr_b16 a[110:111], v10 offset:36864
    v_mfma_f32_16x16x32_bf16 v[196:199], a[28:31], a[112:115], v[196:199]
    v_fmac_f32 v125, v41, v35
    v_fmac_f32 v126, v42, v35
    v_mfma_f32_16x16x32_bf16 v[228:231], a[32:35], a[112:115], v[228:231]
    v_fmac_f32 v127, v43, v35
    v_mul_f32 v124, v124, v126
    v_mfma_f32_16x16x32_bf16 v[168:171], a[24:27], a[116:119], v[168:171]
    ds_read_b64_tr_b16 a[112:113], v11 offset:32768
    ds_read_b64_tr_b16 a[114:115], v11 offset:36864
    v_mfma_f32_16x16x32_bf16 v[200:203], a[28:31], a[116:119], v[200:203]
    buffer_load_dwordx4 a[16:19], v9, s[12:15], s31 offen offset:1024
    v_mfma_f32_16x16x32_bf16 v[232:235], a[32:35], a[116:119], v[232:235]
    v_mul_f32 v125, v125, v127
    v_cvt_pk_bf16_f32 v55, v124, v125
    v_mfma_f32_16x16x32_bf16 v[172:175], a[24:27], a[120:123], v[172:175]
    ds_read_b64_tr_b16 a[116:117], v12 offset:32768
    ds_read_b64_tr_b16 a[118:119], v12 offset:36864
    v_mfma_f32_16x16x32_bf16 v[204:207], a[28:31], a[120:123], v[204:207]
    v_permlane32_swap_b32 v52, v54
    v_mfma_f32_16x16x32_bf16 v[236:239], a[32:35], a[120:123], v[236:239]
    s_waitcnt lgkmcnt(6)
    v_mfma_f32_16x16x32_bf16 v[176:179], a[24:27], a[124:127], v[176:179]
    ds_read_b64_tr_b16 a[120:121], v13 offset:32768
    ds_read_b64_tr_b16 a[122:123], v13 offset:36864
    v_mfma_f32_16x16x32_bf16 v[208:211], a[28:31], a[124:127], v[208:211]
    buffer_load_dwordx4 a[20:23], v9, s[12:15], s31 offen offset:2048
    v_mfma_f32_16x16x32_bf16 v[240:243], a[32:35], a[124:127], v[240:243]
    s_add_u32 s31, s31, 3072
    v_mfma_f32_16x16x32_bf16 v[180:183], a[24:27], a[128:131], v[180:183]
    ds_read_b64_tr_b16 a[124:125], v14 offset:32768
    ds_read_b64_tr_b16 a[126:127], v14 offset:36864
    v_mfma_f32_16x16x32_bf16 v[212:215], a[28:31], a[128:131], v[212:215]
    v_permlane32_swap_b32 v53, v55
    v_mfma_f32_16x16x32_bf16 v[244:247], a[32:35], a[128:131], v[244:247]
    v_mfma_f32_16x16x32_bf16 v[184:187], a[24:27], a[132:135], v[184:187]
    ds_read_b64_tr_b16 a[128:129], v15 offset:32768
    ds_read_b64_tr_b16 a[130:131], v15 offset:36864
    v_mfma_f32_16x16x32_bf16 v[216:219], a[28:31], a[132:135], v[216:219]
    buffer_store_dwordx4 a[252:255], v9, s[16:19], s35 offen offset:2048 sc1
    v_mfma_f32_16x16x32_bf16 v[248:251], a[32:35], a[132:135], v[248:251]
    v_permlane16_swap_b32 v52, v53
    v_mfma_f32_16x16x32_bf16 v[188:191], a[24:27], a[136:139], v[188:191]
    ds_read_b64_tr_b16 a[132:133], v16 offset:32768
    ds_read_b64_tr_b16 a[134:135], v16 offset:36864
    v_mfma_f32_16x16x32_bf16 v[220:223], a[28:31], a[136:139], v[220:223]
    v_permlane16_swap_b32 v54, v55
    v_mfma_f32_16x16x32_bf16 v[252:255], a[32:35], a[136:139], v[252:255]
    s_waitcnt lgkmcnt(6)
    s_waitcnt vmcnt(32)
    v_mfma_f32_16x16x32_bf16 v[160:163], a[36:39], a[108:111], v[160:163]
    ds_read_b64_tr_b16 a[136:137], v17 offset:32768
    ds_read_b64_tr_b16 a[138:139], v17 offset:36864
    v_add_u32 v3, s59, v9
    v_mfma_f32_16x16x32_bf16 v[192:195], a[40:43], a[108:111], v[192:195]
    buffer_load_dwordx4 a[24:27], v9, s[12:15], s31 offen offset:0
    v_mfma_f32_16x16x32_bf16 v[224:227], a[44:47], a[108:111], v[224:227]
    v_and_b32 v4, 15, v2
    v_lshlrev_b32 v4, 2, v4
    v_mfma_f32_16x16x32_bf16 v[164:167], a[36:39], a[112:115], v[164:167]
    ds_read_b64_tr_b16 a[108:109], v10 offset:40960
    ds_read_b64_tr_b16 a[110:111], v10 offset:45056
    v_mfma_f32_16x16x32_bf16 v[196:199], a[40:43], a[112:115], v[196:199]
    v_lshlrev_b32 v5, 16, v2
    v_mov_b32 v6, 1
    v_mfma_f32_16x16x32_bf16 v[228:231], a[44:47], a[112:115], v[228:231]
    s_waitcnt vmcnt(27)
    s_waitcnt vmcnt(18)
    v_mfma_f32_16x16x32_bf16 v[168:171], a[36:39], a[116:119], v[168:171]
    ds_read_b64_tr_b16 a[112:113], v11 offset:40960
    ds_read_b64_tr_b16 a[114:115], v11 offset:45056
    v_mfma_f32_16x16x32_bf16 v[200:203], a[40:43], a[116:119], v[200:203]
    v_add_f32_dpp v56, v56, v56 quad_perm:[1,0,3,2] row_mask:0xf bank_mask:0xf
    v_add_f32_dpp v57, v57, v57 quad_perm:[1,0,3,2] row_mask:0xf bank_mask:0xf
    v_mfma_f32_16x16x32_bf16 v[232:235], a[44:47], a[116:119], v[232:235]
    buffer_load_dwordx4 a[28:31], v9, s[12:15], s31 offen offset:1024
    v_mfma_f32_16x16x32_bf16 v[172:175], a[36:39], a[120:123], v[172:175]
    ds_read_b64_tr_b16 a[116:117], v12 offset:40960
    ds_read_b64_tr_b16 a[118:119], v12 offset:45056
    v_mfma_f32_16x16x32_bf16 v[204:207], a[40:43], a[120:123], v[204:207]
    v_add_f32_dpp v58, v58, v58 quad_perm:[1,0,3,2] row_mask:0xf bank_mask:0xf
    v_add_f32_dpp v59, v59, v59 quad_perm:[1,0,3,2] row_mask:0xf bank_mask:0xf
    v_mfma_f32_16x16x32_bf16 v[236:239], a[44:47], a[120:123], v[236:239]
    v_add_f32_dpp v60, v60, v60 quad_perm:[1,0,3,2] row_mask:0xf bank_mask:0xf
    s_waitcnt lgkmcnt(6)
    v_mfma_f32_16x16x32_bf16 v[176:179], a[36:39], a[124:127], v[176:179]
    ds_read_b64_tr_b16 a[120:121], v13 offset:40960
    ds_read_b64_tr_b16 a[122:123], v13 offset:45056
    v_add_f32_dpp v61, v61, v61 quad_perm:[1,0,3,2] row_mask:0xf bank_mask:0xf
    v_mfma_f32_16x16x32_bf16 v[208:211], a[40:43], a[124:127], v[208:211]
    v_add_f32_dpp v62, v62, v62 quad_perm:[1,0,3,2] row_mask:0xf bank_mask:0xf
    v_add_f32_dpp v63, v63, v63 quad_perm:[1,0,3,2] row_mask:0xf bank_mask:0xf
    v_mfma_f32_16x16x32_bf16 v[240:243], a[44:47], a[124:127], v[240:243]
    v_add_f32_dpp v20, v20, v20 quad_perm:[1,0,3,2] row_mask:0xf bank_mask:0xf
    v_add_f32_dpp v21, v21, v21 quad_perm:[1,0,3,2] row_mask:0xf bank_mask:0xf
    v_mfma_f32_16x16x32_bf16 v[180:183], a[36:39], a[128:131], v[180:183]
    ds_read_b64_tr_b16 a[124:125], v14 offset:40960
    ds_read_b64_tr_b16 a[126:127], v14 offset:45056
    v_mfma_f32_16x16x32_bf16 v[212:215], a[40:43], a[128:131], v[212:215]
    buffer_load_dwordx4 a[32:35], v9, s[12:15], s31 offen offset:2048
    v_mfma_f32_16x16x32_bf16 v[244:247], a[44:47], a[128:131], v[244:247]
    s_add_u32 s31, s31, 3072
    v_add_f32_dpp v22, v22, v22 quad_perm:[1,0,3,2] row_mask:0xf bank_mask:0xf
    v_mfma_f32_16x16x32_bf16 v[184:187], a[36:39], a[132:135], v[184:187]
    ds_read_b64_tr_b16 a[128:129], v15 offset:40960
    ds_read_b64_tr_b16 a[130:131], v15 offset:45056
    v_mfma_f32_16x16x32_bf16 v[216:219], a[40:43], a[132:135], v[216:219]
    v_add_f32_dpp v23, v23, v23 quad_perm:[1,0,3,2] row_mask:0xf bank_mask:0xf
    v_add_f32_dpp v56, v56, v56 quad_perm:[2,3,0,1] row_mask:0xf bank_mask:0xf
    v_mfma_f32_16x16x32_bf16 v[248:251], a[44:47], a[132:135], v[248:251]
    v_add_f32_dpp v57, v57, v57 quad_perm:[2,3,0,1] row_mask:0xf bank_mask:0xf
    v_add_f32_dpp v58, v58, v58 quad_perm:[2,3,0,1] row_mask:0xf bank_mask:0xf
    v_mfma_f32_16x16x32_bf16 v[188:191], a[36:39], a[136:139], v[188:191]
    ds_read_b64_tr_b16 a[132:133], v16 offset:40960
    ds_read_b64_tr_b16 a[134:135], v16 offset:45056
    v_mfma_f32_16x16x32_bf16 v[220:223], a[40:43], a[136:139], v[220:223]
    v_add_f32_dpp v59, v59, v59 quad_perm:[2,3,0,1] row_mask:0xf bank_mask:0xf
    v_add_f32_dpp v60, v60, v60 quad_perm:[2,3,0,1] row_mask:0xf bank_mask:0xf
    v_mfma_f32_16x16x32_bf16 v[252:255], a[44:47], a[136:139], v[252:255]
    v_add_f32_dpp v61, v61, v61 quad_perm:[2,3,0,1] row_mask:0xf bank_mask:0xf
    s_waitcnt lgkmcnt(6)
    v_mfma_f32_16x16x32_bf16 v[160:163], a[48:51], a[108:111], v[160:163]
    ds_read_b64_tr_b16 a[136:137], v17 offset:40960
    ds_read_b64_tr_b16 a[138:139], v17 offset:45056
    v_add_f32_dpp v62, v62, v62 quad_perm:[2,3,0,1] row_mask:0xf bank_mask:0xf
    v_mfma_f32_16x16x32_bf16 v[192:195], a[52:55], a[108:111], v[192:195]
    buffer_load_dwordx4 a[36:39], v9, s[12:15], s31 offen offset:0
    v_mfma_f32_16x16x32_bf16 v[224:227], a[56:59], a[108:111], v[224:227]
    v_add_f32_dpp v63, v63, v63 quad_perm:[2,3,0,1] row_mask:0xf bank_mask:0xf
    v_add_f32_dpp v20, v20, v20 quad_perm:[2,3,0,1] row_mask:0xf bank_mask:0xf
    v_mfma_f32_16x16x32_bf16 v[164:167], a[48:51], a[112:115], v[164:167]
    ds_read_b64_tr_b16 a[108:109], v10 offset:49152
    ds_read_b64_tr_b16 a[110:111], v10 offset:53248
    v_mfma_f32_16x16x32_bf16 v[196:199], a[52:55], a[112:115], v[196:199]
    v_add_f32_dpp v21, v21, v21 quad_perm:[2,3,0,1] row_mask:0xf bank_mask:0xf
    v_add_f32_dpp v22, v22, v22 quad_perm:[2,3,0,1] row_mask:0xf bank_mask:0xf
    v_mfma_f32_16x16x32_bf16 v[228:231], a[56:59], a[112:115], v[228:231]
    v_add_f32_dpp v23, v23, v23 quad_perm:[2,3,0,1] row_mask:0xf bank_mask:0xf
    v_add_f32_dpp v56, v56, v56 row_half_mirror row_mask:0xf bank_mask:0xf
    v_mfma_f32_16x16x32_bf16 v[168:171], a[48:51], a[116:119], v[168:171]
    ds_read_b64_tr_b16 a[112:113], v11 offset:49152
    ds_read_b64_tr_b16 a[114:115], v11 offset:53248
    v_mfma_f32_16x16x32_bf16 v[200:203], a[52:55], a[116:119], v[200:203]
    buffer_load_dwordx4 a[40:43], v9, s[12:15], s31 offen offset:1024
    v_mfma_f32_16x16x32_bf16 v[232:235], a[56:59], a[116:119], v[232:235]
    v_add_f32_dpp v57, v57, v57 row_half_mirror row_mask:0xf bank_mask:0xf
    v_add_f32_dpp v58, v58, v58 row_half_mirror row_mask:0xf bank_mask:0xf
    v_mfma_f32_16x16x32_bf16 v[172:175], a[48:51], a[120:123], v[172:175]
    ds_read_b64_tr_b16 a[116:117], v12 offset:49152
    ds_read_b64_tr_b16 a[118:119], v12 offset:53248
    v_mfma_f32_16x16x32_bf16 v[204:207], a[52:55], a[120:123], v[204:207]
    v_add_f32_dpp v59, v59, v59 row_half_mirror row_mask:0xf bank_mask:0xf
    v_add_f32_dpp v60, v60, v60 row_half_mirror row_mask:0xf bank_mask:0xf
    v_mfma_f32_16x16x32_bf16 v[236:239], a[56:59], a[120:123], v[236:239]
    v_add_f32_dpp v61, v61, v61 row_half_mirror row_mask:0xf bank_mask:0xf
    s_waitcnt lgkmcnt(6)
    v_mfma_f32_16x16x32_bf16 v[176:179], a[48:51], a[124:127], v[176:179]
    ds_read_b64_tr_b16 a[120:121], v13 offset:49152
    ds_read_b64_tr_b16 a[122:123], v13 offset:53248
    v_add_f32_dpp v62, v62, v62 row_half_mirror row_mask:0xf bank_mask:0xf
    v_mfma_f32_16x16x32_bf16 v[208:211], a[52:55], a[124:127], v[208:211]
    buffer_load_dwordx4 a[44:47], v9, s[12:15], s31 offen offset:2048
    v_mfma_f32_16x16x32_bf16 v[240:243], a[56:59], a[124:127], v[240:243]
    s_add_u32 s31, s31, 3072
    v_add_f32_dpp v63, v63, v63 row_half_mirror row_mask:0xf bank_mask:0xf
    v_mfma_f32_16x16x32_bf16 v[180:183], a[48:51], a[128:131], v[180:183]
    ds_read_b64_tr_b16 a[124:125], v14 offset:49152
    ds_read_b64_tr_b16 a[126:127], v14 offset:53248
    v_mfma_f32_16x16x32_bf16 v[212:215], a[52:55], a[128:131], v[212:215]
    v_add_f32_dpp v20, v20, v20 row_half_mirror row_mask:0xf bank_mask:0xf
    v_add_f32_dpp v21, v21, v21 row_half_mirror row_mask:0xf bank_mask:0xf
    v_mfma_f32_16x16x32_bf16 v[244:247], a[56:59], a[128:131], v[244:247]
    v_add_f32_dpp v22, v22, v22 row_half_mirror row_mask:0xf bank_mask:0xf
    v_add_f32_dpp v23, v23, v23 row_half_mirror row_mask:0xf bank_mask:0xf
    v_mfma_f32_16x16x32_bf16 v[184:187], a[48:51], a[132:135], v[184:187]
    ds_read_b64_tr_b16 a[128:129], v15 offset:49152
    ds_read_b64_tr_b16 a[130:131], v15 offset:53248
    v_mfma_f32_16x16x32_bf16 v[216:219], a[52:55], a[132:135], v[216:219]
    buffer_store_dwordx4 a[252:255], v9, s[16:19], s35 offen offset:3072 sc1
    v_mfma_f32_16x16x32_bf16 v[248:251], a[56:59], a[132:135], v[248:251]
    buffer_store_dwordx4 v[52:55], v19, s[16:19], s41 offen sc1
    v_mfma_f32_16x16x32_bf16 v[188:191], a[48:51], a[136:139], v[188:191]
    ds_read_b64_tr_b16 a[132:133], v16 offset:49152
    ds_read_b64_tr_b16 a[134:135], v16 offset:53248
    v_mfma_f32_16x16x32_bf16 v[220:223], a[52:55], a[136:139], v[220:223]
    v_fmac_f32 v144, v44, v32
    v_fmac_f32 v145, v45, v32
    v_mfma_f32_16x16x32_bf16 v[252:255], a[56:59], a[136:139], v[252:255]
    v_fmac_f32 v146, v46, v32
    s_waitcnt lgkmcnt(6)
    v_mfma_f32_16x16x32_bf16 v[160:163], a[60:63], a[108:111], v[160:163]
    ds_read_b64_tr_b16 a[136:137], v17 offset:49152
    ds_read_b64_tr_b16 a[138:139], v17 offset:53248
    v_fmac_f32 v147, v47, v32
    v_mfma_f32_16x16x32_bf16 v[192:195], a[64:67], a[108:111], v[192:195]
    buffer_load_dwordx4 a[48:51], v9, s[12:15], s31 offen offset:0
    v_mfma_f32_16x16x32_bf16 v[224:227], a[68:71], a[108:111], v[224:227]
    v_mul_f32 v144, v144, v146
    v_mul_f32 v145, v145, v147
    v_mfma_f32_16x16x32_bf16 v[164:167], a[60:63], a[112:115], v[164:167]
    ds_read_b64_tr_b16 a[108:109], v10 offset:57344
    ds_read_b64_tr_b16 a[110:111], v10 offset:61440
    v_mfma_f32_16x16x32_bf16 v[196:199], a[64:67], a[112:115], v[196:199]
    v_add_u32 v10, 0x10000, v10
    v_cvt_pk_bf16_f32 v52, v144, v145
    v_mfma_f32_16x16x32_bf16 v[228:231], a[68:71], a[112:115], v[228:231]
    v_fmac_f32 v148, v44, v33
    v_fmac_f32 v149, v45, v33
    v_mfma_f32_16x16x32_bf16 v[168:171], a[60:63], a[116:119], v[168:171]
    ds_read_b64_tr_b16 a[112:113], v11 offset:57344
    ds_read_b64_tr_b16 a[114:115], v11 offset:61440
    v_mfma_f32_16x16x32_bf16 v[200:203], a[64:67], a[116:119], v[200:203]
    v_add_u32 v11, 0x10000, v11
    v_fmac_f32 v150, v46, v33
    v_mfma_f32_16x16x32_bf16 v[232:235], a[68:71], a[116:119], v[232:235]
    buffer_load_dwordx4 a[52:55], v9, s[12:15], s31 offen offset:1024
    v_mfma_f32_16x16x32_bf16 v[172:175], a[60:63], a[120:123], v[172:175]
    ds_read_b64_tr_b16 a[116:117], v12 offset:57344
    ds_read_b64_tr_b16 a[118:119], v12 offset:61440
    v_mfma_f32_16x16x32_bf16 v[204:207], a[64:67], a[120:123], v[204:207]
    v_add_u32 v12, 0x10000, v12
    v_fmac_f32 v151, v47, v33
    v_mfma_f32_16x16x32_bf16 v[236:239], a[68:71], a[120:123], v[236:239]
    v_mul_f32 v148, v148, v150
    s_waitcnt lgkmcnt(6)
    v_mfma_f32_16x16x32_bf16 v[176:179], a[60:63], a[124:127], v[176:179]
    ds_read_b64_tr_b16 a[120:121], v13 offset:57344
    ds_read_b64_tr_b16 a[122:123], v13 offset:61440
    v_mul_f32 v149, v149, v151
    v_mfma_f32_16x16x32_bf16 v[208:211], a[64:67], a[124:127], v[208:211]
    v_add_u32 v13, 0x10000, v13
    v_cvt_pk_bf16_f32 v53, v148, v149
    v_mfma_f32_16x16x32_bf16 v[240:243], a[68:71], a[124:127], v[240:243]
    v_fmac_f32 v152, v44, v34
    v_fmac_f32 v153, v45, v34
    v_mfma_f32_16x16x32_bf16 v[180:183], a[60:63], a[128:131], v[180:183]
    ds_read_b64_tr_b16 a[124:125], v14 offset:57344
    ds_read_b64_tr_b16 a[126:127], v14 offset:61440
    v_mfma_f32_16x16x32_bf16 v[212:215], a[64:67], a[128:131], v[212:215]
    v_add_u32 v14, 0x10000, v14
    v_fmac_f32 v154, v46, v34
    v_mfma_f32_16x16x32_bf16 v[244:247], a[68:71], a[128:131], v[244:247]
    buffer_load_dwordx4 a[56:59], v9, s[12:15], s31 offen offset:2048
    v_mfma_f32_16x16x32_bf16 v[184:187], a[60:63], a[132:135], v[184:187]
    ds_read_b64_tr_b16 a[128:129], v15 offset:57344
    ds_read_b64_tr_b16 a[130:131], v15 offset:61440
    v_mfma_f32_16x16x32_bf16 v[216:219], a[64:67], a[132:135], v[216:219]
    v_add_u32 v15, 0x10000, v15
    s_add_u32 s31, s31, 3072
    v_mfma_f32_16x16x32_bf16 v[248:251], a[68:71], a[132:135], v[248:251]
    v_fmac_f32 v155, v47, v34
    v_mul_f32 v152, v152, v154
    v_mfma_f32_16x16x32_bf16 v[188:191], a[60:63], a[136:139], v[188:191]
    ds_read_b64_tr_b16 a[132:133], v16 offset:57344
    ds_read_b64_tr_b16 a[134:135], v16 offset:61440
    v_mfma_f32_16x16x32_bf16 v[220:223], a[64:67], a[136:139], v[220:223]
    v_add_u32 v16, 0x10000, v16
    v_mul_f32 v153, v153, v155
    v_mfma_f32_16x16x32_bf16 v[252:255], a[68:71], a[136:139], v[252:255]
    v_cvt_pk_bf16_f32 v54, v152, v153
    s_waitcnt lgkmcnt(6)
    v_mfma_f32_16x16x32_bf16 v[160:163], a[72:75], a[108:111], v[160:163]
    ds_read_b64_tr_b16 a[136:137], v17 offset:57344
    ds_read_b64_tr_b16 a[138:139], v17 offset:61440
    v_fmac_f32 v156, v44, v35
    v_mfma_f32_16x16x32_bf16 v[192:195], a[76:79], a[108:111], v[192:195]
    v_add_u32 v17, 0x10000, v17
    v_fmac_f32 v157, v45, v35
    v_mfma_f32_16x16x32_bf16 v[224:227], a[80:83], a[108:111], v[224:227]
    buffer_load_dwordx4 a[60:63], v9, s[12:15], s31 offen offset:0
    v_mfma_f32_16x16x32_bf16 v[164:167], a[72:75], a[112:115], v[164:167]
    ds_read_b64_tr_b16 a[108:109], v10 offset:0
    ds_read_b64_tr_b16 a[110:111], v10 offset:4096
    v_mfma_f32_16x16x32_bf16 v[196:199], a[76:79], a[112:115], v[196:199]
    v_fmac_f32 v158, v46, v35
    v_fmac_f32 v159, v47, v35
    v_mfma_f32_16x16x32_bf16 v[228:231], a[80:83], a[112:115], v[228:231]
    v_mul_f32 v156, v156, v158
    v_mul_f32 v157, v157, v159
    v_mfma_f32_16x16x32_bf16 v[168:171], a[72:75], a[116:119], v[168:171]
    ds_read_b64_tr_b16 a[112:113], v11 offset:0
    ds_read_b64_tr_b16 a[114:115], v11 offset:4096
    v_mfma_f32_16x16x32_bf16 v[200:203], a[76:79], a[116:119], v[200:203]
    v_cvt_pk_bf16_f32 v55, v156, v157
    v_mfma_f32_16x16x32_bf16 v[232:235], a[80:83], a[116:119], v[232:235]
    buffer_load_dwordx4 a[64:67], v9, s[12:15], s31 offen offset:1024
    v_mfma_f32_16x16x32_bf16 v[172:175], a[72:75], a[120:123], v[172:175]
    ds_read_b64_tr_b16 a[116:117], v12 offset:0
    ds_read_b64_tr_b16 a[118:119], v12 offset:4096
    v_mfma_f32_16x16x32_bf16 v[204:207], a[76:79], a[120:123], v[204:207]
    v_permlane32_swap_b32 v52, v54
    v_mfma_f32_16x16x32_bf16 v[236:239], a[80:83], a[120:123], v[236:239]
    s_waitcnt lgkmcnt(6)
    v_mfma_f32_16x16x32_bf16 v[176:179], a[72:75], a[124:127], v[176:179]
    ds_read_b64_tr_b16 a[120:121], v13 offset:0
    ds_read_b64_tr_b16 a[122:123], v13 offset:4096
    v_mfma_f32_16x16x32_bf16 v[208:211], a[76:79], a[124:127], v[208:211]
    v_permlane32_swap_b32 v53, v55
    v_mfma_f32_16x16x32_bf16 v[240:243], a[80:83], a[124:127], v[240:243]
    v_mfma_f32_16x16x32_bf16 v[180:183], a[72:75], a[128:131], v[180:183]
    ds_read_b64_tr_b16 a[124:125], v14 offset:0
    ds_read_b64_tr_b16 a[126:127], v14 offset:4096
    v_mfma_f32_16x16x32_bf16 v[212:215], a[76:79], a[128:131], v[212:215]
    buffer_load_dwordx4 a[68:71], v9, s[12:15], s31 offen offset:2048
    v_mfma_f32_16x16x32_bf16 v[244:247], a[80:83], a[128:131], v[244:247]
    s_add_u32 s31, s31, 3072
    v_mfma_f32_16x16x32_bf16 v[184:187], a[72:75], a[132:135], v[184:187]
    ds_read_b64_tr_b16 a[128:129], v15 offset:0
    ds_read_b64_tr_b16 a[130:131], v15 offset:4096
    v_mfma_f32_16x16x32_bf16 v[216:219], a[76:79], a[132:135], v[216:219]
    v_permlane16_swap_b32 v52, v53
    v_mfma_f32_16x16x32_bf16 v[248:251], a[80:83], a[132:135], v[248:251]
    v_permlane16_swap_b32 v54, v55
    v_mfma_f32_16x16x32_bf16 v[188:191], a[72:75], a[136:139], v[188:191]
    ds_read_b64_tr_b16 a[132:133], v16 offset:0
    ds_read_b64_tr_b16 a[134:135], v16 offset:4096
    v_mfma_f32_16x16x32_bf16 v[220:223], a[76:79], a[136:139], v[220:223]
    buffer_store_dwordx4 v[52:55], v19, s[16:19], s42 offen sc1
    v_mfma_f32_16x16x32_bf16 v[252:255], a[80:83], a[136:139], v[252:255]
    s_waitcnt lgkmcnt(6)
    s_waitcnt vmcnt(27)
    v_mfma_f32_16x16x32_bf16 v[160:163], a[84:87], a[108:111], v[160:163]
    ds_read_b64_tr_b16 a[136:137], v17 offset:0
    ds_read_b64_tr_b16 a[138:139], v17 offset:4096
    v_mfma_f32_16x16x32_bf16 v[192:195], a[88:91], a[108:111], v[192:195]
    buffer_load_dwordx4 a[72:75], v9, s[12:15], s31 offen offset:0
    v_mfma_f32_16x16x32_bf16 v[224:227], a[92:95], a[108:111], v[224:227]
    v_mfma_f32_16x16x32_bf16 v[164:167], a[84:87], a[112:115], v[164:167]
    ds_read_b64_tr_b16 a[108:109], v10 offset:8192
    ds_read_b64_tr_b16 a[110:111], v10 offset:12288
    v_mfma_f32_16x16x32_bf16 v[196:199], a[88:91], a[112:115], v[196:199]
    v_subrev_u32 v10, 0x20000, v10
    v_mfma_f32_16x16x32_bf16 v[228:231], a[92:95], a[112:115], v[228:231]
    v_mfma_f32_16x16x32_bf16 v[168:171], a[84:87], a[116:119], v[168:171]
    ds_read_b64_tr_b16 a[112:113], v11 offset:8192
    ds_read_b64_tr_b16 a[114:115], v11 offset:12288
    v_mfma_f32_16x16x32_bf16 v[200:203], a[88:91], a[116:119], v[200:203]
    v_subrev_u32 v11, 0x20000, v11
    v_mfma_f32_16x16x32_bf16 v[232:235], a[92:95], a[116:119], v[232:235]
    buffer_load_dwordx4 a[76:79], v9, s[12:15], s31 offen offset:1024
    v_mfma_f32_16x16x32_bf16 v[172:175], a[84:87], a[120:123], v[172:175]
    ds_read_b64_tr_b16 a[116:117], v12 offset:8192
    ds_read_b64_tr_b16 a[118:119], v12 offset:12288
    v_mfma_f32_16x16x32_bf16 v[204:207], a[88:91], a[120:123], v[204:207]
    v_subrev_u32 v12, 0x20000, v12
    v_mfma_f32_16x16x32_bf16 v[236:239], a[92:95], a[120:123], v[236:239]
    s_waitcnt lgkmcnt(6)
    v_mfma_f32_16x16x32_bf16 v[176:179], a[84:87], a[124:127], v[176:179]
    ds_read_b64_tr_b16 a[120:121], v13 offset:8192
    ds_read_b64_tr_b16 a[122:123], v13 offset:12288
    v_mfma_f32_16x16x32_bf16 v[208:211], a[88:91], a[124:127], v[208:211]
    v_subrev_u32 v13, 0x20000, v13
    v_mfma_f32_16x16x32_bf16 v[240:243], a[92:95], a[124:127], v[240:243]
    v_mfma_f32_16x16x32_bf16 v[180:183], a[84:87], a[128:131], v[180:183]
    ds_read_b64_tr_b16 a[124:125], v14 offset:8192
    ds_read_b64_tr_b16 a[126:127], v14 offset:12288
    v_mfma_f32_16x16x32_bf16 v[212:215], a[88:91], a[128:131], v[212:215]
    v_subrev_u32 v14, 0x20000, v14
    v_mfma_f32_16x16x32_bf16 v[244:247], a[92:95], a[128:131], v[244:247]
    buffer_load_dwordx4 a[80:83], v9, s[12:15], s31 offen offset:2048
    v_mfma_f32_16x16x32_bf16 v[184:187], a[84:87], a[132:135], v[184:187]
    ds_read_b64_tr_b16 a[128:129], v15 offset:8192
    ds_read_b64_tr_b16 a[130:131], v15 offset:12288
    v_mfma_f32_16x16x32_bf16 v[216:219], a[88:91], a[132:135], v[216:219]
    v_subrev_u32 v15, 0x20000, v15
    s_add_u32 s31, s31, 3072
    v_mfma_f32_16x16x32_bf16 v[248:251], a[92:95], a[132:135], v[248:251]
    v_mfma_f32_16x16x32_bf16 v[188:191], a[84:87], a[136:139], v[188:191]
    ds_read_b64_tr_b16 a[132:133], v16 offset:8192
    ds_read_b64_tr_b16 a[134:135], v16 offset:12288
    v_mfma_f32_16x16x32_bf16 v[220:223], a[88:91], a[136:139], v[220:223]
    v_subrev_u32 v16, 0x20000, v16
    v_mfma_f32_16x16x32_bf16 v[252:255], a[92:95], a[136:139], v[252:255]
    s_waitcnt lgkmcnt(6)
    s_waitcnt vmcnt(27)
    v_mfma_f32_16x16x32_bf16 v[160:163], a[96:99], a[108:111], v[160:163]
    ds_read_b64_tr_b16 a[136:137], v17 offset:8192
    ds_read_b64_tr_b16 a[138:139], v17 offset:12288
    v_mfma_f32_16x16x32_bf16 v[192:195], a[100:103], a[108:111], v[192:195]
    v_subrev_u32 v17, 0x20000, v17
    v_mfma_f32_16x16x32_bf16 v[224:227], a[104:107], a[108:111], v[224:227]
    buffer_load_dwordx4 a[84:87], v9, s[12:15], s31 offen offset:0
    v_mfma_f32_16x16x32_bf16 v[164:167], a[96:99], a[112:115], v[164:167]
    ds_read_b64_tr_b16 a[108:109], v10 offset:0
    ds_read_b64_tr_b16 a[110:111], v10 offset:4096
    v_mfma_f32_16x16x32_bf16 v[196:199], a[100:103], a[112:115], v[196:199]
    v_mfma_f32_16x16x32_bf16 v[228:231], a[104:107], a[112:115], v[228:231]
    v_mfma_f32_16x16x32_bf16 v[168:171], a[96:99], a[116:119], v[168:171]
    ds_read_b64_tr_b16 a[112:113], v11 offset:0
    ds_read_b64_tr_b16 a[114:115], v11 offset:4096
    v_mfma_f32_16x16x32_bf16 v[200:203], a[100:103], a[116:119], v[200:203]
    v_mfma_f32_16x16x32_bf16 v[232:235], a[104:107], a[116:119], v[232:235]
    buffer_load_dwordx4 a[88:91], v9, s[12:15], s31 offen offset:1024
    v_mfma_f32_16x16x32_bf16 v[172:175], a[96:99], a[120:123], v[172:175]
    ds_read_b64_tr_b16 a[116:117], v12 offset:0
    ds_read_b64_tr_b16 a[118:119], v12 offset:4096
    v_mfma_f32_16x16x32_bf16 v[204:207], a[100:103], a[120:123], v[204:207]
    v_mfma_f32_16x16x32_bf16 v[236:239], a[104:107], a[120:123], v[236:239]
    s_waitcnt lgkmcnt(6)
    v_mfma_f32_16x16x32_bf16 v[176:179], a[96:99], a[124:127], v[176:179]
    ds_read_b64_tr_b16 a[120:121], v13 offset:0
    ds_read_b64_tr_b16 a[122:123], v13 offset:4096
    v_mfma_f32_16x16x32_bf16 v[208:211], a[100:103], a[124:127], v[208:211]
    v_mfma_f32_16x16x32_bf16 v[240:243], a[104:107], a[124:127], v[240:243]
    v_mfma_f32_16x16x32_bf16 v[180:183], a[96:99], a[128:131], v[180:183]
    ds_read_b64_tr_b16 a[124:125], v14 offset:0
    ds_read_b64_tr_b16 a[126:127], v14 offset:4096
    v_mfma_f32_16x16x32_bf16 v[212:215], a[100:103], a[128:131], v[212:215]
    buffer_load_dwordx4 a[92:95], v9, s[12:15], s31 offen offset:2048
    v_mfma_f32_16x16x32_bf16 v[244:247], a[104:107], a[128:131], v[244:247]
    s_add_u32 s31, s31, 3072
    v_mfma_f32_16x16x32_bf16 v[184:187], a[96:99], a[132:135], v[184:187]
    ds_read_b64_tr_b16 a[128:129], v15 offset:0
    ds_read_b64_tr_b16 a[130:131], v15 offset:4096
    v_mfma_f32_16x16x32_bf16 v[216:219], a[100:103], a[132:135], v[216:219]
    v_mfma_f32_16x16x32_bf16 v[248:251], a[104:107], a[132:135], v[248:251]
    v_mfma_f32_16x16x32_bf16 v[188:191], a[96:99], a[136:139], v[188:191]
    ds_read_b64_tr_b16 a[132:133], v16 offset:0
    ds_read_b64_tr_b16 a[134:135], v16 offset:4096
    v_mfma_f32_16x16x32_bf16 v[220:223], a[100:103], a[136:139], v[220:223]
    v_mfma_f32_16x16x32_bf16 v[252:255], a[104:107], a[136:139], v[252:255]
    s_waitcnt lgkmcnt(6)
    s_waitcnt vmcnt(25)
    v_mfma_f32_16x16x32_bf16 v[64:67], a[0:3], a[108:111], 0
    ds_read_b64_tr_b16 a[136:137], v17 offset:0
    ds_read_b64_tr_b16 a[138:139], v17 offset:4096
    v_fmac_f32 v160, v56, v28
    v_mfma_f32_16x16x32_bf16 v[96:99], a[4:7], a[108:111], 0
    buffer_load_dwordx4 a[96:99], v9, s[12:15], s31 offen offset:0
    v_mfma_f32_16x16x32_bf16 v[128:131], a[8:11], a[108:111], 0
    v_fmac_f32 v161, v57, v28
    v_fmac_f32 v162, v58, v28
    v_mfma_f32_16x16x32_bf16 v[68:71], a[0:3], a[112:115], 0
    ds_read_b64_tr_b16 a[108:109], v10 offset:8192
    ds_read_b64_tr_b16 a[110:111], v10 offset:12288
    v_fmac_f32 v163, v59, v28
    v_mfma_f32_16x16x32_bf16 v[100:103], a[4:7], a[112:115], 0
    v_mul_f32 v160, v160, v162
    v_mul_f32 v161, v161, v163
    v_mfma_f32_16x16x32_bf16 v[132:135], a[8:11], a[112:115], 0
    v_cvt_pk_bf16_f32 v48, v160, v161
    v_fmac_f32 v164, v56, v29
    v_mfma_f32_16x16x32_bf16 v[72:75], a[0:3], a[116:119], 0
    ds_read_b64_tr_b16 a[112:113], v11 offset:8192
    ds_read_b64_tr_b16 a[114:115], v11 offset:12288
    v_fmac_f32 v165, v57, v29
    v_mfma_f32_16x16x32_bf16 v[104:107], a[4:7], a[116:119], 0
    v_fmac_f32 v166, v58, v29
    v_fmac_f32 v167, v59, v29
    v_mfma_f32_16x16x32_bf16 v[136:139], a[8:11], a[116:119], 0
    buffer_load_dwordx4 a[100:103], v9, s[12:15], s31 offen offset:1024
    v_mfma_f32_16x16x32_bf16 v[76:79], a[0:3], a[120:123], 0
    ds_read_b64_tr_b16 a[116:117], v12 offset:8192
    ds_read_b64_tr_b16 a[118:119], v12 offset:12288
    v_mul_f32 v164, v164, v166
    v_mfma_f32_16x16x32_bf16 v[108:111], a[4:7], a[120:123], 0
    v_mul_f32 v165, v165, v167
    v_cvt_pk_bf16_f32 v49, v164, v165
    v_mfma_f32_16x16x32_bf16 v[140:143], a[8:11], a[120:123], 0
    v_fmac_f32 v168, v56, v30
    s_waitcnt lgkmcnt(6)
    v_mfma_f32_16x16x32_bf16 v[80:83], a[0:3], a[124:127], 0
    ds_read_b64_tr_b16 a[120:121], v13 offset:8192
    ds_read_b64_tr_b16 a[122:123], v13 offset:12288
    v_fmac_f32 v169, v57, v30
    v_mfma_f32_16x16x32_bf16 v[112:115], a[4:7], a[124:127], 0
    v_fmac_f32 v170, v58, v30
    v_fmac_f32 v171, v59, v30
    v_mfma_f32_16x16x32_bf16 v[144:147], a[8:11], a[124:127], 0
    v_mul_f32 v168, v168, v170
    v_mul_f32 v169, v169, v171
    v_mfma_f32_16x16x32_bf16 v[84:87], a[0:3], a[128:131], 0
    ds_read_b64_tr_b16 a[124:125], v14 offset:8192
    ds_read_b64_tr_b16 a[126:127], v14 offset:12288
    v_cvt_pk_bf16_f32 v50, v168, v169
    v_mfma_f32_16x16x32_bf16 v[116:119], a[4:7], a[128:131], 0
    buffer_load_dwordx4 a[104:107], v9, s[12:15], s31 offen offset:2048
    v_mfma_f32_16x16x32_bf16 v[148:151], a[8:11], a[128:131], 0
    s_add_u32 s31, s31, 3072
    v_fmac_f32 v172, v56, v31
    v_mfma_f32_16x16x32_bf16 v[88:91], a[0:3], a[132:135], 0
    ds_read_b64_tr_b16 a[128:129], v15 offset:8192
    ds_read_b64_tr_b16 a[130:131], v15 offset:12288
    v_fmac_f32 v173, v57, v31
    v_mfma_f32_16x16x32_bf16 v[120:123], a[4:7], a[132:135], 0
    v_fmac_f32 v174, v58, v31
    v_fmac_f32 v175, v59, v31
    v_mfma_f32_16x16x32_bf16 v[152:155], a[8:11], a[132:135], 0
    v_mul_f32 v172, v172, v174
    v_mul_f32 v173, v173, v175
    v_mfma_f32_16x16x32_bf16 v[92:95], a[0:3], a[136:139], 0
    ds_read_b64_tr_b16 a[132:133], v16 offset:8192
    ds_read_b64_tr_b16 a[134:135], v16 offset:12288
    v_cvt_pk_bf16_f32 v51, v172, v173
    v_mfma_f32_16x16x32_bf16 v[124:127], a[4:7], a[136:139], 0
    v_permlane32_swap_b32 v48, v50
    v_mfma_f32_16x16x32_bf16 v[156:159], a[8:11], a[136:139], 0
    s_waitcnt lgkmcnt(6)
    s_waitcnt vmcnt(25)
    v_mfma_f32_16x16x32_bf16 v[64:67], a[12:15], a[108:111], v[64:67]
    ds_read_b64_tr_b16 a[136:137], v17 offset:8192
    ds_read_b64_tr_b16 a[138:139], v17 offset:12288
    v_fmac_f32 v176, v56, v32
    v_mfma_f32_16x16x32_bf16 v[96:99], a[16:19], a[108:111], v[96:99]
    buffer_load_dwordx4 a[0:3], v9, s[12:15], s31 offen offset:0
    v_mfma_f32_16x16x32_bf16 v[128:131], a[20:23], a[108:111], v[128:131]
    v_permlane32_swap_b32 v49, v51
    v_mfma_f32_16x16x32_bf16 v[68:71], a[12:15], a[112:115], v[68:71]
    ds_read_b64_tr_b16 a[108:109], v10 offset:16384
    ds_read_b64_tr_b16 a[110:111], v10 offset:20480
    v_fmac_f32 v177, v57, v32
    v_mfma_f32_16x16x32_bf16 v[100:103], a[16:19], a[112:115], v[100:103]
    v_permlane16_swap_b32 v48, v49
    v_mfma_f32_16x16x32_bf16 v[132:135], a[20:23], a[112:115], v[132:135]
    v_permlane16_swap_b32 v50, v51
    v_mfma_f32_16x16x32_bf16 v[72:75], a[12:15], a[116:119], v[72:75]
    ds_read_b64_tr_b16 a[112:113], v11 offset:16384
    ds_read_b64_tr_b16 a[114:115], v11 offset:20480
    v_fmac_f32 v178, v58, v32
    v_mfma_f32_16x16x32_bf16 v[104:107], a[16:19], a[116:119], v[104:107]
    buffer_store_dwordx4 v[48:51], v18, s[16:19], s43 offen sc1
    v_mfma_f32_16x16x32_bf16 v[136:139], a[20:23], a[116:119], v[136:139]
    buffer_load_dwordx4 a[4:7], v9, s[12:15], s31 offen offset:1024
    v_mfma_f32_16x16x32_bf16 v[76:79], a[12:15], a[120:123], v[76:79]
    ds_read_b64_tr_b16 a[116:117], v12 offset:16384
    ds_read_b64_tr_b16 a[118:119], v12 offset:20480
    v_fmac_f32 v192, v60, v28
    v_mfma_f32_16x16x32_bf16 v[108:111], a[16:19], a[120:123], v[108:111]
    s_waitcnt vmcnt(12)
    v_fmac_f32 v193, v61, v28
    v_mfma_f32_16x16x32_bf16 v[140:143], a[20:23], a[120:123], v[140:143]
    v_fmac_f32 v194, v62, v28
    s_waitcnt lgkmcnt(6)
    v_mfma_f32_16x16x32_bf16 v[80:83], a[12:15], a[124:127], v[80:83]
    ds_read_b64_tr_b16 a[120:121], v13 offset:16384
    ds_read_b64_tr_b16 a[122:123], v13 offset:20480
    v_fmac_f32 v195, v63, v28
    v_mfma_f32_16x16x32_bf16 v[112:115], a[16:19], a[124:127], v[112:115]
    buffer_store_dword v6, v5, s[64:67], s49 offen offset:0 sc1
    v_mfma_f32_16x16x32_bf16 v[144:147], a[20:23], a[124:127], v[144:147]
    buffer_store_dword v6, v5, s[64:67], s36 offen sc1
    v_mfma_f32_16x16x32_bf16 v[84:87], a[12:15], a[128:131], v[84:87]
    ds_read_b64_tr_b16 a[124:125], v14 offset:16384
    ds_read_b64_tr_b16 a[126:127], v14 offset:20480
    v_mul_f32 v192, v192, v194
    v_mfma_f32_16x16x32_bf16 v[116:119], a[16:19], a[128:131], v[116:119]
    buffer_load_dwordx4 a[8:11], v9, s[12:15], s31 offen offset:2048
    v_mfma_f32_16x16x32_bf16 v[148:151], a[20:23], a[128:131], v[148:151]
    s_add_u32 s31, s31, 3072
    v_mul_f32 v193, v193, v195
    v_mfma_f32_16x16x32_bf16 v[88:91], a[12:15], a[132:135], v[88:91]
    ds_read_b64_tr_b16 a[128:129], v15 offset:16384
    ds_read_b64_tr_b16 a[130:131], v15 offset:20480
    v_cvt_pk_bf16_f32 v48, v192, v193
    v_mfma_f32_16x16x32_bf16 v[120:123], a[16:19], a[132:135], v[120:123]
    v_fmac_f32 v196, v60, v29
    v_fmac_f32 v197, v61, v29
    v_mfma_f32_16x16x32_bf16 v[152:155], a[20:23], a[132:135], v[152:155]
    v_fmac_f32 v198, v62, v29
    v_fmac_f32 v199, v63, v29
    v_mfma_f32_16x16x32_bf16 v[92:95], a[12:15], a[136:139], v[92:95]
    ds_read_b64_tr_b16 a[132:133], v16 offset:16384
    ds_read_b64_tr_b16 a[134:135], v16 offset:20480
    v_mul_f32 v196, v196, v198
    v_mfma_f32_16x16x32_bf16 v[124:127], a[16:19], a[136:139], v[124:127]
    v_mul_f32 v197, v197, v199
    v_cvt_pk_bf16_f32 v49, v196, v197
    v_mfma_f32_16x16x32_bf16 v[156:159], a[20:23], a[136:139], v[156:159]
    v_fmac_f32 v200, v60, v30
    s_waitcnt lgkmcnt(6)
    v_mfma_f32_16x16x32_bf16 v[64:67], a[24:27], a[108:111], v[64:67]
    ds_read_b64_tr_b16 a[136:137], v17 offset:16384
    ds_read_b64_tr_b16 a[138:139], v17 offset:20480
    v_fmac_f32 v201, v61, v30
    v_mfma_f32_16x16x32_bf16 v[96:99], a[28:31], a[108:111], v[96:99]
    buffer_load_dwordx4 a[12:15], v9, s[12:15], s31 offen offset:0
    v_mfma_f32_16x16x32_bf16 v[128:131], a[32:35], a[108:111], v[128:131]
    v_fmac_f32 v202, v62, v30
    v_fmac_f32 v203, v63, v30
    v_mfma_f32_16x16x32_bf16 v[68:71], a[24:27], a[112:115], v[68:71]
    ds_read_b64_tr_b16 a[108:109], v10 offset:24576
    ds_read_b64_tr_b16 a[110:111], v10 offset:28672
    v_mul_f32 v200, v200, v202
    v_mfma_f32_16x16x32_bf16 v[100:103], a[28:31], a[112:115], v[100:103]
    v_mul_f32 v201, v201, v203
    v_cvt_pk_bf16_f32 v50, v200, v201
    v_mfma_f32_16x16x32_bf16 v[132:135], a[32:35], a[112:115], v[132:135]
    v_fmac_f32 v204, v60, v31
    v_fmac_f32 v205, v61, v31
    v_mfma_f32_16x16x32_bf16 v[72:75], a[24:27], a[116:119], v[72:75]
    ds_read_b64_tr_b16 a[112:113], v11 offset:24576
    ds_read_b64_tr_b16 a[114:115], v11 offset:28672
    v_fmac_f32 v206, v62, v31
    v_mfma_f32_16x16x32_bf16 v[104:107], a[28:31], a[116:119], v[104:107]
    v_fmac_f32 v207, v63, v31
    v_mul_f32 v204, v204, v206
    v_mfma_f32_16x16x32_bf16 v[136:139], a[32:35], a[116:119], v[136:139]
    buffer_load_dwordx4 a[16:19], v9, s[12:15], s31 offen offset:1024
    v_mfma_f32_16x16x32_bf16 v[76:79], a[24:27], a[120:123], v[76:79]
    ds_read_b64_tr_b16 a[116:117], v12 offset:24576
    ds_read_b64_tr_b16 a[118:119], v12 offset:28672
    v_mul_f32 v205, v205, v207
    v_mfma_f32_16x16x32_bf16 v[108:111], a[28:31], a[120:123], v[108:111]
    v_cvt_pk_bf16_f32 v51, v204, v205
    v_fmac_f32 v179, v59, v32
    v_mfma_f32_16x16x32_bf16 v[140:143], a[32:35], a[120:123], v[140:143]
    v_mul_f32 v176, v176, v178
    s_waitcnt lgkmcnt(6)
    v_mfma_f32_16x16x32_bf16 v[80:83], a[24:27], a[124:127], v[80:83]
    ds_read_b64_tr_b16 a[120:121], v13 offset:24576
    ds_read_b64_tr_b16 a[122:123], v13 offset:28672
    v_mul_f32 v177, v177, v179
    v_mfma_f32_16x16x32_bf16 v[112:115], a[28:31], a[124:127], v[112:115]
    v_permlane32_swap_b32 v48, v50
    v_mfma_f32_16x16x32_bf16 v[144:147], a[32:35], a[124:127], v[144:147]
    v_permlane32_swap_b32 v49, v51
    v_mfma_f32_16x16x32_bf16 v[84:87], a[24:27], a[128:131], v[84:87]
    ds_read_b64_tr_b16 a[124:125], v14 offset:24576
    ds_read_b64_tr_b16 a[126:127], v14 offset:28672
    v_cvt_pk_bf16_f32 v52, v176, v177
    v_mfma_f32_16x16x32_bf16 v[116:119], a[28:31], a[128:131], v[116:119]
    buffer_load_dwordx4 a[20:23], v9, s[12:15], s31 offen offset:2048
    v_mfma_f32_16x16x32_bf16 v[148:151], a[32:35], a[128:131], v[148:151]
    s_add_u32 s31, s31, 3072
    v_fmac_f32 v180, v56, v33
    v_mfma_f32_16x16x32_bf16 v[88:91], a[24:27], a[132:135], v[88:91]
    ds_read_b64_tr_b16 a[128:129], v15 offset:24576
    ds_read_b64_tr_b16 a[130:131], v15 offset:28672
    v_fmac_f32 v181, v57, v33
    v_mfma_f32_16x16x32_bf16 v[120:123], a[28:31], a[132:135], v[120:123]
    v_permlane16_swap_b32 v48, v49
    v_mfma_f32_16x16x32_bf16 v[152:155], a[32:35], a[132:135], v[152:155]
    v_permlane16_swap_b32 v50, v51
    v_mfma_f32_16x16x32_bf16 v[92:95], a[24:27], a[136:139], v[92:95]
    ds_read_b64_tr_b16 a[132:133], v16 offset:24576
    ds_read_b64_tr_b16 a[134:135], v16 offset:28672
    v_fmac_f32 v182, v58, v33
    v_mfma_f32_16x16x32_bf16 v[124:127], a[28:31], a[136:139], v[124:127]
    buffer_store_dwordx4 v[48:51], v18, s[16:19], s44 offen sc1
    v_mfma_f32_16x16x32_bf16 v[156:159], a[32:35], a[136:139], v[156:159]
    v_fmac_f32 v224, v20, v28
    s_waitcnt lgkmcnt(6)
    v_mfma_f32_16x16x32_bf16 v[64:67], a[36:39], a[108:111], v[64:67]
    ds_read_b64_tr_b16 a[136:137], v17 offset:24576
    ds_read_b64_tr_b16 a[138:139], v17 offset:28672
    v_fmac_f32 v225, v21, v28
    v_mfma_f32_16x16x32_bf16 v[96:99], a[40:43], a[108:111], v[96:99]
    buffer_load_dwordx4 a[24:27], v9, s[12:15], s31 offen offset:0
    v_mfma_f32_16x16x32_bf16 v[128:131], a[44:47], a[108:111], v[128:131]
    v_fmac_f32 v226, v22, v28
    v_fmac_f32 v227, v23, v28
    v_mfma_f32_16x16x32_bf16 v[68:71], a[36:39], a[112:115], v[68:71]
    ds_read_b64_tr_b16 a[108:109], v10 offset:32768
    ds_read_b64_tr_b16 a[110:111], v10 offset:36864
    v_mul_f32 v224, v224, v226
    v_mfma_f32_16x16x32_bf16 v[100:103], a[40:43], a[112:115], v[100:103]
    v_mul_f32 v225, v225, v227
    v_cvt_pk_bf16_f32 v48, v224, v225
    v_mfma_f32_16x16x32_bf16 v[132:135], a[44:47], a[112:115], v[132:135]
    v_fmac_f32 v228, v20, v29
    v_fmac_f32 v229, v21, v29
    v_mfma_f32_16x16x32_bf16 v[72:75], a[36:39], a[116:119], v[72:75]
    ds_read_b64_tr_b16 a[112:113], v11 offset:32768
    ds_read_b64_tr_b16 a[114:115], v11 offset:36864
    v_fmac_f32 v230, v22, v29
    v_mfma_f32_16x16x32_bf16 v[104:107], a[40:43], a[116:119], v[104:107]
    v_fmac_f32 v231, v23, v29
    v_mul_f32 v228, v228, v230
    v_mfma_f32_16x16x32_bf16 v[136:139], a[44:47], a[116:119], v[136:139]
    buffer_load_dwordx4 a[28:31], v9, s[12:15], s31 offen offset:1024
    v_mfma_f32_16x16x32_bf16 v[76:79], a[36:39], a[120:123], v[76:79]
    ds_read_b64_tr_b16 a[116:117], v12 offset:32768
    ds_read_b64_tr_b16 a[118:119], v12 offset:36864
    v_mul_f32 v229, v229, v231
    v_mfma_f32_16x16x32_bf16 v[108:111], a[40:43], a[120:123], v[108:111]
    v_cvt_pk_bf16_f32 v49, v228, v229
    v_fmac_f32 v232, v20, v30
    v_mfma_f32_16x16x32_bf16 v[140:143], a[44:47], a[120:123], v[140:143]
    v_fmac_f32 v233, v21, v30
    s_waitcnt lgkmcnt(6)
    v_mfma_f32_16x16x32_bf16 v[80:83], a[36:39], a[124:127], v[80:83]
    ds_read_b64_tr_b16 a[120:121], v13 offset:32768
    ds_read_b64_tr_b16 a[122:123], v13 offset:36864
    v_fmac_f32 v234, v22, v30
    v_mfma_f32_16x16x32_bf16 v[112:115], a[40:43], a[124:127], v[112:115]
    v_fmac_f32 v235, v23, v30
    v_mul_f32 v232, v232, v234
    v_mfma_f32_16x16x32_bf16 v[144:147], a[44:47], a[124:127], v[144:147]
    v_mul_f32 v233, v233, v235
    v_cvt_pk_bf16_f32 v50, v232, v233
    v_mfma_f32_16x16x32_bf16 v[84:87], a[36:39], a[128:131], v[84:87]
    ds_read_b64_tr_b16 a[124:125], v14 offset:32768
    ds_read_b64_tr_b16 a[126:127], v14 offset:36864
    v_fmac_f32 v236, v20, v31
    v_mfma_f32_16x16x32_bf16 v[116:119], a[40:43], a[128:131], v[116:119]
    buffer_load_dwordx4 a[32:35], v9, s[12:15], s31 offen offset:2048
    v_mfma_f32_16x16x32_bf16 v[148:151], a[44:47], a[128:131], v[148:151]
    s_add_u32 s31, s31, 3072
    v_fmac_f32 v237, v21, v31
    v_mfma_f32_16x16x32_bf16 v[88:91], a[36:39], a[132:135], v[88:91]
    ds_read_b64_tr_b16 a[128:129], v15 offset:32768
    ds_read_b64_tr_b16 a[130:131], v15 offset:36864
    v_fmac_f32 v238, v22, v31
    v_mfma_f32_16x16x32_bf16 v[120:123], a[40:43], a[132:135], v[120:123]
    v_fmac_f32 v239, v23, v31
    v_mul_f32 v236, v236, v238
    v_mfma_f32_16x16x32_bf16 v[152:155], a[44:47], a[132:135], v[152:155]
    v_mul_f32 v237, v237, v239
    v_cvt_pk_bf16_f32 v51, v236, v237
    v_mfma_f32_16x16x32_bf16 v[92:95], a[36:39], a[136:139], v[92:95]
    ds_read_b64_tr_b16 a[132:133], v16 offset:32768
    ds_read_b64_tr_b16 a[134:135], v16 offset:36864
    v_fmac_f32 v183, v59, v33
    v_mfma_f32_16x16x32_bf16 v[124:127], a[40:43], a[136:139], v[124:127]
    v_permlane32_swap_b32 v48, v50
    v_mfma_f32_16x16x32_bf16 v[156:159], a[44:47], a[136:139], v[156:159]
    v_mul_f32 v180, v180, v182
    s_waitcnt lgkmcnt(6)
    v_mfma_f32_16x16x32_bf16 v[64:67], a[48:51], a[108:111], v[64:67]
    ds_read_b64_tr_b16 a[136:137], v17 offset:32768
    ds_read_b64_tr_b16 a[138:139], v17 offset:36864
    s_barrier
    v_mfma_f32_16x16x32_bf16 v[96:99], a[52:55], a[108:111], v[96:99]
    buffer_load_dwordx4 a[36:39], v9, s[12:15], s31 offen offset:0
    v_mfma_f32_16x16x32_bf16 v[128:131], a[56:59], a[108:111], v[128:131]
    s_mov_b32 m0, s75
    v_mul_f32 v181, v181, v183
    v_mfma_f32_16x16x32_bf16 v[68:71], a[48:51], a[112:115], v[68:71]
    ds_read_b64_tr_b16 a[108:109], v10 offset:40960
    ds_read_b64_tr_b16 a[110:111], v10 offset:45056
    v_cvt_pk_bf16_f32 v53, v180, v181
    v_mfma_f32_16x16x32_bf16 v[100:103], a[52:55], a[112:115], v[100:103]
    buffer_load_dwordx4 v9, s[60:63], s99 offen offset:0 lds
    v_mfma_f32_16x16x32_bf16 v[132:135], a[56:59], a[112:115], v[132:135]
    v_permlane32_swap_b32 v49, v51
    v_mfma_f32_16x16x32_bf16 v[72:75], a[48:51], a[116:119], v[72:75]
    ds_read_b64_tr_b16 a[112:113], v11 offset:40960
    ds_read_b64_tr_b16 a[114:115], v11 offset:45056
    v_fmac_f32 v184, v56, v34
    v_mfma_f32_16x16x32_bf16 v[104:107], a[52:55], a[116:119], v[104:107]
    v_permlane16_swap_b32 v48, v49
    v_mfma_f32_16x16x32_bf16 v[136:139], a[56:59], a[116:119], v[136:139]
    buffer_load_dwordx4 a[40:43], v9, s[12:15], s31 offen offset:1024
    v_mfma_f32_16x16x32_bf16 v[76:79], a[48:51], a[120:123], v[76:79]
    ds_read_b64_tr_b16 a[116:117], v12 offset:40960
    ds_read_b64_tr_b16 a[118:119], v12 offset:45056
    v_fmac_f32 v185, v57, v34
    v_mfma_f32_16x16x32_bf16 v[108:111], a[52:55], a[120:123], v[108:111]
    v_permlane16_swap_b32 v50, v51
    v_mfma_f32_16x16x32_bf16 v[140:143], a[56:59], a[120:123], v[140:143]
    v_fmac_f32 v186, v58, v34
    s_waitcnt lgkmcnt(6)
    v_mfma_f32_16x16x32_bf16 v[80:83], a[48:51], a[124:127], v[80:83]
    ds_read_b64_tr_b16 a[120:121], v13 offset:40960
    ds_read_b64_tr_b16 a[122:123], v13 offset:45056
    v_fmac_f32 v187, v59, v34
    v_mfma_f32_16x16x32_bf16 v[112:115], a[52:55], a[124:127], v[112:115]
    buffer_load_dwordx4 v9, s[60:63], s99 offen offset:1024 lds
    v_mfma_f32_16x16x32_bf16 v[144:147], a[56:59], a[124:127], v[144:147]
    buffer_store_dwordx4 v[48:51], v18, s[16:19], s45 offen sc1
    v_mfma_f32_16x16x32_bf16 v[84:87], a[48:51], a[128:131], v[84:87]
    ds_read_b64_tr_b16 a[124:125], v14 offset:40960
    ds_read_b64_tr_b16 a[126:127], v14 offset:45056
    v_mul_f32 v184, v184, v186
    v_mfma_f32_16x16x32_bf16 v[116:119], a[52:55], a[128:131], v[116:119]
    buffer_load_dwordx4 a[44:47], v9, s[12:15], s31 offen offset:2048
    v_mfma_f32_16x16x32_bf16 v[148:151], a[56:59], a[128:131], v[148:151]
    s_add_u32 s31, s31, 3072
    v_mul_f32 v185, v185, v187
    v_mfma_f32_16x16x32_bf16 v[88:91], a[48:51], a[132:135], v[88:91]
    ds_read_b64_tr_b16 a[128:129], v15 offset:40960
    ds_read_b64_tr_b16 a[130:131], v15 offset:45056
    v_cvt_pk_bf16_f32 v54, v184, v185
    v_mfma_f32_16x16x32_bf16 v[120:123], a[52:55], a[132:135], v[120:123]
    v_fmac_f32 v188, v56, v35
    v_fmac_f32 v189, v57, v35
    v_mfma_f32_16x16x32_bf16 v[152:155], a[56:59], a[132:135], v[152:155]
    v_fmac_f32 v190, v58, v35
    v_fmac_f32 v191, v59, v35
    v_mfma_f32_16x16x32_bf16 v[92:95], a[48:51], a[136:139], v[92:95]
    ds_read_b64_tr_b16 a[132:133], v16 offset:40960
    ds_read_b64_tr_b16 a[134:135], v16 offset:45056
    v_mul_f32 v188, v188, v190
    v_mfma_f32_16x16x32_bf16 v[124:127], a[52:55], a[136:139], v[124:127]
    v_mul_f32 v189, v189, v191
    v_cvt_pk_bf16_f32 v55, v188, v189
    v_mfma_f32_16x16x32_bf16 v[156:159], a[56:59], a[136:139], v[156:159]
    s_waitcnt lgkmcnt(6)
    v_mfma_f32_16x16x32_bf16 v[64:67], a[60:63], a[108:111], v[64:67]
    ds_read_b64_tr_b16 a[136:137], v17 offset:40960
    ds_read_b64_tr_b16 a[138:139], v17 offset:45056
    v_mfma_f32_16x16x32_bf16 v[96:99], a[64:67], a[108:111], v[96:99]
    buffer_load_dwordx4 a[48:51], v9, s[12:15], s31 offen offset:0
    v_mfma_f32_16x16x32_bf16 v[128:131], a[68:71], a[108:111], v[128:131]
    buffer_load_dwordx4 v9, s[60:63], s99 offen offset:2048 lds
    v_mfma_f32_16x16x32_bf16 v[68:71], a[60:63], a[112:115], v[68:71]
    ds_read_b64_tr_b16 a[108:109], v10 offset:49152
    ds_read_b64_tr_b16 a[110:111], v10 offset:53248
    v_mfma_f32_16x16x32_bf16 v[100:103], a[64:67], a[112:115], v[100:103]
    v_permlane32_swap_b32 v52, v54
    v_mfma_f32_16x16x32_bf16 v[132:135], a[68:71], a[112:115], v[132:135]
    v_permlane32_swap_b32 v53, v55
    v_mfma_f32_16x16x32_bf16 v[72:75], a[60:63], a[116:119], v[72:75]
    ds_read_b64_tr_b16 a[112:113], v11 offset:49152
    ds_read_b64_tr_b16 a[114:115], v11 offset:53248
    v_mfma_f32_16x16x32_bf16 v[104:107], a[64:67], a[116:119], v[104:107]
    buffer_load_dwordx4 a[52:55], v9, s[12:15], s31 offen offset:1024
    v_mfma_f32_16x16x32_bf16 v[136:139], a[68:71], a[116:119], v[136:139]
    v_permlane16_swap_b32 v52, v53
    v_mfma_f32_16x16x32_bf16 v[76:79], a[60:63], a[120:123], v[76:79]
    ds_read_b64_tr_b16 a[116:117], v12 offset:49152
    ds_read_b64_tr_b16 a[118:119], v12 offset:53248
    v_mfma_f32_16x16x32_bf16 v[108:111], a[64:67], a[120:123], v[108:111]
    v_permlane16_swap_b32 v54, v55
    v_mfma_f32_16x16x32_bf16 v[140:143], a[68:71], a[120:123], v[140:143]
    s_waitcnt lgkmcnt(6)
    v_mfma_f32_16x16x32_bf16 v[80:83], a[60:63], a[124:127], v[80:83]
    ds_read_b64_tr_b16 a[120:121], v13 offset:49152
    ds_read_b64_tr_b16 a[122:123], v13 offset:53248
    v_mfma_f32_16x16x32_bf16 v[112:115], a[64:67], a[124:127], v[112:115]
    buffer_load_dwordx4 a[56:59], v9, s[12:15], s31 offen offset:2048
    v_mfma_f32_16x16x32_bf16 v[144:147], a[68:71], a[124:127], v[144:147]
    s_add_u32 s31, s31, 3072
    v_mfma_f32_16x16x32_bf16 v[84:87], a[60:63], a[128:131], v[84:87]
    ds_read_b64_tr_b16 a[124:125], v14 offset:49152
    ds_read_b64_tr_b16 a[126:127], v14 offset:53248
    v_mfma_f32_16x16x32_bf16 v[116:119], a[64:67], a[128:131], v[116:119]
    buffer_load_dwordx4 v9, s[60:63], s99 offen offset:3072 lds
    v_mfma_f32_16x16x32_bf16 v[148:151], a[68:71], a[128:131], v[148:151]
    s_add_u32 s75, s75, 16384
    s_add_u32 s99, s99, 16384
    v_mfma_f32_16x16x32_bf16 v[88:91], a[60:63], a[132:135], v[88:91]
    ds_read_b64_tr_b16 a[128:129], v15 offset:49152
    ds_read_b64_tr_b16 a[130:131], v15 offset:53248
    v_mfma_f32_16x16x32_bf16 v[120:123], a[64:67], a[132:135], v[120:123]
    buffer_load_dwordx4 v[36:39], v25, s[20:23], s51 offen offset:0
    v_mfma_f32_16x16x32_bf16 v[152:155], a[68:71], a[132:135], v[152:155]
    buffer_store_dwordx4 v[52:55], v19, s[16:19], s43 offen sc1
    v_mfma_f32_16x16x32_bf16 v[92:95], a[60:63], a[136:139], v[92:95]
    ds_read_b64_tr_b16 a[132:133], v16 offset:49152
    ds_read_b64_tr_b16 a[134:135], v16 offset:53248
    v_fmac_f32 v208, v60, v32
    v_mfma_f32_16x16x32_bf16 v[124:127], a[64:67], a[136:139], v[124:127]
    v_fmac_f32 v209, v61, v32
    v_fmac_f32 v210, v62, v32
    v_mfma_f32_16x16x32_bf16 v[156:159], a[68:71], a[136:139], v[156:159]
    s_waitcnt lgkmcnt(6)
    s_waitcnt vmcnt(32)
    v_mfma_f32_16x16x32_bf16 v[64:67], a[72:75], a[108:111], v[64:67]
    ds_read_b64_tr_b16 a[136:137], v17 offset:49152
    ds_read_b64_tr_b16 a[138:139], v17 offset:53248
    s_mov_b32 m0, s75
    v_mfma_f32_16x16x32_bf16 v[96:99], a[76:79], a[108:111], v[96:99]
    buffer_load_dwordx4 a[60:63], v9, s[12:15], s31 offen offset:0
    v_mfma_f32_16x16x32_bf16 v[128:131], a[80:83], a[108:111], v[128:131]
    buffer_load_dwordx4 v9, s[60:63], s99 offen offset:0 lds
    v_mfma_f32_16x16x32_bf16 v[68:71], a[72:75], a[112:115], v[68:71]
    ds_read_b64_tr_b16 a[108:109], v10 offset:57344
    ds_read_b64_tr_b16 a[110:111], v10 offset:61440
    v_fmac_f32 v211, v63, v32
    v_mfma_f32_16x16x32_bf16 v[100:103], a[76:79], a[112:115], v[100:103]
    v_add_u32 v10, 0x10000, v10
    v_mul_f32 v208, v208, v210
    v_mfma_f32_16x16x32_bf16 v[132:135], a[80:83], a[112:115], v[132:135]
    v_mul_f32 v209, v209, v211
    v_cvt_pk_bf16_f32 v52, v208, v209
    v_mfma_f32_16x16x32_bf16 v[72:75], a[72:75], a[116:119], v[72:75]
    ds_read_b64_tr_b16 a[112:113], v11 offset:57344
    ds_read_b64_tr_b16 a[114:115], v11 offset:61440
    v_fmac_f32 v212, v60, v33
    v_mfma_f32_16x16x32_bf16 v[104:107], a[76:79], a[116:119], v[104:107]
    v_add_u32 v11, 0x10000, v11
    v_fmac_f32 v213, v61, v33
    v_mfma_f32_16x16x32_bf16 v[136:139], a[80:83], a[116:119], v[136:139]
    buffer_load_dwordx4 a[64:67], v9, s[12:15], s31 offen offset:1024
    v_mfma_f32_16x16x32_bf16 v[76:79], a[72:75], a[120:123], v[76:79]
    ds_read_b64_tr_b16 a[116:117], v12 offset:57344
    ds_read_b64_tr_b16 a[118:119], v12 offset:61440
    v_fmac_f32 v214, v62, v33
    v_mfma_f32_16x16x32_bf16 v[108:111], a[76:79], a[120:123], v[108:111]
    v_add_u32 v12, 0x10000, v12
    v_fmac_f32 v215, v63, v33
    v_mfma_f32_16x16x32_bf16 v[140:143], a[80:83], a[120:123], v[140:143]
    v_mul_f32 v212, v212, v214
    s_waitcnt lgkmcnt(6)
    v_mfma_f32_16x16x32_bf16 v[80:83], a[72:75], a[124:127], v[80:83]
    ds_read_b64_tr_b16 a[120:121], v13 offset:57344
    ds_read_b64_tr_b16 a[122:123], v13 offset:61440
    v_mul_f32 v213, v213, v215
    v_mfma_f32_16x16x32_bf16 v[112:115], a[76:79], a[124:127], v[112:115]
    v_add_u32 v13, 0x10000, v13
    v_cvt_pk_bf16_f32 v53, v212, v213
    v_mfma_f32_16x16x32_bf16 v[144:147], a[80:83], a[124:127], v[144:147]
    buffer_load_dwordx4 a[68:71], v9, s[12:15], s31 offen offset:2048
    v_mfma_f32_16x16x32_bf16 v[84:87], a[72:75], a[128:131], v[84:87]
    ds_read_b64_tr_b16 a[124:125], v14 offset:57344
    ds_read_b64_tr_b16 a[126:127], v14 offset:61440
    s_add_u32 s31, s31, 3072
    v_mfma_f32_16x16x32_bf16 v[116:119], a[76:79], a[128:131], v[116:119]
    v_add_u32 v14, 0x10000, v14
    v_fmac_f32 v216, v60, v34
    v_mfma_f32_16x16x32_bf16 v[148:151], a[80:83], a[128:131], v[148:151]
    buffer_load_dwordx4 v9, s[60:63], s99 offen offset:1024 lds
    v_mfma_f32_16x16x32_bf16 v[88:91], a[72:75], a[132:135], v[88:91]
    ds_read_b64_tr_b16 a[128:129], v15 offset:57344
    ds_read_b64_tr_b16 a[130:131], v15 offset:61440
    v_fmac_f32 v217, v61, v34
    v_mfma_f32_16x16x32_bf16 v[120:123], a[76:79], a[132:135], v[120:123]
    v_add_u32 v15, 0x10000, v15
    v_fmac_f32 v218, v62, v34
    v_mfma_f32_16x16x32_bf16 v[152:155], a[80:83], a[132:135], v[152:155]
    buffer_load_dwordx4 v[40:43], v25, s[20:23], s51 offen offset:64
    v_mfma_f32_16x16x32_bf16 v[92:95], a[72:75], a[136:139], v[92:95]
    ds_read_b64_tr_b16 a[132:133], v16 offset:57344
    ds_read_b64_tr_b16 a[134:135], v16 offset:61440
    v_fmac_f32 v219, v63, v34
    v_mfma_f32_16x16x32_bf16 v[124:127], a[76:79], a[136:139], v[124:127]
    v_add_u32 v16, 0x10000, v16
    v_mul_f32 v216, v216, v218
    v_mfma_f32_16x16x32_bf16 v[156:159], a[80:83], a[136:139], v[156:159]
    s_waitcnt lgkmcnt(6)
    s_waitcnt vmcnt(35)
    v_mfma_f32_16x16x32_bf16 v[64:67], a[84:87], a[108:111], v[64:67]
    ds_read_b64_tr_b16 a[136:137], v17 offset:57344
    ds_read_b64_tr_b16 a[138:139], v17 offset:61440
    v_mul_f32 v217, v217, v219
    v_mfma_f32_16x16x32_bf16 v[96:99], a[88:91], a[108:111], v[96:99]
    v_add_u32 v17, 0x10000, v17
    v_cvt_pk_bf16_f32 v54, v216, v217
    v_mfma_f32_16x16x32_bf16 v[128:131], a[92:95], a[108:111], v[128:131]
    buffer_load_dwordx4 a[72:75], v9, s[12:15], s31 offen offset:0
    v_mfma_f32_16x16x32_bf16 v[68:71], a[84:87], a[112:115], v[68:71]
    ds_read_b64_tr_b16 a[108:109], v10 offset:0
    ds_read_b64_tr_b16 a[110:111], v10 offset:4096
    v_fmac_f32 v220, v60, v35
    v_mfma_f32_16x16x32_bf16 v[100:103], a[88:91], a[112:115], v[100:103]
    buffer_load_dword v7, v4, s[64:67], s50 offen offset:0 sc1
    v_mfma_f32_16x16x32_bf16 v[132:135], a[92:95], a[112:115], v[132:135]
    buffer_load_dwordx4 v9, s[60:63], s99 offen offset:2048 lds
    v_mfma_f32_16x16x32_bf16 v[72:75], a[84:87], a[116:119], v[72:75]
    ds_read_b64_tr_b16 a[112:113], v11 offset:0
    ds_read_b64_tr_b16 a[114:115], v11 offset:4096
    v_fmac_f32 v221, v61, v35
    v_mfma_f32_16x16x32_bf16 v[104:107], a[88:91], a[116:119], v[104:107]
    buffer_load_dwordx4 a[76:79], v9, s[12:15], s31 offen offset:1024
    v_mfma_f32_16x16x32_bf16 v[136:139], a[92:95], a[116:119], v[136:139]
    v_fmac_f32 v222, v62, v35
    v_fmac_f32 v223, v63, v35
    v_mfma_f32_16x16x32_bf16 v[76:79], a[84:87], a[120:123], v[76:79]
    ds_read_b64_tr_b16 a[116:117], v12 offset:0
    ds_read_b64_tr_b16 a[118:119], v12 offset:4096
    v_mul_f32 v220, v220, v222
    v_mfma_f32_16x16x32_bf16 v[108:111], a[88:91], a[120:123], v[108:111]
    v_mul_f32 v221, v221, v223
    v_cvt_pk_bf16_f32 v55, v220, v221
    v_mfma_f32_16x16x32_bf16 v[140:143], a[92:95], a[120:123], v[140:143]
    s_waitcnt lgkmcnt(6)
    v_mfma_f32_16x16x32_bf16 v[80:83], a[84:87], a[124:127], v[80:83]
    ds_read_b64_tr_b16 a[120:121], v13 offset:0
    ds_read_b64_tr_b16 a[122:123], v13 offset:4096
    v_mfma_f32_16x16x32_bf16 v[112:115], a[88:91], a[124:127], v[112:115]
    buffer_load_dwordx4 a[80:83], v9, s[12:15], s31 offen offset:2048
    v_mfma_f32_16x16x32_bf16 v[144:147], a[92:95], a[124:127], v[144:147]
    s_add_u32 s31, s31, 3072
    v_mfma_f32_16x16x32_bf16 v[84:87], a[84:87], a[128:131], v[84:87]
    ds_read_b64_tr_b16 a[124:125], v14 offset:0
    ds_read_b64_tr_b16 a[126:127], v14 offset:4096
    v_mfma_f32_16x16x32_bf16 v[116:119], a[88:91], a[128:131], v[116:119]
    buffer_load_dwordx4 v9, s[60:63], s99 offen offset:3072 lds
    v_mfma_f32_16x16x32_bf16 v[148:151], a[92:95], a[128:131], v[148:151]
    s_add_u32 s75, s75, 16384
    s_add_u32 s99, s99, 16384
    v_mfma_f32_16x16x32_bf16 v[88:91], a[84:87], a[132:135], v[88:91]
    ds_read_b64_tr_b16 a[128:129], v15 offset:0
    ds_read_b64_tr_b16 a[130:131], v15 offset:4096
    v_mfma_f32_16x16x32_bf16 v[120:123], a[88:91], a[132:135], v[120:123]
    buffer_load_dwordx4 v[44:47], v25, s[20:23], s51 offen offset:128
    v_mfma_f32_16x16x32_bf16 v[152:155], a[92:95], a[132:135], v[152:155]
    s_add_u32 s51, s51, 12288
    v_mfma_f32_16x16x32_bf16 v[92:95], a[84:87], a[136:139], v[92:95]
    ds_read_b64_tr_b16 a[132:133], v16 offset:0
    ds_read_b64_tr_b16 a[134:135], v16 offset:4096
    v_mfma_f32_16x16x32_bf16 v[124:127], a[88:91], a[136:139], v[124:127]
    v_permlane32_swap_b32 v52, v54
    v_mfma_f32_16x16x32_bf16 v[156:159], a[92:95], a[136:139], v[156:159]
    s_waitcnt lgkmcnt(6)
    s_waitcnt vmcnt(39)
    v_mfma_f32_16x16x32_bf16 v[64:67], a[96:99], a[108:111], v[64:67]
    ds_read_b64_tr_b16 a[136:137], v17 offset:0
    ds_read_b64_tr_b16 a[138:139], v17 offset:4096
    s_barrier
    v_mfma_f32_16x16x32_bf16 v[96:99], a[100:103], a[108:111], v[96:99]
    buffer_load_dwordx4 a[84:87], v9, s[12:15], s31 offen offset:0
    v_mfma_f32_16x16x32_bf16 v[128:131], a[104:107], a[108:111], v[128:131]
    s_waitcnt vmcnt(22)
    s_mov_b32 m0, s75
    v_mfma_f32_16x16x32_bf16 v[68:71], a[96:99], a[112:115], v[68:71]
    ds_read_b64_tr_b16 a[108:109], v10 offset:8192
    ds_read_b64_tr_b16 a[110:111], v10 offset:12288
    v_mfma_f32_16x16x32_bf16 v[100:103], a[100:103], a[112:115], v[100:103]
    buffer_load_dwordx4 v9, s[60:63], s99 offen offset:0 lds
    v_mfma_f32_16x16x32_bf16 v[132:135], a[104:107], a[112:115], v[132:135]
    v_permlane32_swap_b32 v53, v55
    v_mfma_f32_16x16x32_bf16 v[72:75], a[96:99], a[116:119], v[72:75]
    ds_read_b64_tr_b16 a[112:113], v11 offset:8192
    ds_read_b64_tr_b16 a[114:115], v11 offset:12288
    v_mfma_f32_16x16x32_bf16 v[104:107], a[100:103], a[116:119], v[104:107]
    v_permlane16_swap_b32 v52, v53
    v_mfma_f32_16x16x32_bf16 v[136:139], a[104:107], a[116:119], v[136:139]
    buffer_load_dwordx4 a[88:91], v9, s[12:15], s31 offen offset:1024
    v_mfma_f32_16x16x32_bf16 v[76:79], a[96:99], a[120:123], v[76:79]
    ds_read_b64_tr_b16 a[116:117], v12 offset:8192
    ds_read_b64_tr_b16 a[118:119], v12 offset:12288
    v_mfma_f32_16x16x32_bf16 v[108:111], a[100:103], a[120:123], v[108:111]
    v_permlane16_swap_b32 v54, v55
    v_mfma_f32_16x16x32_bf16 v[140:143], a[104:107], a[120:123], v[140:143]
    s_waitcnt lgkmcnt(6)
    v_mfma_f32_16x16x32_bf16 v[80:83], a[96:99], a[124:127], v[80:83]
    ds_read_b64_tr_b16 a[120:121], v13 offset:8192
    ds_read_b64_tr_b16 a[122:123], v13 offset:12288
    v_mfma_f32_16x16x32_bf16 v[112:115], a[100:103], a[124:127], v[112:115]
    buffer_load_dwordx4 v9, s[60:63], s99 offen offset:1024 lds
    v_mfma_f32_16x16x32_bf16 v[144:147], a[104:107], a[124:127], v[144:147]
    buffer_store_dwordx4 v[52:55], v19, s[16:19], s44 offen sc1
    v_mfma_f32_16x16x32_bf16 v[84:87], a[96:99], a[128:131], v[84:87]
    ds_read_b64_tr_b16 a[124:125], v14 offset:8192
    ds_read_b64_tr_b16 a[126:127], v14 offset:12288
    v_fmac_f32 v240, v20, v32
    v_mfma_f32_16x16x32_bf16 v[116:119], a[100:103], a[128:131], v[116:119]
    buffer_load_dwordx4 a[92:95], v9, s[12:15], s31 offen offset:2048
    v_mfma_f32_16x16x32_bf16 v[148:151], a[104:107], a[128:131], v[148:151]
    s_add_u32 s31, s31, 3072
    v_fmac_f32 v241, v21, v32
    v_mfma_f32_16x16x32_bf16 v[88:91], a[96:99], a[132:135], v[88:91]
    ds_read_b64_tr_b16 a[128:129], v15 offset:8192
    ds_read_b64_tr_b16 a[130:131], v15 offset:12288
    v_fmac_f32 v242, v22, v32
    v_mfma_f32_16x16x32_bf16 v[120:123], a[100:103], a[132:135], v[120:123]
    v_fmac_f32 v243, v23, v32
    v_mul_f32 v240, v240, v242
    v_mfma_f32_16x16x32_bf16 v[152:155], a[104:107], a[132:135], v[152:155]
    v_mul_f32 v241, v241, v243
    v_cvt_pk_bf16_f32 v52, v240, v241
    v_mfma_f32_16x16x32_bf16 v[92:95], a[96:99], a[136:139], v[92:95]
    ds_read_b64_tr_b16 a[132:133], v16 offset:8192
    ds_read_b64_tr_b16 a[134:135], v16 offset:12288
    v_fmac_f32 v244, v20, v33
    v_mfma_f32_16x16x32_bf16 v[124:127], a[100:103], a[136:139], v[124:127]
    v_fmac_f32 v245, v21, v33
    v_fmac_f32 v246, v22, v33
    v_mfma_f32_16x16x32_bf16 v[156:159], a[104:107], a[136:139], v[156:159]
    v_fmac_f32 v247, v23, v33
    s_waitcnt lgkmcnt(6)
    v_mfma_f32_16x16x32_bf16 v[64:67], a[0:3], a[108:111], v[64:67]
    ds_read_b64_tr_b16 a[136:137], v17 offset:8192
    ds_read_b64_tr_b16 a[138:139], v17 offset:12288
    s_waitcnt vmcnt(11)
    v_mfma_f32_16x16x32_bf16 v[96:99], a[4:7], a[108:111], v[96:99]
    buffer_load_dwordx4 a[96:99], v9, s[12:15], s31 offen offset:0
    v_mfma_f32_16x16x32_bf16 v[128:131], a[8:11], a[108:111], v[128:131]
    v_cmp_eq_u32 vcc, 0, v7
    s_nop 3
    s_cbranch_vccnz POLL_SLOW0
POLL_OK0:
    v_mfma_f32_16x16x32_bf16 v[68:71], a[0:3], a[112:115], v[68:71]
    ds_read_b64_tr_b16 a[108:109], v10 offset:16384
    ds_read_b64_tr_b16 a[110:111], v10 offset:20480
    v_mul_f32 v244, v244, v246
    v_mfma_f32_16x16x32_bf16 v[100:103], a[4:7], a[112:115], v[100:103]
    buffer_load_dwordx4 a[212:215], v1, s[16:19], s97 offen
    v_mfma_f32_16x16x32_bf16 v[132:135], a[8:11], a[112:115], v[132:135]
    buffer_load_dwordx4 a[216:219], v1, s[16:19], s98 offen
    v_mfma_f32_16x16x32_bf16 v[72:75], a[0:3], a[116:119], v[72:75]
    ds_read_b64_tr_b16 a[112:113], v11 offset:16384
    ds_read_b64_tr_b16 a[114:115], v11 offset:20480
    v_mul_f32 v245, v245, v247
    v_mfma_f32_16x16x32_bf16 v[104:107], a[4:7], a[116:119], v[104:107]
    buffer_load_dwordx4 v9, s[60:63], s99 offen offset:2048 lds
    v_mfma_f32_16x16x32_bf16 v[136:139], a[8:11], a[116:119], v[136:139]
    buffer_load_dwordx4 a[100:103], v9, s[12:15], s31 offen offset:1024
    v_mfma_f32_16x16x32_bf16 v[76:79], a[0:3], a[120:123], v[76:79]
    ds_read_b64_tr_b16 a[116:117], v12 offset:16384
    ds_read_b64_tr_b16 a[118:119], v12 offset:20480
    v_cvt_pk_bf16_f32 v53, v244, v245
    v_mfma_f32_16x16x32_bf16 v[108:111], a[4:7], a[120:123], v[108:111]
    v_fmac_f32 v248, v20, v34
    v_fmac_f32 v249, v21, v34
    v_mfma_f32_16x16x32_bf16 v[140:143], a[8:11], a[120:123], v[140:143]
    v_fmac_f32 v250, v22, v34
    s_waitcnt lgkmcnt(6)
    v_mfma_f32_16x16x32_bf16 v[80:83], a[0:3], a[124:127], v[80:83]
    ds_read_b64_tr_b16 a[120:121], v13 offset:16384
    ds_read_b64_tr_b16 a[122:123], v13 offset:20480
    v_fmac_f32 v251, v23, v34
    v_mfma_f32_16x16x32_bf16 v[112:115], a[4:7], a[124:127], v[112:115]
    buffer_load_dwordx4 a[220:223], v24, s[16:19], s97 offen
    v_mfma_f32_16x16x32_bf16 v[144:147], a[8:11], a[124:127], v[144:147]
    buffer_load_dwordx4 v9, s[60:63], s99 offen offset:3072 lds
    v_mfma_f32_16x16x32_bf16 v[84:87], a[0:3], a[128:131], v[84:87]
    ds_read_b64_tr_b16 a[124:125], v14 offset:16384
    ds_read_b64_tr_b16 a[126:127], v14 offset:20480
    s_add_u32 s75, s75, 16384
    v_mfma_f32_16x16x32_bf16 v[116:119], a[4:7], a[128:131], v[116:119]
    buffer_load_dwordx4 a[104:107], v9, s[12:15], s31 offen offset:2048
    v_mfma_f32_16x16x32_bf16 v[148:151], a[8:11], a[128:131], v[148:151]
    s_add_u32 s31, s31, 3486720
    s_add_u32 s99, s99, 16384
    v_mfma_f32_16x16x32_bf16 v[88:91], a[0:3], a[132:135], v[88:91]
    ds_read_b64_tr_b16 a[128:129], v15 offset:16384
    ds_read_b64_tr_b16 a[130:131], v15 offset:20480
    v_mul_f32 v248, v248, v250
    v_mfma_f32_16x16x32_bf16 v[120:123], a[4:7], a[132:135], v[120:123]
    buffer_load_dwordx4 a[224:227], v24, s[16:19], s98 offen
    v_mfma_f32_16x16x32_bf16 v[152:155], a[8:11], a[132:135], v[152:155]
    v_mul_f32 v249, v249, v251
    v_cvt_pk_bf16_f32 v54, v248, v249
    v_mfma_f32_16x16x32_bf16 v[92:95], a[0:3], a[136:139], v[92:95]
    ds_read_b64_tr_b16 a[132:133], v16 offset:16384
    ds_read_b64_tr_b16 a[134:135], v16 offset:20480
    v_fmac_f32 v252, v20, v35
    v_mfma_f32_16x16x32_bf16 v[124:127], a[4:7], a[136:139], v[124:127]
    buffer_load_dwordx4 a[228:231], v27, s[16:19], s97 offen
    v_mfma_f32_16x16x32_bf16 v[156:159], a[8:11], a[136:139], v[156:159]
    v_fmac_f32 v253, v21, v35
    s_waitcnt lgkmcnt(6)
    v_mfma_f32_16x16x32_bf16 v[64:67], a[12:15], a[108:111], v[64:67]
    ds_read_b64_tr_b16 a[136:137], v17 offset:16384
    ds_read_b64_tr_b16 a[138:139], v17 offset:20480
    s_mov_b32 m0, s75
    v_mfma_f32_16x16x32_bf16 v[96:99], a[16:19], a[108:111], v[96:99]
    buffer_load_dwordx4 v9, s[60:63], s99 offen offset:0 lds
    v_mfma_f32_16x16x32_bf16 v[128:131], a[20:23], a[108:111], v[128:131]
    v_fmac_f32 v254, v22, v35
    v_fmac_f32 v255, v23, v35
    v_mfma_f32_16x16x32_bf16 v[68:71], a[12:15], a[112:115], v[68:71]
    ds_read_b64_tr_b16 a[108:109], v10 offset:24576
    ds_read_b64_tr_b16 a[110:111], v10 offset:28672
    v_mul_f32 v252, v252, v254
    v_mfma_f32_16x16x32_bf16 v[100:103], a[16:19], a[112:115], v[100:103]
    buffer_load_dwordx4 a[232:235], v27, s[16:19], s98 offen
    v_mfma_f32_16x16x32_bf16 v[132:135], a[20:23], a[112:115], v[132:135]
    v_mul_f32 v253, v253, v255
    v_cvt_pk_bf16_f32 v55, v252, v253
    v_mfma_f32_16x16x32_bf16 v[72:75], a[12:15], a[116:119], v[72:75]
    ds_read_b64_tr_b16 a[112:113], v11 offset:24576
    ds_read_b64_tr_b16 a[114:115], v11 offset:28672
    v_mfma_f32_16x16x32_bf16 v[104:107], a[16:19], a[116:119], v[104:107]
    v_permlane32_swap_b32 v52, v54
    v_mfma_f32_16x16x32_bf16 v[136:139], a[20:23], a[116:119], v[136:139]
    v_permlane32_swap_b32 v53, v55
    v_mfma_f32_16x16x32_bf16 v[76:79], a[12:15], a[120:123], v[76:79]
    ds_read_b64_tr_b16 a[116:117], v12 offset:24576
    ds_read_b64_tr_b16 a[118:119], v12 offset:28672
    v_mfma_f32_16x16x32_bf16 v[108:111], a[16:19], a[120:123], v[108:111]
    buffer_load_dwordx4 a[236:239], v3, s[16:19], s97 offen
    v_mfma_f32_16x16x32_bf16 v[140:143], a[20:23], a[120:123], v[140:143]
    s_add_u32 s97, s97, 8192
    s_waitcnt lgkmcnt(6)
    v_mfma_f32_16x16x32_bf16 v[80:83], a[12:15], a[124:127], v[80:83]
    ds_read_b64_tr_b16 a[120:121], v13 offset:24576
    ds_read_b64_tr_b16 a[122:123], v13 offset:28672
    v_mfma_f32_16x16x32_bf16 v[112:115], a[16:19], a[124:127], v[112:115]
    buffer_load_dwordx4 v9, s[60:63], s99 offen offset:1024 lds
    v_mfma_f32_16x16x32_bf16 v[144:147], a[20:23], a[124:127], v[144:147]
    buffer_load_dwordx4 a[240:243], v3, s[16:19], s98 offen
    v_mfma_f32_16x16x32_bf16 v[84:87], a[12:15], a[128:131], v[84:87]
    ds_read_b64_tr_b16 a[124:125], v14 offset:24576
    ds_read_b64_tr_b16 a[126:127], v14 offset:28672
    s_add_u32 s98, s98, 8192
    v_mfma_f32_16x16x32_bf16 v[116:119], a[16:19], a[128:131], v[116:119]
    v_permlane16_swap_b32 v52, v53
    v_mfma_f32_16x16x32_bf16 v[148:151], a[20:23], a[128:131], v[148:151]
    v_permlane16_swap_b32 v54, v55
    v_mfma_f32_16x16x32_bf16 v[88:91], a[12:15], a[132:135], v[88:91]
    ds_read_b64_tr_b16 a[128:129], v15 offset:24576
    ds_read_b64_tr_b16 a[130:131], v15 offset:28672
    v_mfma_f32_16x16x32_bf16 v[120:123], a[16:19], a[132:135], v[120:123]
    buffer_store_dwordx4 v[52:55], v19, s[16:19], s45 offen sc1
    v_mfma_f32_16x16x32_bf16 v[152:155], a[20:23], a[132:135], v[152:155]
    buffer_load_dwordx4 a[244:247], v1, s[16:19], s97 offen
    v_mfma_f32_16x16x32_bf16 v[92:95], a[12:15], a[136:139], v[92:95]
    ds_read_b64_tr_b16 a[132:133], v16 offset:24576
    ds_read_b64_tr_b16 a[134:135], v16 offset:28672
    v_mfma_f32_16x16x32_bf16 v[124:127], a[16:19], a[136:139], v[124:127]
    v_mfma_f32_16x16x32_bf16 v[156:159], a[20:23], a[136:139], v[156:159]
    s_waitcnt lgkmcnt(6)
    v_mfma_f32_16x16x32_bf16 v[64:67], a[24:27], a[108:111], v[64:67]
    ds_read_b64_tr_b16 a[136:137], v17 offset:24576
    ds_read_b64_tr_b16 a[138:139], v17 offset:28672
    v_mfma_f32_16x16x32_bf16 v[96:99], a[28:31], a[108:111], v[96:99]
    buffer_load_dwordx4 a[248:251], v1, s[16:19], s98 offen
    v_mfma_f32_16x16x32_bf16 v[128:131], a[32:35], a[108:111], v[128:131]
    buffer_load_dwordx4 v9, s[60:63], s99 offen offset:2048 lds
    v_mfma_f32_16x16x32_bf16 v[68:71], a[24:27], a[112:115], v[68:71]
    ds_read_b64_tr_b16 a[108:109], v10 offset:32768
    ds_read_b64_tr_b16 a[110:111], v10 offset:36864
    v_mfma_f32_16x16x32_bf16 v[100:103], a[28:31], a[112:115], v[100:103]
    v_mfma_f32_16x16x32_bf16 v[132:135], a[32:35], a[112:115], v[132:135]
    v_mfma_f32_16x16x32_bf16 v[72:75], a[24:27], a[116:119], v[72:75]
    ds_read_b64_tr_b16 a[112:113], v11 offset:32768
    ds_read_b64_tr_b16 a[114:115], v11 offset:36864
    v_mfma_f32_16x16x32_bf16 v[104:107], a[28:31], a[116:119], v[104:107]
    buffer_load_dwordx4 a[252:255], v24, s[16:19], s97 offen
    v_mfma_f32_16x16x32_bf16 v[136:139], a[32:35], a[116:119], v[136:139]
    v_mfma_f32_16x16x32_bf16 v[76:79], a[24:27], a[120:123], v[76:79]
    ds_read_b64_tr_b16 a[116:117], v12 offset:32768
    ds_read_b64_tr_b16 a[118:119], v12 offset:36864
    v_mfma_f32_16x16x32_bf16 v[108:111], a[28:31], a[120:123], v[108:111]
    v_mfma_f32_16x16x32_bf16 v[140:143], a[32:35], a[120:123], v[140:143]
    s_waitcnt lgkmcnt(6)
    v_mfma_f32_16x16x32_bf16 v[80:83], a[24:27], a[124:127], v[80:83]
    ds_read_b64_tr_b16 a[120:121], v13 offset:32768
    ds_read_b64_tr_b16 a[122:123], v13 offset:36864
    v_mfma_f32_16x16x32_bf16 v[112:115], a[28:31], a[124:127], v[112:115]
    buffer_load_dwordx4 a[0:3], v24, s[16:19], s98 offen
    v_mfma_f32_16x16x32_bf16 v[144:147], a[32:35], a[124:127], v[144:147]
    buffer_load_dwordx4 v9, s[60:63], s99 offen offset:3072 lds
    v_mfma_f32_16x16x32_bf16 v[84:87], a[24:27], a[128:131], v[84:87]
    ds_read_b64_tr_b16 a[124:125], v14 offset:32768
    ds_read_b64_tr_b16 a[126:127], v14 offset:36864
    v_mfma_f32_16x16x32_bf16 v[116:119], a[28:31], a[128:131], v[116:119]
    s_add_u32 s75, s75, 16384
    s_add_u32 s99, s99, 16384
    v_mfma_f32_16x16x32_bf16 v[148:151], a[32:35], a[128:131], v[148:151]
    v_mfma_f32_16x16x32_bf16 v[88:91], a[24:27], a[132:135], v[88:91]
    ds_read_b64_tr_b16 a[128:129], v15 offset:32768
    ds_read_b64_tr_b16 a[130:131], v15 offset:36864
    v_mfma_f32_16x16x32_bf16 v[120:123], a[28:31], a[132:135], v[120:123]
    buffer_load_dwordx4 a[4:7], v27, s[16:19], s97 offen
    v_mfma_f32_16x16x32_bf16 v[152:155], a[32:35], a[132:135], v[152:155]
    v_mfma_f32_16x16x32_bf16 v[92:95], a[24:27], a[136:139], v[92:95]
    ds_read_b64_tr_b16 a[132:133], v16 offset:32768
    ds_read_b64_tr_b16 a[134:135], v16 offset:36864
    v_mfma_f32_16x16x32_bf16 v[124:127], a[28:31], a[136:139], v[124:127]
    v_mfma_f32_16x16x32_bf16 v[156:159], a[32:35], a[136:139], v[156:159]
    s_waitcnt lgkmcnt(6)
    v_mfma_f32_16x16x32_bf16 v[64:67], a[36:39], a[108:111], v[64:67]
    ds_read_b64_tr_b16 a[136:137], v17 offset:32768
    ds_read_b64_tr_b16 a[138:139], v17 offset:36864
    v_mfma_f32_16x16x32_bf16 v[96:99], a[40:43], a[108:111], v[96:99]
    s_waitcnt vmcnt(30)
    s_barrier
    v_mfma_f32_16x16x32_bf16 v[128:131], a[44:47], a[108:111], v[128:131]
    buffer_load_dwordx4 a[8:11], v27, s[16:19], s98 offen
    v_mfma_f32_16x16x32_bf16 v[68:71], a[36:39], a[112:115], v[68:71]
    ds_read_b64_tr_b16 a[108:109], v10 offset:40960
    ds_read_b64_tr_b16 a[110:111], v10 offset:45056
    v_mfma_f32_16x16x32_bf16 v[100:103], a[40:43], a[112:115], v[100:103]
    s_mov_b32 m0, s75
    s_waitcnt vmcnt(30)
    v_mfma_f32_16x16x32_bf16 v[132:135], a[44:47], a[112:115], v[132:135]
    buffer_load_dwordx4 a[12:15], v3, s[16:19], s97 offen
    v_mfma_f32_16x16x32_bf16 v[72:75], a[36:39], a[116:119], v[72:75]
    ds_read_b64_tr_b16 a[112:113], v11 offset:40960
    ds_read_b64_tr_b16 a[114:115], v11 offset:45056
    v_mfma_f32_16x16x32_bf16 v[104:107], a[40:43], a[116:119], v[104:107]
    s_add_u32 s97, s97, 8192
    v_add_f32_dpp v36, v36, v36 quad_perm:[1,0,3,2] row_mask:0xf bank_mask:0xf
    v_mfma_f32_16x16x32_bf16 v[136:139], a[44:47], a[116:119], v[136:139]
    buffer_load_dwordx4 v9, s[60:63], s99 offen offset:0 lds
    v_mfma_f32_16x16x32_bf16 v[76:79], a[36:39], a[120:123], v[76:79]
    ds_read_b64_tr_b16 a[116:117], v12 offset:40960
    ds_read_b64_tr_b16 a[118:119], v12 offset:45056
    v_mfma_f32_16x16x32_bf16 v[108:111], a[40:43], a[120:123], v[108:111]
    buffer_load_dwordx4 a[16:19], v3, s[16:19], s98 offen
    v_mfma_f32_16x16x32_bf16 v[140:143], a[44:47], a[120:123], v[140:143]
    s_add_u32 s98, s98, 8192
    s_waitcnt lgkmcnt(6)
    v_mfma_f32_16x16x32_bf16 v[80:83], a[36:39], a[124:127], v[80:83]
    ds_read_b64_tr_b16 a[120:121], v13 offset:40960
    ds_read_b64_tr_b16 a[122:123], v13 offset:45056
    v_mfma_f32_16x16x32_bf16 v[112:115], a[40:43], a[124:127], v[112:115]
    buffer_load_dwordx4 v9, s[60:63], s99 offen offset:1024 lds
    v_mfma_f32_16x16x32_bf16 v[144:147], a[44:47], a[124:127], v[144:147]
    v_add_f32_dpp v37, v37, v37 quad_perm:[1,0,3,2] row_mask:0xf bank_mask:0xf
    v_add_f32_dpp v38, v38, v38 quad_perm:[1,0,3,2] row_mask:0xf bank_mask:0xf
    v_mfma_f32_16x16x32_bf16 v[84:87], a[36:39], a[128:131], v[84:87]
    ds_read_b64_tr_b16 a[124:125], v14 offset:40960
    ds_read_b64_tr_b16 a[126:127], v14 offset:45056
    v_mfma_f32_16x16x32_bf16 v[116:119], a[40:43], a[128:131], v[116:119]
    buffer_load_dwordx4 a[20:23], v1, s[16:19], s97 offen
    v_mfma_f32_16x16x32_bf16 v[148:151], a[44:47], a[128:131], v[148:151]
    v_add_f32_dpp v39, v39, v39 quad_perm:[1,0,3,2] row_mask:0xf bank_mask:0xf
    v_add_f32_dpp v40, v40, v40 quad_perm:[1,0,3,2] row_mask:0xf bank_mask:0xf
    v_mfma_f32_16x16x32_bf16 v[88:91], a[36:39], a[132:135], v[88:91]
    ds_read_b64_tr_b16 a[128:129], v15 offset:40960
    ds_read_b64_tr_b16 a[130:131], v15 offset:45056
    v_mfma_f32_16x16x32_bf16 v[120:123], a[40:43], a[132:135], v[120:123]
    v_add_f32_dpp v41, v41, v41 quad_perm:[1,0,3,2] row_mask:0xf bank_mask:0xf
    v_add_f32_dpp v42, v42, v42 quad_perm:[1,0,3,2] row_mask:0xf bank_mask:0xf
    v_mfma_f32_16x16x32_bf16 v[152:155], a[44:47], a[132:135], v[152:155]
    v_add_f32_dpp v43, v43, v43 quad_perm:[1,0,3,2] row_mask:0xf bank_mask:0xf
    v_add_f32_dpp v44, v44, v44 quad_perm:[1,0,3,2] row_mask:0xf bank_mask:0xf
    v_mfma_f32_16x16x32_bf16 v[92:95], a[36:39], a[136:139], v[92:95]
    ds_read_b64_tr_b16 a[132:133], v16 offset:40960
    ds_read_b64_tr_b16 a[134:135], v16 offset:45056
    v_mfma_f32_16x16x32_bf16 v[124:127], a[40:43], a[136:139], v[124:127]
    buffer_load_dwordx4 a[24:27], v1, s[16:19], s98 offen
    v_mfma_f32_16x16x32_bf16 v[156:159], a[44:47], a[136:139], v[156:159]
    v_add_f32_dpp v45, v45, v45 quad_perm:[1,0,3,2] row_mask:0xf bank_mask:0xf
    s_waitcnt lgkmcnt(6)
    v_mfma_f32_16x16x32_bf16 v[64:67], a[48:51], a[108:111], v[64:67]
    ds_read_b64_tr_b16 a[136:137], v17 offset:40960
    ds_read_b64_tr_b16 a[138:139], v17 offset:45056
    v_mfma_f32_16x16x32_bf16 v[96:99], a[52:55], a[108:111], v[96:99]
    buffer_load_dwordx4 v9, s[60:63], s99 offen offset:2048 lds
    v_mfma_f32_16x16x32_bf16 v[128:131], a[56:59], a[108:111], v[128:131]
    v_add_f32_dpp v46, v46, v46 quad_perm:[1,0,3,2] row_mask:0xf bank_mask:0xf
    v_add_f32_dpp v47, v47, v47 quad_perm:[1,0,3,2] row_mask:0xf bank_mask:0xf
    v_mfma_f32_16x16x32_bf16 v[68:71], a[48:51], a[112:115], v[68:71]
    ds_read_b64_tr_b16 a[108:109], v10 offset:49152
    ds_read_b64_tr_b16 a[110:111], v10 offset:53248
    v_mfma_f32_16x16x32_bf16 v[100:103], a[52:55], a[112:115], v[100:103]
    buffer_load_dwordx4 a[28:31], v24, s[16:19], s97 offen
    v_mfma_f32_16x16x32_bf16 v[132:135], a[56:59], a[112:115], v[132:135]
    v_add_f32_dpp v36, v36, v36 quad_perm:[2,3,0,1] row_mask:0xf bank_mask:0xf
    v_add_f32_dpp v37, v37, v37 quad_perm:[2,3,0,1] row_mask:0xf bank_mask:0xf
    v_mfma_f32_16x16x32_bf16 v[72:75], a[48:51], a[116:119], v[72:75]
    ds_read_b64_tr_b16 a[112:113], v11 offset:49152
    ds_read_b64_tr_b16 a[114:115], v11 offset:53248
    v_mfma_f32_16x16x32_bf16 v[104:107], a[52:55], a[116:119], v[104:107]
    v_add_f32_dpp v38, v38, v38 quad_perm:[2,3,0,1] row_mask:0xf bank_mask:0xf
    v_add_f32_dpp v39, v39, v39 quad_perm:[2,3,0,1] row_mask:0xf bank_mask:0xf
    v_mfma_f32_16x16x32_bf16 v[136:139], a[56:59], a[116:119], v[136:139]
    buffer_load_dwordx4 a[32:35], v24, s[16:19], s98 offen
    v_mfma_f32_16x16x32_bf16 v[76:79], a[48:51], a[120:123], v[76:79]
    ds_read_b64_tr_b16 a[116:117], v12 offset:49152
    ds_read_b64_tr_b16 a[118:119], v12 offset:53248
    v_mfma_f32_16x16x32_bf16 v[108:111], a[52:55], a[120:123], v[108:111]
    v_add_f32_dpp v40, v40, v40 quad_perm:[2,3,0,1] row_mask:0xf bank_mask:0xf
    v_add_f32_dpp v41, v41, v41 quad_perm:[2,3,0,1] row_mask:0xf bank_mask:0xf
    v_mfma_f32_16x16x32_bf16 v[140:143], a[56:59], a[120:123], v[140:143]
    v_add_f32_dpp v42, v42, v42 quad_perm:[2,3,0,1] row_mask:0xf bank_mask:0xf
    s_waitcnt lgkmcnt(6)
    v_mfma_f32_16x16x32_bf16 v[80:83], a[48:51], a[124:127], v[80:83]
    ds_read_b64_tr_b16 a[120:121], v13 offset:49152
    ds_read_b64_tr_b16 a[122:123], v13 offset:53248
    v_mfma_f32_16x16x32_bf16 v[112:115], a[52:55], a[124:127], v[112:115]
    buffer_load_dwordx4 v9, s[60:63], s99 offen offset:3072 lds
    v_mfma_f32_16x16x32_bf16 v[144:147], a[56:59], a[124:127], v[144:147]
    buffer_load_dwordx4 a[36:39], v27, s[16:19], s97 offen
    v_mfma_f32_16x16x32_bf16 v[84:87], a[48:51], a[128:131], v[84:87]
    ds_read_b64_tr_b16 a[124:125], v14 offset:49152
    ds_read_b64_tr_b16 a[126:127], v14 offset:53248
    v_mfma_f32_16x16x32_bf16 v[116:119], a[52:55], a[128:131], v[116:119]
    s_add_u32 s75, s75, 16384
    s_add_u32 s99, s99, 16384
    v_mfma_f32_16x16x32_bf16 v[148:151], a[56:59], a[128:131], v[148:151]
    v_add_f32_dpp v43, v43, v43 quad_perm:[2,3,0,1] row_mask:0xf bank_mask:0xf
    v_add_f32_dpp v44, v44, v44 quad_perm:[2,3,0,1] row_mask:0xf bank_mask:0xf
    v_mfma_f32_16x16x32_bf16 v[88:91], a[48:51], a[132:135], v[88:91]
    ds_read_b64_tr_b16 a[128:129], v15 offset:49152
    ds_read_b64_tr_b16 a[130:131], v15 offset:53248
    v_mfma_f32_16x16x32_bf16 v[120:123], a[52:55], a[132:135], v[120:123]
    buffer_load_dwordx4 a[40:43], v27, s[16:19], s98 offen
    v_mfma_f32_16x16x32_bf16 v[152:155], a[56:59], a[132:135], v[152:155]
    v_add_f32_dpp v45, v45, v45 quad_perm:[2,3,0,1] row_mask:0xf bank_mask:0xf
    v_add_f32_dpp v46, v46, v46 quad_perm:[2,3,0,1] row_mask:0xf bank_mask:0xf
    v_mfma_f32_16x16x32_bf16 v[92:95], a[48:51], a[136:139], v[92:95]
    ds_read_b64_tr_b16 a[132:133], v16 offset:49152
    ds_read_b64_tr_b16 a[134:135], v16 offset:53248
    v_mfma_f32_16x16x32_bf16 v[124:127], a[52:55], a[136:139], v[124:127]
    v_add_f32_dpp v47, v47, v47 quad_perm:[2,3,0,1] row_mask:0xf bank_mask:0xf
    v_add_f32_dpp v36, v36, v36 row_half_mirror row_mask:0xf bank_mask:0xf
    v_mfma_f32_16x16x32_bf16 v[156:159], a[56:59], a[136:139], v[156:159]
    v_add_f32_dpp v37, v37, v37 row_half_mirror row_mask:0xf bank_mask:0xf
    s_waitcnt lgkmcnt(6)
    v_mfma_f32_16x16x32_bf16 v[64:67], a[60:63], a[108:111], v[64:67]
    ds_read_b64_tr_b16 a[136:137], v17 offset:49152
    ds_read_b64_tr_b16 a[138:139], v17 offset:53248
    v_mfma_f32_16x16x32_bf16 v[96:99], a[64:67], a[108:111], v[96:99]
    buffer_load_dwordx4 a[44:47], v3, s[16:19], s97 offen
    v_mfma_f32_16x16x32_bf16 v[128:131], a[68:71], a[108:111], v[128:131]
    s_add_u32 s97, s97, 8192
    ds_read_b128 a[140:143], v9 offset:0
    v_mfma_f32_16x16x32_bf16 v[68:71], a[60:63], a[112:115], v[68:71]
    ds_read_b64_tr_b16 a[108:109], v10 offset:57344
    ds_read_b64_tr_b16 a[110:111], v10 offset:61440
    v_mfma_f32_16x16x32_bf16 v[100:103], a[64:67], a[112:115], v[100:103]
    v_add_u32 v10, 0x10000, v10
    s_mov_b32 m0, s75
    v_mfma_f32_16x16x32_bf16 v[132:135], a[68:71], a[112:115], v[132:135]
    buffer_load_dwordx4 v9, s[60:63], s99 offen offset:0 lds
    v_mfma_f32_16x16x32_bf16 v[72:75], a[60:63], a[116:119], v[72:75]
    ds_read_b64_tr_b16 a[112:113], v11 offset:57344
    ds_read_b64_tr_b16 a[114:115], v11 offset:61440
    v_mfma_f32_16x16x32_bf16 v[104:107], a[64:67], a[116:119], v[104:107]
    v_add_u32 v11, 0x10000, v11
    s_waitcnt vmcnt(22)
    v_mfma_f32_16x16x32_bf16 v[136:139], a[68:71], a[116:119], v[136:139]
    buffer_store_dword v6, v5, s[64:67], s49 offen offset:256 sc1
    v_mfma_f32_16x16x32_bf16 v[76:79], a[60:63], a[120:123], v[76:79]
    ds_read_b64_tr_b16 a[116:117], v12 offset:57344
    ds_read_b64_tr_b16 a[118:119], v12 offset:61440
    v_mfma_f32_16x16x32_bf16 v[108:111], a[64:67], a[120:123], v[108:111]
    v_add_u32 v12, 0x10000, v12
    v_add_f32_dpp v38, v38, v38 row_half_mirror row_mask:0xf bank_mask:0xf
    v_mfma_f32_16x16x32_bf16 v[140:143], a[68:71], a[120:123], v[140:143]
    v_add_f32_dpp v39, v39, v39 row_half_mirror row_mask:0xf bank_mask:0xf
    s_waitcnt lgkmcnt(7)
    v_mfma_f32_16x16x32_bf16 v[80:83], a[60:63], a[124:127], v[80:83]
    ds_read_b64_tr_b16 a[120:121], v13 offset:57344
    ds_read_b64_tr_b16 a[122:123], v13 offset:61440
    v_mfma_f32_16x16x32_bf16 v[112:115], a[64:67], a[124:127], v[112:115]
    v_add_u32 v13, 0x10000, v13
    v_add_f32_dpp v40, v40, v40 row_half_mirror row_mask:0xf bank_mask:0xf
    v_mfma_f32_16x16x32_bf16 v[144:147], a[68:71], a[124:127], v[144:147]
    buffer_load_dwordx4 a[48:51], v3, s[16:19], s98 offen
    v_mfma_f32_16x16x32_bf16 v[84:87], a[60:63], a[128:131], v[84:87]
    ds_read_b64_tr_b16 a[124:125], v14 offset:57344
    ds_read_b64_tr_b16 a[126:127], v14 offset:61440
    v_mfma_f32_16x16x32_bf16 v[116:119], a[64:67], a[128:131], v[116:119]
    v_add_u32 v14, 0x10000, v14
    s_add_u32 s98, s98, 8192
    v_mfma_f32_16x16x32_bf16 v[148:151], a[68:71], a[128:131], v[148:151]
    buffer_load_dwordx4 a[52:55], v1, s[16:19], s97 offen
    v_mfma_f32_16x16x32_bf16 v[88:91], a[60:63], a[132:135], v[88:91]
    ds_read_b64_tr_b16 a[128:129], v15 offset:57344
    ds_read_b64_tr_b16 a[130:131], v15 offset:61440
    v_mfma_f32_16x16x32_bf16 v[120:123], a[64:67], a[132:135], v[120:123]
    v_add_u32 v15, 0x10000, v15
    ds_read_b128 a[156:159], v9 offset:4096
    v_mfma_f32_16x16x32_bf16 v[152:155], a[68:71], a[132:135], v[152:155]
    buffer_load_dwordx4 a[56:59], v1, s[16:19], s98 offen
    v_mfma_f32_16x16x32_bf16 v[92:95], a[60:63], a[136:139], v[92:95]
    ds_read_b64_tr_b16 a[132:133], v16 offset:57344
    ds_read_b64_tr_b16 a[134:135], v16 offset:61440
    v_mfma_f32_16x16x32_bf16 v[124:127], a[64:67], a[136:139], v[124:127]
    v_add_u32 v16, 0x10000, v16
    ds_read_b128 a[144:147], v9 offset:1024
    v_mfma_f32_16x16x32_bf16 v[156:159], a[68:71], a[136:139], v[156:159]
    ds_read_b128 a[160:163], v9 offset:5120
    s_waitcnt lgkmcnt(9)
    v_mfma_f32_16x16x32_bf16 v[64:67], a[72:75], a[108:111], v[64:67]
    ds_read_b64_tr_b16 a[136:137], v17 offset:57344
    ds_read_b64_tr_b16 a[138:139], v17 offset:61440
    v_mfma_f32_16x16x32_bf16 v[96:99], a[76:79], a[108:111], v[96:99]
    v_add_u32 v17, 0x10000, v17
    ds_read_b128 a[148:151], v9 offset:2048
    v_mfma_f32_16x16x32_bf16 v[128:131], a[80:83], a[108:111], v[128:131]
    buffer_load_dwordx4 a[60:63], v24, s[16:19], s97 offen
    v_mfma_f32_16x16x32_bf16 v[68:71], a[72:75], a[112:115], v[68:71]
    ds_read_b64_tr_b16 a[108:109], v10 offset:0
    ds_read_b64_tr_b16 a[110:111], v10 offset:4096
    v_mfma_f32_16x16x32_bf16 v[100:103], a[76:79], a[112:115], v[100:103]
    buffer_load_dwordx4 a[64:67], v24, s[16:19], s98 offen
    v_mfma_f32_16x16x32_bf16 v[132:135], a[80:83], a[112:115], v[132:135]
    ds_read_b128 a[164:167], v9 offset:6144
    ds_read_b128 a[152:155], v9 offset:3072
    v_mfma_f32_16x16x32_bf16 v[72:75], a[72:75], a[116:119], v[72:75]
    ds_read_b64_tr_b16 a[112:113], v11 offset:0
    ds_read_b64_tr_b16 a[114:115], v11 offset:4096
    v_mfma_f32_16x16x32_bf16 v[104:107], a[76:79], a[116:119], v[104:107]
    ds_read_b128 a[168:171], v9 offset:7168
    v_add_f32_dpp v41, v41, v41 row_half_mirror row_mask:0xf bank_mask:0xf
    v_mfma_f32_16x16x32_bf16 v[136:139], a[80:83], a[116:119], v[136:139]
    ds_read_b128 a[172:175], v9 offset:8192
    v_add_f32_dpp v42, v42, v42 row_half_mirror row_mask:0xf bank_mask:0xf
    v_mfma_f32_16x16x32_bf16 v[76:79], a[72:75], a[120:123], v[76:79]
    ds_read_b64_tr_b16 a[116:117], v12 offset:0
    ds_read_b64_tr_b16 a[118:119], v12 offset:4096
    v_mfma_f32_16x16x32_bf16 v[108:111], a[76:79], a[120:123], v[108:111]
    buffer_load_dwordx4 a[68:71], v27, s[16:19], s97 offen
    v_mfma_f32_16x16x32_bf16 v[140:143], a[80:83], a[120:123], v[140:143]
    v_add_f32_dpp v43, v43, v43 row_half_mirror row_mask:0xf bank_mask:0xf
    s_waitcnt lgkmcnt(11)
    v_mfma_f32_16x16x32_bf16 v[80:83], a[72:75], a[124:127], v[80:83]
    ds_read_b64_tr_b16 a[120:121], v13 offset:0
    ds_read_b64_tr_b16 a[122:123], v13 offset:4096
    v_mfma_f32_16x16x32_bf16 v[112:115], a[76:79], a[124:127], v[112:115]
    ds_read_b128 a[176:179], v9 offset:9216
    v_add_f32_dpp v44, v44, v44 row_half_mirror row_mask:0xf bank_mask:0xf
    v_mfma_f32_16x16x32_bf16 v[144:147], a[80:83], a[124:127], v[144:147]
    buffer_load_dwordx4 v9, s[60:63], s99 offen offset:1024 lds
    v_mfma_f32_16x16x32_bf16 v[84:87], a[72:75], a[128:131], v[84:87]
    ds_read_b64_tr_b16 a[124:125], v14 offset:0
    ds_read_b64_tr_b16 a[126:127], v14 offset:4096
    v_mfma_f32_16x16x32_bf16 v[116:119], a[76:79], a[128:131], v[116:119]
    buffer_load_dwordx4 v9, s[60:63], s99 offen offset:2048 lds
    v_mfma_f32_16x16x32_bf16 v[148:151], a[80:83], a[128:131], v[148:151]
    buffer_load_dwordx4 v9, s[60:63], s99 offen offset:3072 lds
    v_mfma_f32_16x16x32_bf16 v[88:91], a[72:75], a[132:135], v[88:91]
    ds_read_b64_tr_b16 a[128:129], v15 offset:0
    ds_read_b64_tr_b16 a[130:131], v15 offset:4096
    v_mfma_f32_16x16x32_bf16 v[120:123], a[76:79], a[132:135], v[120:123]
    s_add_u32 s75, s75, 16384
    s_add_u32 s99, s99, 16384
    v_mfma_f32_16x16x32_bf16 v[152:155], a[80:83], a[132:135], v[152:155]
    v_add_f32_dpp v45, v45, v45 row_half_mirror row_mask:0xf bank_mask:0xf
    v_add_f32_dpp v46, v46, v46 row_half_mirror row_mask:0xf bank_mask:0xf
    v_mfma_f32_16x16x32_bf16 v[92:95], a[72:75], a[136:139], v[92:95]
    ds_read_b64_tr_b16 a[132:133], v16 offset:0
    ds_read_b64_tr_b16 a[134:135], v16 offset:4096
    v_mfma_f32_16x16x32_bf16 v[124:127], a[76:79], a[136:139], v[124:127]
    v_add_f32_dpp v47, v47, v47 row_half_mirror row_mask:0xf bank_mask:0xf
    v_mfma_f32_16x16x32_bf16 v[156:159], a[80:83], a[136:139], v[156:159]
    s_waitcnt lgkmcnt(7)
    v_mfma_f32_16x16x32_bf16 v[64:67], a[84:87], a[108:111], v[64:67]
    ds_read_b64_tr_b16 a[136:137], v17 offset:0
    ds_read_b64_tr_b16 a[138:139], v17 offset:4096
    v_mfma_f32_16x16x32_bf16 v[96:99], a[88:91], a[108:111], v[96:99]
    s_waitcnt vmcnt(26)
    s_barrier
    v_mfma_f32_16x16x32_bf16 v[128:131], a[92:95], a[108:111], v[128:131]
    buffer_load_dwordx4 a[72:75], v27, s[16:19], s98 offen
    v_mfma_f32_16x16x32_bf16 v[68:71], a[84:87], a[112:115], v[68:71]
    ds_read_b64_tr_b16 a[108:109], v10 offset:8192
    ds_read_b64_tr_b16 a[110:111], v10 offset:12288
    v_mfma_f32_16x16x32_bf16 v[100:103], a[88:91], a[112:115], v[100:103]
    buffer_load_dwordx4 a[76:79], v3, s[16:19], s97 offen
    v_mfma_f32_16x16x32_bf16 v[132:135], a[92:95], a[112:115], v[132:135]
    s_add_u32 s97, s97, 8192
    ds_read_b128 a[192:195], v9 offset:13312
    v_mfma_f32_16x16x32_bf16 v[72:75], a[84:87], a[116:119], v[72:75]
    ds_read_b64_tr_b16 a[112:113], v11 offset:8192
    ds_read_b64_tr_b16 a[114:115], v11 offset:12288
    v_mfma_f32_16x16x32_bf16 v[104:107], a[88:91], a[116:119], v[104:107]
    buffer_load_dwordx4 a[80:83], v3, s[16:19], s98 offen
    v_mfma_f32_16x16x32_bf16 v[136:139], a[92:95], a[116:119], v[136:139]
    s_add_u32 s98, s98, 8192
    ds_read_b128 a[180:183], v9 offset:10240
    v_mfma_f32_16x16x32_bf16 v[76:79], a[84:87], a[120:123], v[76:79]
    ds_read_b64_tr_b16 a[116:117], v12 offset:8192
    ds_read_b64_tr_b16 a[118:119], v12 offset:12288
    v_mfma_f32_16x16x32_bf16 v[108:111], a[88:91], a[120:123], v[108:111]
    ds_read_b128 a[196:199], v9 offset:14336
    ds_read_b128 a[184:187], v9 offset:11264
    v_mfma_f32_16x16x32_bf16 v[140:143], a[92:95], a[120:123], v[140:143]
    s_mov_b32 m0, s75
    s_waitcnt lgkmcnt(10)
    v_mfma_f32_16x16x32_bf16 v[80:83], a[84:87], a[124:127], v[80:83]
    ds_read_b64_tr_b16 a[120:121], v13 offset:8192
    ds_read_b64_tr_b16 a[122:123], v13 offset:12288
    v_mfma_f32_16x16x32_bf16 v[112:115], a[88:91], a[124:127], v[112:115]
    ds_read_b128 a[200:203], v9 offset:15360
    ds_read_b128 a[188:191], v9 offset:12288
    v_mfma_f32_16x16x32_bf16 v[144:147], a[92:95], a[124:127], v[144:147]
    buffer_load_dwordx4 v9, s[60:63], s99 offen offset:0 lds
    v_mfma_f32_16x16x32_bf16 v[84:87], a[84:87], a[128:131], v[84:87]
    ds_read_b64_tr_b16 a[124:125], v14 offset:8192
    ds_read_b64_tr_b16 a[126:127], v14 offset:12288
    v_mfma_f32_16x16x32_bf16 v[116:119], a[88:91], a[128:131], v[116:119]
    ds_read_b128 a[204:207], v9 offset:16384
    v_mfma_f32_16x16x32_bf16 v[148:151], a[92:95], a[128:131], v[148:151]
    buffer_load_dwordx4 v9, s[60:63], s99 offen offset:1024 lds
    v_mfma_f32_16x16x32_bf16 v[88:91], a[84:87], a[132:135], v[88:91]
    ds_read_b64_tr_b16 a[128:129], v15 offset:8192
    ds_read_b64_tr_b16 a[130:131], v15 offset:12288
    v_mfma_f32_16x16x32_bf16 v[120:123], a[88:91], a[132:135], v[120:123]
    v_mfma_f32_16x16x32_bf16 v[152:155], a[92:95], a[132:135], v[152:155]
    ds_read_b128 a[208:211], v9 offset:17408
    v_mfma_f32_16x16x32_bf16 v[92:95], a[84:87], a[136:139], v[92:95]
    ds_read_b64_tr_b16 a[132:133], v16 offset:8192
    ds_read_b64_tr_b16 a[134:135], v16 offset:12288
    v_mfma_f32_16x16x32_bf16 v[124:127], a[88:91], a[136:139], v[124:127]
    v_mfma_f32_16x16x32_bf16 v[156:159], a[92:95], a[136:139], v[156:159]
    s_waitcnt lgkmcnt(10)
    v_mfma_f32_16x16x32_bf16 v[64:67], a[96:99], a[108:111], v[64:67]
    ds_read_b64_tr_b16 a[136:137], v17 offset:8192
    ds_read_b64_tr_b16 a[138:139], v17 offset:12288
    v_mfma_f32_16x16x32_bf16 v[96:99], a[100:103], a[108:111], v[96:99]
    buffer_load_dwordx4 a[84:87], v1, s[16:19], s97 offen
    v_mfma_f32_16x16x32_bf16 v[128:131], a[104:107], a[108:111], v[128:131]
    buffer_load_dwordx4 a[88:91], v1, s[16:19], s98 offen
    v_mfma_f32_16x16x32_bf16 v[68:71], a[96:99], a[112:115], v[68:71]
    buffer_load_dwordx4 a[92:95], v24, s[16:19], s97 offen
    v_mfma_f32_16x16x32_bf16 v[100:103], a[100:103], a[112:115], v[100:103]
    buffer_load_dwordx4 v9, s[60:63], s99 offen offset:2048 lds
    v_mfma_f32_16x16x32_bf16 v[132:135], a[104:107], a[112:115], v[132:135]
    v_mfma_f32_16x16x32_bf16 v[72:75], a[96:99], a[116:119], v[72:75]
    v_mfma_f32_16x16x32_bf16 v[104:107], a[100:103], a[116:119], v[104:107]
    v_mfma_f32_16x16x32_bf16 v[136:139], a[104:107], a[116:119], v[136:139]
    v_mfma_f32_16x16x32_bf16 v[76:79], a[96:99], a[120:123], v[76:79]
    v_mfma_f32_16x16x32_bf16 v[108:111], a[100:103], a[120:123], v[108:111]
    v_mfma_f32_16x16x32_bf16 v[140:143], a[104:107], a[120:123], v[140:143]
    s_waitcnt lgkmcnt(0)
    v_mfma_f32_16x16x32_bf16 v[80:83], a[96:99], a[124:127], v[80:83]
    buffer_load_dwordx4 v9, s[60:63], s99 offen offset:3072 lds
    v_mfma_f32_16x16x32_bf16 v[112:115], a[100:103], a[124:127], v[112:115]
    s_add_u32 s75, s75, 16384
    s_add_u32 s99, s99, 16384
    v_mfma_f32_16x16x32_bf16 v[144:147], a[104:107], a[124:127], v[144:147]
    v_mfma_f32_16x16x32_bf16 v[84:87], a[96:99], a[128:131], v[84:87]
    v_mfma_f32_16x16x32_bf16 v[116:119], a[100:103], a[128:131], v[116:119]
    v_mfma_f32_16x16x32_bf16 v[148:151], a[104:107], a[128:131], v[148:151]
    v_mfma_f32_16x16x32_bf16 v[88:91], a[96:99], a[132:135], v[88:91]
    v_mfma_f32_16x16x32_bf16 v[120:123], a[100:103], a[132:135], v[120:123]
    v_mfma_f32_16x16x32_bf16 v[152:155], a[104:107], a[132:135], v[152:155]
    v_mfma_f32_16x16x32_bf16 v[92:95], a[96:99], a[136:139], v[92:95]
    v_mfma_f32_16x16x32_bf16 v[124:127], a[100:103], a[136:139], v[124:127]
    v_mfma_f32_16x16x32_bf16 v[156:159], a[104:107], a[136:139], v[156:159]
    v_mfma_f32_16x16x32_bf16 v[160:163], a[140:143], a[212:215], 0
    v_add_u32 v10, 0x10000, v9
    v_add_u32 v11, 0x20000, v9
    buffer_load_dwordx4 a[96:99], v24, s[16:19], s98 offen
    s_mov_b32 m0, s75
    v_fmac_f32 v64, v36, v28
    v_mfma_f32_16x16x32_bf16 v[160:163], a[156:159], a[216:219], v[160:163]
    buffer_load_dwordx4 v9, s[60:63], s99 offen offset:0 lds
    v_fmac_f32 v65, v37, v28
    v_fmac_f32 v66, v38, v28
    v_fmac_f32 v67, v39, v28
    v_mul_f32 v64, v64, v66
    v_mfma_f32_16x16x32_bf16 v[164:167], a[144:147], a[212:215], 0
    s_barrier
    v_mul_f32 v65, v65, v67
    v_cvt_pk_bf16_f32 v48, v64, v65
    v_fmac_f32 v68, v36, v29
    v_fmac_f32 v69, v37, v29
    v_fmac_f32 v70, v38, v29
    v_mfma_f32_16x16x32_bf16 v[164:167], a[160:163], a[216:219], v[164:167]
    v_fmac_f32 v71, v39, v29
    v_mul_f32 v68, v68, v70
    v_mul_f32 v69, v69, v71
    v_cvt_pk_bf16_f32 v49, v68, v69
    v_fmac_f32 v72, v36, v30
    v_fmac_f32 v73, v37, v30
    v_mfma_f32_16x16x32_bf16 v[168:171], a[148:151], a[212:215], 0
    v_fmac_f32 v74, v38, v30
    v_fmac_f32 v75, v39, v30
    v_mul_f32 v72, v72, v74
    v_mul_f32 v73, v73, v75
    v_cvt_pk_bf16_f32 v50, v72, v73
    v_fmac_f32 v76, v36, v31
    v_mfma_f32_16x16x32_bf16 v[168:171], a[164:167], a[216:219], v[168:171]
    v_fmac_f32 v77, v37, v31
    v_fmac_f32 v78, v38, v31
    v_fmac_f32 v79, v39, v31
    v_mul_f32 v76, v76, v78
    v_mul_f32 v77, v77, v79
    v_cvt_pk_bf16_f32 v51, v76, v77
    v_mfma_f32_16x16x32_bf16 v[172:175], a[152:155], a[212:215], 0
    v_permlane32_swap_b32 v48, v50
    v_permlane32_swap_b32 v49, v51
    v_fmac_f32 v80, v36, v32
    v_fmac_f32 v81, v37, v32
    v_mfma_f32_16x16x32_bf16 v[172:175], a[168:171], a[216:219], v[172:175]
    v_permlane16_swap_b32 v48, v49
    v_permlane16_swap_b32 v50, v51
    buffer_store_dwordx4 v[48:51], v18, s[16:19], s46 offen sc1
    v_mfma_f32_16x16x32_bf16 v[176:179], a[172:175], a[212:215], 0
    v_fmac_f32 v96, v40, v28
    v_fmac_f32 v97, v41, v28
    v_fmac_f32 v98, v42, v28
    v_fmac_f32 v99, v43, v28
    v_mul_f32 v96, v96, v98
    v_mul_f32 v97, v97, v99
    v_mfma_f32_16x16x32_bf16 v[180:183], a[172:175], a[216:219], 0
    v_cvt_pk_bf16_f32 v48, v96, v97
    v_fmac_f32 v100, v40, v29
    v_fmac_f32 v101, v41, v29
    v_fmac_f32 v102, v42, v29
    v_fmac_f32 v103, v43, v29
    v_mul_f32 v100, v100, v102
    v_mfma_f32_16x16x32_bf16 v[184:187], a[140:143], a[220:223], 0
    v_mul_f32 v101, v101, v103
    v_cvt_pk_bf16_f32 v49, v100, v101
    v_fmac_f32 v104, v40, v30
    v_fmac_f32 v105, v41, v30
    v_fmac_f32 v106, v42, v30
    v_fmac_f32 v107, v43, v30
    v_mfma_f32_16x16x32_bf16 v[184:187], a[156:159], a[224:227], v[184:187]
    v_mul_f32 v104, v104, v106
    v_mul_f32 v105, v105, v107
    v_cvt_pk_bf16_f32 v50, v104, v105
    v_fmac_f32 v108, v40, v31
    v_fmac_f32 v109, v41, v31
    v_fmac_f32 v110, v42, v31
    v_mfma_f32_16x16x32_bf16 v[188:191], a[144:147], a[220:223], 0
    buffer_load_dwordx4 v9, s[60:63], s99 offen offset:1024 lds
    v_fmac_f32 v111, v43, v31
    v_mul_f32 v108, v108, v110
    v_mul_f32 v109, v109, v111
    v_cvt_pk_bf16_f32 v51, v108, v109
    v_mfma_f32_16x16x32_bf16 v[188:191], a[160:163], a[224:227], v[188:191]
    v_permlane32_swap_b32 v48, v50
    v_permlane32_swap_b32 v49, v51
    v_fmac_f32 v82, v38, v32
    v_fmac_f32 v83, v39, v32
    v_mfma_f32_16x16x32_bf16 v[192:195], a[148:151], a[220:223], 0
    v_permlane16_swap_b32 v48, v49
    v_permlane16_swap_b32 v50, v51
    buffer_store_dwordx4 v[48:51], v18, s[16:19], s47 offen sc1
    v_mfma_f32_16x16x32_bf16 v[192:195], a[164:167], a[224:227], v[192:195]
    v_fmac_f32 v128, v44, v28
    v_fmac_f32 v129, v45, v28
    v_fmac_f32 v130, v46, v28
    v_fmac_f32 v131, v47, v28
    v_mul_f32 v128, v128, v130
    v_mul_f32 v129, v129, v131
    v_mfma_f32_16x16x32_bf16 v[196:199], a[152:155], a[220:223], 0
    v_cvt_pk_bf16_f32 v48, v128, v129
    v_fmac_f32 v132, v44, v29
    v_fmac_f32 v133, v45, v29
    v_fmac_f32 v134, v46, v29
    v_fmac_f32 v135, v47, v29
    v_mul_f32 v132, v132, v134
    v_mfma_f32_16x16x32_bf16 v[196:199], a[168:171], a[224:227], v[196:199]
    v_mul_f32 v133, v133, v135
    v_cvt_pk_bf16_f32 v49, v132, v133
    v_fmac_f32 v136, v44, v30
    v_fmac_f32 v137, v45, v30
    v_fmac_f32 v138, v46, v30
    v_fmac_f32 v139, v47, v30
    v_mfma_f32_16x16x32_bf16 v[200:203], a[172:175], a[220:223], 0
    v_mul_f32 v136, v136, v138
    v_mul_f32 v137, v137, v139
    v_cvt_pk_bf16_f32 v50, v136, v137
    v_fmac_f32 v140, v44, v31
    v_fmac_f32 v141, v45, v31
    v_fmac_f32 v142, v46, v31
    v_mfma_f32_16x16x32_bf16 v[204:207], a[172:175], a[224:227], 0
    v_fmac_f32 v143, v47, v31
    v_mul_f32 v140, v140, v142
    v_mul_f32 v141, v141, v143
    v_cvt_pk_bf16_f32 v51, v140, v141
    v_permlane32_swap_b32 v48, v50
    v_mfma_f32_16x16x32_bf16 v[208:211], a[140:143], a[228:231], 0
    v_permlane32_swap_b32 v49, v51
    v_mul_f32 v80, v80, v82
    v_mul_f32 v81, v81, v83
    v_permlane16_swap_b32 v48, v49
    v_mfma_f32_16x16x32_bf16 v[208:211], a[156:159], a[232:235], v[208:211]
    v_permlane16_swap_b32 v50, v51
    buffer_store_dwordx4 v[48:51], v18, s[16:19], s48 offen sc1
    v_cvt_pk_bf16_f32 v52, v80, v81
    v_fmac_f32 v84, v36, v33
    v_mfma_f32_16x16x32_bf16 v[212:215], a[144:147], a[228:231], 0
    v_fmac_f32 v85, v37, v33
    v_fmac_f32 v86, v38, v33
    v_fmac_f32 v87, v39, v33
    v_mul_f32 v84, v84, v86
    v_mul_f32 v85, v85, v87
    v_cvt_pk_bf16_f32 v53, v84, v85
    v_mfma_f32_16x16x32_bf16 v[212:215], a[160:163], a[232:235], v[212:215]
    v_fmac_f32 v88, v36, v34
    v_fmac_f32 v89, v37, v34
    v_fmac_f32 v90, v38, v34
    v_fmac_f32 v91, v39, v34
    v_mul_f32 v88, v88, v90
    v_mul_f32 v89, v89, v91
    v_mfma_f32_16x16x32_bf16 v[216:219], a[148:151], a[228:231], 0
    buffer_load_dwordx4 v9, s[60:63], s99 offen offset:2048 lds
    v_cvt_pk_bf16_f32 v54, v88, v89
    v_fmac_f32 v92, v36, v35
    v_fmac_f32 v93, v37, v35
    v_fmac_f32 v94, v38, v35
    v_mfma_f32_16x16x32_bf16 v[216:219], a[164:167], a[232:235], v[216:219]
    v_fmac_f32 v95, v39, v35
    v_mul_f32 v92, v92, v94
    v_mul_f32 v93, v93, v95
    v_cvt_pk_bf16_f32 v55, v92, v93
    v_permlane32_swap_b32 v52, v54
    v_mfma_f32_16x16x32_bf16 v[220:223], a[152:155], a[228:231], 0
    v_permlane32_swap_b32 v53, v55
    v_mfma_f32_16x16x32_bf16 v[220:223], a[168:171], a[232:235], v[220:223]
    v_mfma_f32_16x16x32_bf16 v[224:227], a[172:175], a[228:231], 0
    v_permlane16_swap_b32 v52, v53
    v_permlane16_swap_b32 v54, v55
    buffer_store_dwordx4 v[52:55], v19, s[16:19], s46 offen sc1
    v_mfma_f32_16x16x32_bf16 v[228:231], a[172:175], a[232:235], 0
    v_fmac_f32 v112, v40, v32
    v_fmac_f32 v113, v41, v32
    v_fmac_f32 v114, v42, v32
    v_fmac_f32 v115, v43, v32
    v_mul_f32 v112, v112, v114
    v_mul_f32 v113, v113, v115
    v_mfma_f32_16x16x32_bf16 v[232:235], a[140:143], a[236:239], 0
    ds_read_b128 a[140:143], v9 offset:18432
    v_cvt_pk_bf16_f32 v52, v112, v113
    v_fmac_f32 v116, v40, v33
    v_fmac_f32 v117, v41, v33
    v_fmac_f32 v118, v42, v33
    v_fmac_f32 v119, v43, v33
    v_mfma_f32_16x16x32_bf16 v[232:235], a[156:159], a[240:243], v[232:235]
    ds_read_b128 a[156:159], v9 offset:22528
    v_mul_f32 v116, v116, v118
    v_mul_f32 v117, v117, v119
    v_cvt_pk_bf16_f32 v53, v116, v117
    v_fmac_f32 v120, v40, v34
    v_fmac_f32 v121, v41, v34
    v_mfma_f32_16x16x32_bf16 v[236:239], a[144:147], a[236:239], 0
    ds_read_b128 a[144:147], v9 offset:19456
    v_fmac_f32 v122, v42, v34
    v_fmac_f32 v123, v43, v34
    v_mul_f32 v120, v120, v122
    v_mul_f32 v121, v121, v123
    v_cvt_pk_bf16_f32 v54, v120, v121
    v_mfma_f32_16x16x32_bf16 v[236:239], a[160:163], a[240:243], v[236:239]
    ds_read_b128 a[160:163], v9 offset:23552
    v_fmac_f32 v124, v40, v35
    v_fmac_f32 v125, v41, v35
    v_fmac_f32 v126, v42, v35
    v_fmac_f32 v127, v43, v35
    v_mul_f32 v124, v124, v126
    v_mfma_f32_16x16x32_bf16 v[240:243], a[148:151], a[236:239], 0
    ds_read_b128 a[148:151], v9 offset:20480
    v_mul_f32 v125, v125, v127
    v_cvt_pk_bf16_f32 v55, v124, v125
    v_permlane32_swap_b32 v52, v54
    v_mfma_f32_16x16x32_bf16 v[240:243], a[164:167], a[240:243], v[240:243]
    ds_read_b128 a[164:167], v9 offset:24576
    v_permlane32_swap_b32 v53, v55
    v_mfma_f32_16x16x32_bf16 v[244:247], a[152:155], a[236:239], 0
    ds_read_b128 a[152:155], v9 offset:21504
    buffer_load_dwordx4 v9, s[60:63], s99 offen offset:3072 lds
    s_add_u32 s75, s75, 16384
    s_add_u32 s99, s99, 16384
    s_mov_b32 m0, s75
    v_mfma_f32_16x16x32_bf16 v[244:247], a[168:171], a[240:243], v[244:247]
    ds_read_b128 a[168:171], v9 offset:25600
    buffer_load_dwordx4 v9, s[60:63], s99 offen offset:0 lds
    v_permlane16_swap_b32 v52, v53
    v_mfma_f32_16x16x32_bf16 v[248:251], a[172:175], a[236:239], 0
    buffer_load_dwordx4 v9, s[60:63], s99 offen offset:1024 lds
    v_permlane16_swap_b32 v54, v55
    v_mfma_f32_16x16x32_bf16 v[252:255], a[172:175], a[240:243], 0
    ds_read_b128 a[172:175], v9 offset:26624
    buffer_load_dwordx4 v9, s[60:63], s99 offen offset:2048 lds
    v_mfma_f32_16x16x32_bf16 v[160:163], a[176:179], a[244:247], v[160:163]
    buffer_load_dwordx4 v9, s[60:63], s99 offen offset:3072 lds
    s_sub_u32 s75, s75, 131072
    s_add_u32 s99, s99, 16384
    v_mfma_f32_16x16x32_bf16 v[160:163], a[192:195], a[248:251], v[160:163]
    buffer_load_dwordx4 a[108:111], v1, s[16:19], s100 offen
    s_add_u32 s100, s100, 155648
    v_mfma_f32_16x16x32_bf16 v[164:167], a[180:183], a[244:247], v[164:167]
    buffer_load_dwordx4 a[112:115], v1, s[16:19], s101 offen
    s_add_u32 s101, s101, 155648
    v_mfma_f32_16x16x32_bf16 v[164:167], a[196:199], a[248:251], v[164:167]
    buffer_store_dwordx4 v[52:55], v19, s[16:19], s47 offen sc1
    v_fmac_f32 v144, v44, v32
    v_fmac_f32 v145, v45, v32
    v_fmac_f32 v146, v46, v32
    v_fmac_f32 v147, v47, v32
    v_mfma_f32_16x16x32_bf16 v[168:171], a[184:187], a[244:247], v[168:171]
    v_mul_f32 v144, v144, v146
    v_mul_f32 v145, v145, v147
    v_cvt_pk_bf16_f32 v52, v144, v145
    v_fmac_f32 v148, v44, v33
    v_fmac_f32 v149, v45, v33
    v_fmac_f32 v150, v46, v33
    v_mfma_f32_16x16x32_bf16 v[168:171], a[200:203], a[248:251], v[168:171]
    v_fmac_f32 v151, v47, v33
    v_mul_f32 v148, v148, v150
    v_mul_f32 v149, v149, v151
    v_cvt_pk_bf16_f32 v53, v148, v149
    v_fmac_f32 v152, v44, v34
    v_fmac_f32 v153, v45, v34
    v_mfma_f32_16x16x32_bf16 v[172:175], a[188:191], a[244:247], v[172:175]
    v_fmac_f32 v154, v46, v34
    v_fmac_f32 v155, v47, v34
    v_mul_f32 v152, v152, v154
    v_mul_f32 v153, v153, v155
    v_cvt_pk_bf16_f32 v54, v152, v153
    v_fmac_f32 v156, v44, v35
    v_mfma_f32_16x16x32_bf16 v[172:175], a[204:207], a[248:251], v[172:175]
    v_fmac_f32 v157, v45, v35
    v_fmac_f32 v158, v46, v35
    v_fmac_f32 v159, v47, v35
    v_mul_f32 v156, v156, v158
    v_mul_f32 v157, v157, v159
    v_cvt_pk_bf16_f32 v55, v156, v157
    v_mfma_f32_16x16x32_bf16 v[176:179], a[208:211], a[244:247], v[176:179]
    v_permlane32_swap_b32 v52, v54
    v_permlane32_swap_b32 v53, v55
    v_mfma_f32_16x16x32_bf16 v[180:183], a[208:211], a[248:251], v[180:183]
    v_mfma_f32_16x16x32_bf16 v[184:187], a[176:179], a[252:255], v[184:187]
    v_permlane16_swap_b32 v52, v53
    v_permlane16_swap_b32 v54, v55
    buffer_store_dwordx4 v[52:55], v19, s[16:19], s48 offen sc1
    v_mfma_f32_16x16x32_bf16 v[184:187], a[192:195], a[0:3], v[184:187]
    v_mfma_f32_16x16x32_bf16 v[188:191], a[180:183], a[252:255], v[188:191]
    v_mfma_f32_16x16x32_bf16 v[188:191], a[196:199], a[0:3], v[188:191]
    v_mfma_f32_16x16x32_bf16 v[192:195], a[184:187], a[252:255], v[192:195]
    v_mfma_f32_16x16x32_bf16 v[192:195], a[200:203], a[0:3], v[192:195]
    v_mfma_f32_16x16x32_bf16 v[196:199], a[188:191], a[252:255], v[196:199]
    v_mfma_f32_16x16x32_bf16 v[196:199], a[204:207], a[0:3], v[196:199]
    v_mfma_f32_16x16x32_bf16 v[200:203], a[208:211], a[252:255], v[200:203]
    v_mfma_f32_16x16x32_bf16 v[204:207], a[208:211], a[0:3], v[204:207]
    s_waitcnt vmcnt(48)
    v_mfma_f32_16x16x32_bf16 v[208:211], a[176:179], a[4:7], v[208:211]
    v_mfma_f32_16x16x32_bf16 v[208:211], a[192:195], a[8:11], v[208:211]
    v_mfma_f32_16x16x32_bf16 v[212:215], a[180:183], a[4:7], v[212:215]
    v_mfma_f32_16x16x32_bf16 v[212:215], a[196:199], a[8:11], v[212:215]
    v_mfma_f32_16x16x32_bf16 v[216:219], a[184:187], a[4:7], v[216:219]
    v_mfma_f32_16x16x32_bf16 v[216:219], a[200:203], a[8:11], v[216:219]
    v_mfma_f32_16x16x32_bf16 v[220:223], a[188:191], a[4:7], v[220:223]
    v_mfma_f32_16x16x32_bf16 v[220:223], a[204:207], a[8:11], v[220:223]
    v_mfma_f32_16x16x32_bf16 v[224:227], a[208:211], a[4:7], v[224:227]
    v_mfma_f32_16x16x32_bf16 v[228:231], a[208:211], a[8:11], v[228:231]
    v_mfma_f32_16x16x32_bf16 v[232:235], a[176:179], a[12:15], v[232:235]
    ds_read_b128 a[176:179], v9 offset:27648
    v_mfma_f32_16x16x32_bf16 v[232:235], a[192:195], a[16:19], v[232:235]
    ds_read_b128 a[192:195], v9 offset:31744
    v_mfma_f32_16x16x32_bf16 v[236:239], a[180:183], a[12:15], v[236:239]
    ds_read_b128 a[180:183], v9 offset:28672
    v_mfma_f32_16x16x32_bf16 v[236:239], a[196:199], a[16:19], v[236:239]
    ds_read_b128 a[196:199], v9 offset:32768
    v_mfma_f32_16x16x32_bf16 v[240:243], a[184:187], a[12:15], v[240:243]
    ds_read_b128 a[184:187], v9 offset:29696
    v_mfma_f32_16x16x32_bf16 v[240:243], a[200:203], a[16:19], v[240:243]
    ds_read_b128 a[200:203], v9 offset:33792
    v_mfma_f32_16x16x32_bf16 v[244:247], a[188:191], a[12:15], v[244:247]
    ds_read_b128 a[188:191], v9 offset:30720
    v_mfma_f32_16x16x32_bf16 v[244:247], a[204:207], a[16:19], v[244:247]
    ds_read_b128 a[204:207], v9 offset:34816
    v_mfma_f32_16x16x32_bf16 v[248:251], a[208:211], a[12:15], v[248:251]
    v_mfma_f32_16x16x32_bf16 v[252:255], a[208:211], a[16:19], v[252:255]
    s_waitcnt vmcnt(42)
    s_waitcnt lgkmcnt(13)
    v_mfma_f32_16x16x32_bf16 v[160:163], a[140:143], a[20:23], v[160:163]
    buffer_load_dword v7, v4, s[64:67], s50 offen offset:256 sc1
    v_mfma_f32_16x16x32_bf16 v[160:163], a[156:159], a[24:27], v[160:163]
    buffer_load_dwordx4 a[100:103], v27, s[16:19], s97 offen
    v_mfma_f32_16x16x32_bf16 v[164:167], a[144:147], a[20:23], v[164:167]
    s_waitcnt vmcnt(29)
    s_barrier
    v_mfma_f32_16x16x32_bf16 v[164:167], a[160:163], a[24:27], v[164:167]
    ds_read_b128 a[208:211], v9 offset:35840
    s_waitcnt lgkmcnt(9)
    v_mfma_f32_16x16x32_bf16 v[168:171], a[148:151], a[20:23], v[168:171]
    buffer_load_dwordx4 a[104:107], v27, s[16:19], s98 offen
    v_mfma_f32_16x16x32_bf16 v[168:171], a[164:167], a[24:27], v[168:171]
    buffer_load_dwordx4 a[116:119], v3, s[16:19], s97 offen
    v_mfma_f32_16x16x32_bf16 v[172:175], a[152:155], a[20:23], v[172:175]
    s_add_u32 s97, s97, 8192
    s_mov_b32 m0, s75
    v_mfma_f32_16x16x32_bf16 v[172:175], a[168:171], a[24:27], v[172:175]
    buffer_load_dwordx4 v9, s[60:63], s99 offen offset:0 lds
    v_mfma_f32_16x16x32_bf16 v[176:179], a[172:175], a[20:23], v[176:179]
    buffer_load_dwordx4 v9, s[60:63], s99 offen offset:1024 lds
    v_mfma_f32_16x16x32_bf16 v[180:183], a[172:175], a[24:27], v[180:183]
    v_mfma_f32_16x16x32_bf16 v[184:187], a[140:143], a[28:31], v[184:187]
    v_mfma_f32_16x16x32_bf16 v[184:187], a[156:159], a[32:35], v[184:187]
    s_waitcnt vmcnt(17)
    v_mfma_f32_16x16x32_bf16 v[188:191], a[144:147], a[28:31], v[188:191]
    buffer_load_dwordx4 a[120:123], v3, s[16:19], s98 offen
    v_mfma_f32_16x16x32_bf16 v[188:191], a[160:163], a[32:35], v[188:191]
    s_add_u32 s98, s98, 8192
    v_mfma_f32_16x16x32_bf16 v[192:195], a[148:151], a[28:31], v[192:195]
    buffer_load_dwordx4 v9, s[60:63], s99 offen offset:2048 lds
    v_mfma_f32_16x16x32_bf16 v[192:195], a[164:167], a[32:35], v[192:195]
    v_mfma_f32_16x16x32_bf16 v[196:199], a[152:155], a[28:31], v[196:199]
    v_mfma_f32_16x16x32_bf16 v[196:199], a[168:171], a[32:35], v[196:199]
    v_mfma_f32_16x16x32_bf16 v[200:203], a[172:175], a[28:31], v[200:203]
    v_mfma_f32_16x16x32_bf16 v[204:207], a[172:175], a[32:35], v[204:207]
    v_mfma_f32_16x16x32_bf16 v[208:211], a[140:143], a[36:39], v[208:211]
    buffer_load_dwordx4 a[124:127], v24, s[16:19], s97 offen
    v_mfma_f32_16x16x32_bf16 v[208:211], a[156:159], a[40:43], v[208:211]
    buffer_load_dwordx4 a[128:131], v24, s[16:19], s98 offen
    v_mfma_f32_16x16x32_bf16 v[212:215], a[144:147], a[36:39], v[212:215]
    buffer_load_dwordx4 v9, s[60:63], s99 offen offset:3072 lds
    v_mfma_f32_16x16x32_bf16 v[212:215], a[160:163], a[40:43], v[212:215]
    s_sub_u32 s99, s99, s75
    s_bfe_u32 s75, s75, 0x1000c
    v_mfma_f32_16x16x32_bf16 v[216:219], a[148:151], a[36:39], v[216:219]
    s_lshl_b32 s75, s75, 10
    s_add_u32 s75, s75, 16384
    v_mfma_f32_16x16x32_bf16 v[216:219], a[164:167], a[40:43], v[216:219]
    s_add_u32 s99, s99, s75
    v_mfma_f32_16x16x32_bf16 v[220:223], a[152:155], a[36:39], v[220:223]
    s_mov_b32 m0, s75
    v_mfma_f32_16x16x32_bf16 v[220:223], a[168:171], a[40:43], v[220:223]
    buffer_load_dwordx4 v9, s[60:63], s99 offen offset:0 lds
    v_mfma_f32_16x16x32_bf16 v[224:227], a[172:175], a[36:39], v[224:227]
    v_mfma_f32_16x16x32_bf16 v[228:231], a[172:175], a[40:43], v[228:231]
    v_mfma_f32_16x16x32_bf16 v[232:235], a[140:143], a[44:47], v[232:235]
    buffer_load_dwordx4 a[132:135], v27, s[16:19], s97 offen
    v_mfma_f32_16x16x32_bf16 v[232:235], a[156:159], a[48:51], v[232:235]
    buffer_load_dwordx4 a[136:139], v27, s[16:19], s98 offen
    v_mfma_f32_16x16x32_bf16 v[236:239], a[144:147], a[44:47], v[236:239]
    ds_read_b128 a[140:143], v9 offset:36864
    ds_read_b128 a[156:159], v9 offset:40960
    v_mfma_f32_16x16x32_bf16 v[236:239], a[160:163], a[48:51], v[236:239]
    ds_read_b128 a[144:147], v9 offset:37888
    ds_read_b128 a[160:163], v9 offset:41984
    v_mfma_f32_16x16x32_bf16 v[240:243], a[148:151], a[44:47], v[240:243]
    ds_read_b128 a[148:151], v9 offset:38912
    v_mfma_f32_16x16x32_bf16 v[240:243], a[164:167], a[48:51], v[240:243]
    ds_read_b128 a[164:167], v9 offset:43008
    v_mfma_f32_16x16x32_bf16 v[244:247], a[152:155], a[44:47], v[244:247]
    ds_read_b128 a[152:155], v9 offset:39936
    v_mfma_f32_16x16x32_bf16 v[244:247], a[168:171], a[48:51], v[244:247]
    ds_read_b128 a[168:171], v9 offset:44032
    v_mfma_f32_16x16x32_bf16 v[248:251], a[172:175], a[44:47], v[248:251]
    v_mfma_f32_16x16x32_bf16 v[252:255], a[172:175], a[48:51], v[252:255]
    ds_read_b128 a[172:175], v9 offset:45056
    s_waitcnt lgkmcnt(14)
    v_mfma_f32_16x16x32_bf16 v[160:163], a[176:179], a[52:55], v[160:163]
    s_waitcnt vmcnt(14)
    v_mfma_f32_16x16x32_bf16 v[160:163], a[192:195], a[56:59], v[160:163]
    buffer_store_dword v6, v5, s[64:67], s49 offen offset:512 sc1
    v_mfma_f32_16x16x32_bf16 v[164:167], a[180:183], a[52:55], v[164:167]
    buffer_load_dwordx4 a[212:215], v3, s[16:19], s97 offen
    v_mfma_f32_16x16x32_bf16 v[164:167], a[196:199], a[56:59], v[164:167]
    s_add_u32 s97, s97, 155648
    s_waitcnt lgkmcnt(9)
    v_mfma_f32_16x16x32_bf16 v[168:171], a[184:187], a[52:55], v[168:171]
    buffer_load_dwordx4 a[216:219], v3, s[16:19], s98 offen
    v_mfma_f32_16x16x32_bf16 v[168:171], a[200:203], a[56:59], v[168:171]
    s_add_u32 s98, s98, 155648
    v_mfma_f32_16x16x32_bf16 v[172:175], a[188:191], a[52:55], v[172:175]
    v_mfma_f32_16x16x32_bf16 v[172:175], a[204:207], a[56:59], v[172:175]
    v_mfma_f32_16x16x32_bf16 v[176:179], a[208:211], a[52:55], v[176:179]
    v_mfma_f32_16x16x32_bf16 v[180:183], a[208:211], a[56:59], v[180:183]
    v_mfma_f32_16x16x32_bf16 v[184:187], a[176:179], a[60:63], v[184:187]
    s_waitcnt vmcnt(16)
    v_mfma_f32_16x16x32_bf16 v[184:187], a[192:195], a[64:67], v[184:187]
    v_cmp_eq_u32 vcc, 0, v7
    s_nop 3
    s_cbranch_vccnz POLL_SLOW1
POLL_OK1:
    v_mfma_f32_16x16x32_bf16 v[188:191], a[180:183], a[60:63], v[188:191]
    buffer_load_dwordx4 a[220:223], v24, s[16:19], s97 offen
    v_mfma_f32_16x16x32_bf16 v[188:191], a[196:199], a[64:67], v[188:191]
    buffer_load_dwordx4 a[224:227], v24, s[16:19], s98 offen
    v_mfma_f32_16x16x32_bf16 v[192:195], a[184:187], a[60:63], v[192:195]
    v_mfma_f32_16x16x32_bf16 v[192:195], a[200:203], a[64:67], v[192:195]
    v_mfma_f32_16x16x32_bf16 v[196:199], a[188:191], a[60:63], v[196:199]
    v_mfma_f32_16x16x32_bf16 v[196:199], a[204:207], a[64:67], v[196:199]
    v_mfma_f32_16x16x32_bf16 v[200:203], a[208:211], a[60:63], v[200:203]
    v_mfma_f32_16x16x32_bf16 v[204:207], a[208:211], a[64:67], v[204:207]
    v_mfma_f32_16x16x32_bf16 v[208:211], a[176:179], a[68:71], v[208:211]
    buffer_load_dwordx4 a[228:231], v27, s[16:19], s97 offen
    v_mfma_f32_16x16x32_bf16 v[208:211], a[192:195], a[72:75], v[208:211]
    buffer_load_dwordx4 a[232:235], v27, s[16:19], s98 offen
    v_mfma_f32_16x16x32_bf16 v[212:215], a[180:183], a[68:71], v[212:215]
    v_mfma_f32_16x16x32_bf16 v[212:215], a[196:199], a[72:75], v[212:215]
    v_mfma_f32_16x16x32_bf16 v[216:219], a[184:187], a[68:71], v[216:219]
    v_mfma_f32_16x16x32_bf16 v[216:219], a[200:203], a[72:75], v[216:219]
    v_mfma_f32_16x16x32_bf16 v[220:223], a[188:191], a[68:71], v[220:223]
    v_mfma_f32_16x16x32_bf16 v[220:223], a[204:207], a[72:75], v[220:223]
    v_mfma_f32_16x16x32_bf16 v[224:227], a[208:211], a[68:71], v[224:227]
    v_mfma_f32_16x16x32_bf16 v[228:231], a[208:211], a[72:75], v[228:231]
    v_mfma_f32_16x16x32_bf16 v[232:235], a[176:179], a[76:79], v[232:235]
    buffer_load_dwordx4 a[236:239], v3, s[16:19], s97 offen
    v_mfma_f32_16x16x32_bf16 v[232:235], a[192:195], a[80:83], v[232:235]
    s_add_u32 s97, s97, 8192
    ds_read_b128 a[176:179], v9 offset:46080
    v_mfma_f32_16x16x32_bf16 v[236:239], a[180:183], a[76:79], v[236:239]
    buffer_load_dwordx4 a[240:243], v3, s[16:19], s98 offen
    v_mfma_f32_16x16x32_bf16 v[236:239], a[196:199], a[80:83], v[236:239]
    s_add_u32 s98, s98, 8192
    ds_read_b128 a[192:195], v9 offset:50176
    v_mfma_f32_16x16x32_bf16 v[240:243], a[184:187], a[76:79], v[240:243]
    ds_read_b128 a[180:183], v9 offset:47104
    ds_read_b128 a[196:199], v9 offset:51200
    v_mfma_f32_16x16x32_bf16 v[240:243], a[200:203], a[80:83], v[240:243]
    ds_read_b128 a[184:187], v9 offset:48128
    ds_read_b128 a[200:203], v9 offset:52224
    v_mfma_f32_16x16x32_bf16 v[244:247], a[188:191], a[76:79], v[244:247]
    ds_read_b128 a[188:191], v9 offset:49152
    v_mfma_f32_16x16x32_bf16 v[244:247], a[204:207], a[80:83], v[244:247]
    ds_read_b128 a[204:207], v9 offset:53248
    v_mfma_f32_16x16x32_bf16 v[248:251], a[208:211], a[76:79], v[248:251]
    v_mfma_f32_16x16x32_bf16 v[252:255], a[208:211], a[80:83], v[252:255]
    ds_read_b128 a[208:211], v9 offset:54272
    s_waitcnt lgkmcnt(14)
    v_mfma_f32_16x16x32_bf16 v[160:163], a[140:143], a[84:87], v[160:163]
    buffer_load_dwordx4 a[244:247], v24, s[16:19], s97 offen
    v_mfma_f32_16x16x32_bf16 v[160:163], a[156:159], a[88:91], v[160:163]
    buffer_load_dwordx4 a[248:251], v24, s[16:19], s98 offen
    v_mfma_f32_16x16x32_bf16 v[164:167], a[144:147], a[84:87], v[164:167]
    v_mfma_f32_16x16x32_bf16 v[164:167], a[160:163], a[88:91], v[164:167]
    s_waitcnt lgkmcnt(9)
    v_mfma_f32_16x16x32_bf16 v[168:171], a[148:151], a[84:87], v[168:171]
    v_mfma_f32_16x16x32_bf16 v[168:171], a[164:167], a[88:91], v[168:171]
    v_mfma_f32_16x16x32_bf16 v[172:175], a[152:155], a[84:87], v[172:175]
    v_mfma_f32_16x16x32_bf16 v[172:175], a[168:171], a[88:91], v[172:175]
    v_mfma_f32_16x16x32_bf16 v[176:179], a[172:175], a[84:87], v[176:179]
    v_mfma_f32_16x16x32_bf16 v[180:183], a[172:175], a[88:91], v[180:183]
    v_mfma_f32_16x16x32_bf16 v[184:187], a[140:143], a[92:95], v[184:187]
    buffer_load_dwordx4 a[252:255], v27, s[16:19], s97 offen
    v_mfma_f32_16x16x32_bf16 v[184:187], a[156:159], a[96:99], v[184:187]
    buffer_load_dwordx4 a[0:3], v27, s[16:19], s98 offen
    v_mfma_f32_16x16x32_bf16 v[188:191], a[144:147], a[92:95], v[188:191]
    v_mfma_f32_16x16x32_bf16 v[188:191], a[160:163], a[96:99], v[188:191]
    v_mfma_f32_16x16x32_bf16 v[192:195], a[148:151], a[92:95], v[192:195]
    v_mfma_f32_16x16x32_bf16 v[192:195], a[164:167], a[96:99], v[192:195]
    v_mfma_f32_16x16x32_bf16 v[196:199], a[152:155], a[92:95], v[196:199]
    v_mfma_f32_16x16x32_bf16 v[196:199], a[168:171], a[96:99], v[196:199]
    v_mfma_f32_16x16x32_bf16 v[200:203], a[172:175], a[92:95], v[200:203]
    v_mfma_f32_16x16x32_bf16 v[204:207], a[172:175], a[96:99], v[204:207]
    s_waitcnt vmcnt(20)
    v_mfma_f32_16x16x32_bf16 v[208:211], a[140:143], a[100:103], v[208:211]
    buffer_load_dwordx4 a[4:7], v3, s[16:19], s97 offen
    v_mfma_f32_16x16x32_bf16 v[208:211], a[156:159], a[104:107], v[208:211]
    s_add_u32 s97, s97, 8192
    v_mfma_f32_16x16x32_bf16 v[212:215], a[144:147], a[100:103], v[212:215]
    buffer_load_dwordx4 a[8:11], v3, s[16:19], s98 offen
    v_mfma_f32_16x16x32_bf16 v[212:215], a[160:163], a[104:107], v[212:215]
    s_add_u32 s98, s98, 8192
    v_mfma_f32_16x16x32_bf16 v[216:219], a[148:151], a[100:103], v[216:219]
    v_mfma_f32_16x16x32_bf16 v[216:219], a[164:167], a[104:107], v[216:219]
    v_mfma_f32_16x16x32_bf16 v[220:223], a[152:155], a[100:103], v[220:223]
    v_mfma_f32_16x16x32_bf16 v[220:223], a[168:171], a[104:107], v[220:223]
    v_mfma_f32_16x16x32_bf16 v[224:227], a[172:175], a[100:103], v[224:227]
    v_mfma_f32_16x16x32_bf16 v[228:231], a[172:175], a[104:107], v[228:231]
    v_mfma_f32_16x16x32_bf16 v[232:235], a[140:143], a[116:119], v[232:235]
    buffer_load_dwordx4 a[12:15], v24, s[16:19], s97 offen
    v_mfma_f32_16x16x32_bf16 v[232:235], a[156:159], a[120:123], v[232:235]
    buffer_load_dwordx4 a[16:19], v24, s[16:19], s98 offen
    v_mfma_f32_16x16x32_bf16 v[236:239], a[144:147], a[116:119], v[236:239]
    ds_read_b128 a[140:143], v9 offset:55296
    ds_read_b128 a[156:159], v9 offset:59392
    v_mfma_f32_16x16x32_bf16 v[236:239], a[160:163], a[120:123], v[236:239]
    ds_read_b128 a[144:147], v9 offset:56320
    ds_read_b128 a[160:163], v9 offset:60416
    v_mfma_f32_16x16x32_bf16 v[240:243], a[148:151], a[116:119], v[240:243]
    ds_read_b128 a[148:151], v9 offset:57344
    v_mfma_f32_16x16x32_bf16 v[240:243], a[164:167], a[120:123], v[240:243]
    ds_read_b128 a[164:167], v9 offset:61440
    v_mfma_f32_16x16x32_bf16 v[244:247], a[152:155], a[116:119], v[244:247]
    ds_read_b128 a[152:155], v9 offset:58368
    v_mfma_f32_16x16x32_bf16 v[244:247], a[168:171], a[120:123], v[244:247]
    ds_read_b128 a[168:171], v9 offset:62464
    v_mfma_f32_16x16x32_bf16 v[248:251], a[172:175], a[116:119], v[248:251]
    v_mfma_f32_16x16x32_bf16 v[252:255], a[172:175], a[120:123], v[252:255]
    s_waitcnt vmcnt(21)
    s_waitcnt lgkmcnt(13)
    v_mfma_f32_16x16x32_bf16 v[184:187], a[176:179], a[124:127], v[184:187]
    buffer_load_dwordx4 a[20:23], v27, s[16:19], s97 offen
    v_mfma_f32_16x16x32_bf16 v[184:187], a[192:195], a[128:131], v[184:187]
    buffer_load_dwordx4 a[24:27], v27, s[16:19], s98 offen
    v_mfma_f32_16x16x32_bf16 v[188:191], a[180:183], a[124:127], v[188:191]
    ds_read_b128 a[172:175], v9 offset:63488
    v_mfma_f32_16x16x32_bf16 v[188:191], a[196:199], a[128:131], v[188:191]
    s_waitcnt lgkmcnt(9)
    v_mfma_f32_16x16x32_bf16 v[192:195], a[184:187], a[124:127], v[192:195]
    v_mfma_f32_16x16x32_bf16 v[192:195], a[200:203], a[128:131], v[192:195]
    v_mfma_f32_16x16x32_bf16 v[196:199], a[188:191], a[124:127], v[196:199]
    v_mfma_f32_16x16x32_bf16 v[196:199], a[204:207], a[128:131], v[196:199]
    v_mfma_f32_16x16x32_bf16 v[200:203], a[208:211], a[124:127], v[200:203]
    v_mfma_f32_16x16x32_bf16 v[204:207], a[208:211], a[128:131], v[204:207]
    s_waitcnt vmcnt(16)
    v_mfma_f32_16x16x32_bf16 v[208:211], a[176:179], a[132:135], v[208:211]
    buffer_load_dwordx4 a[28:31], v3, s[16:19], s97 offen
    v_mfma_f32_16x16x32_bf16 v[208:211], a[192:195], a[136:139], v[208:211]
    s_add_u32 s97, s97, 8192
    v_mfma_f32_16x16x32_bf16 v[212:215], a[180:183], a[132:135], v[212:215]
    buffer_load_dwordx4 a[32:35], v3, s[16:19], s98 offen
    v_mfma_f32_16x16x32_bf16 v[212:215], a[196:199], a[136:139], v[212:215]
    s_add_u32 s98, s98, 8192
    v_mfma_f32_16x16x32_bf16 v[216:219], a[184:187], a[132:135], v[216:219]
    v_mfma_f32_16x16x32_bf16 v[216:219], a[200:203], a[136:139], v[216:219]
    v_mfma_f32_16x16x32_bf16 v[220:223], a[188:191], a[132:135], v[220:223]
    v_mfma_f32_16x16x32_bf16 v[220:223], a[204:207], a[136:139], v[220:223]
    v_mfma_f32_16x16x32_bf16 v[224:227], a[208:211], a[132:135], v[224:227]
    v_mfma_f32_16x16x32_bf16 v[228:231], a[208:211], a[136:139], v[228:231]
    v_mfma_f32_16x16x32_bf16 v[232:235], a[176:179], a[212:215], v[232:235]
    buffer_load_dwordx4 a[36:39], v24, s[16:19], s97 offen
    v_mfma_f32_16x16x32_bf16 v[232:235], a[192:195], a[216:219], v[232:235]
    buffer_load_dwordx4 a[40:43], v24, s[16:19], s98 offen
    v_mfma_f32_16x16x32_bf16 v[236:239], a[180:183], a[212:215], v[236:239]
    ds_read_b128 a[176:179], v9 offset:64512
    ds_read_b128 a[192:195], v10 offset:3072
    v_mfma_f32_16x16x32_bf16 v[236:239], a[196:199], a[216:219], v[236:239]
    ds_read_b128 a[180:183], v10 offset:0
    ds_read_b128 a[196:199], v10 offset:4096
    v_mfma_f32_16x16x32_bf16 v[240:243], a[184:187], a[212:215], v[240:243]
    ds_read_b128 a[184:187], v10 offset:1024
    v_mfma_f32_16x16x32_bf16 v[240:243], a[200:203], a[216:219], v[240:243]
    ds_read_b128 a[200:203], v10 offset:5120
    v_mfma_f32_16x16x32_bf16 v[244:247], a[188:191], a[212:215], v[244:247]
    ds_read_b128 a[188:191], v10 offset:2048
    v_mfma_f32_16x16x32_bf16 v[244:247], a[204:207], a[216:219], v[244:247]
    ds_read_b128 a[204:207], v10 offset:6144
    v_mfma_f32_16x16x32_bf16 v[248:251], a[208:211], a[212:215], v[248:251]
    v_mfma_f32_16x16x32_bf16 v[252:255], a[208:211], a[216:219], v[252:255]
    s_waitcnt vmcnt(18)
    s_waitcnt lgkmcnt(13)
    v_mfma_f32_16x16x32_bf16 v[184:187], a[140:143], a[220:223], v[184:187]
    buffer_load_dwordx4 a[44:47], v27, s[16:19], s97 offen
    v_mfma_f32_16x16x32_bf16 v[184:187], a[156:159], a[224:227], v[184:187]
    buffer_load_dwordx4 a[48:51], v27, s[16:19], s98 offen
    v_mfma_f32_16x16x32_bf16 v[188:191], a[144:147], a[220:223], v[188:191]
    ds_read_b128 a[208:211], v10 offset:7168
    v_mfma_f32_16x16x32_bf16 v[188:191], a[160:163], a[224:227], v[188:191]
    s_waitcnt lgkmcnt(9)
    v_mfma_f32_16x16x32_bf16 v[192:195], a[148:151], a[220:223], v[192:195]
    v_mfma_f32_16x16x32_bf16 v[192:195], a[164:167], a[224:227], v[192:195]
    v_mfma_f32_16x16x32_bf16 v[196:199], a[152:155], a[220:223], v[196:199]
    v_mfma_f32_16x16x32_bf16 v[196:199], a[168:171], a[224:227], v[196:199]
    v_mfma_f32_16x16x32_bf16 v[200:203], a[172:175], a[220:223], v[200:203]
    v_mfma_f32_16x16x32_bf16 v[204:207], a[172:175], a[224:227], v[204:207]
    s_waitcnt vmcnt(16)
    v_mfma_f32_16x16x32_bf16 v[208:211], a[140:143], a[228:231], v[208:211]
    buffer_load_dwordx4 a[52:55], v3, s[16:19], s97 offen
    v_mfma_f32_16x16x32_bf16 v[208:211], a[156:159], a[232:235], v[208:211]
    s_add_u32 s97, s97, 8192
    v_mfma_f32_16x16x32_bf16 v[212:215], a[144:147], a[228:231], v[212:215]
    buffer_load_dwordx4 a[56:59], v3, s[16:19], s98 offen
    v_mfma_f32_16x16x32_bf16 v[212:215], a[160:163], a[232:235], v[212:215]
    s_add_u32 s98, s98, 8192
    v_mfma_f32_16x16x32_bf16 v[216:219], a[148:151], a[228:231], v[216:219]
    v_mfma_f32_16x16x32_bf16 v[216:219], a[164:167], a[232:235], v[216:219]
    v_mfma_f32_16x16x32_bf16 v[220:223], a[152:155], a[228:231], v[220:223]
    v_mfma_f32_16x16x32_bf16 v[220:223], a[168:171], a[232:235], v[220:223]
    v_mfma_f32_16x16x32_bf16 v[224:227], a[172:175], a[228:231], v[224:227]
    v_mfma_f32_16x16x32_bf16 v[228:231], a[172:175], a[232:235], v[228:231]
    v_mfma_f32_16x16x32_bf16 v[232:235], a[140:143], a[236:239], v[232:235]
    buffer_load_dwordx4 a[60:63], v24, s[16:19], s97 offen
    v_mfma_f32_16x16x32_bf16 v[232:235], a[156:159], a[240:243], v[232:235]
    buffer_load_dwordx4 a[64:67], v24, s[16:19], s98 offen
    v_mfma_f32_16x16x32_bf16 v[236:239], a[144:147], a[236:239], v[236:239]
    ds_read_b128 a[140:143], v10 offset:8192
    ds_read_b128 a[156:159], v10 offset:12288
    v_mfma_f32_16x16x32_bf16 v[236:239], a[160:163], a[240:243], v[236:239]
    ds_read_b128 a[144:147], v10 offset:9216
    ds_read_b128 a[160:163], v10 offset:13312
    v_mfma_f32_16x16x32_bf16 v[240:243], a[148:151], a[236:239], v[240:243]
    ds_read_b128 a[148:151], v10 offset:10240
    v_mfma_f32_16x16x32_bf16 v[240:243], a[164:167], a[240:243], v[240:243]
    ds_read_b128 a[164:167], v10 offset:14336
    v_mfma_f32_16x16x32_bf16 v[244:247], a[152:155], a[236:239], v[244:247]
    ds_read_b128 a[152:155], v10 offset:11264
    v_mfma_f32_16x16x32_bf16 v[244:247], a[168:171], a[240:243], v[244:247]
    ds_read_b128 a[168:171], v10 offset:15360
    v_mfma_f32_16x16x32_bf16 v[248:251], a[172:175], a[236:239], v[248:251]
    v_mfma_f32_16x16x32_bf16 v[252:255], a[172:175], a[240:243], v[252:255]
    s_waitcnt vmcnt(18)
    s_waitcnt lgkmcnt(13)
    v_mfma_f32_16x16x32_bf16 v[184:187], a[176:179], a[244:247], v[184:187]
    s_barrier
    ds_read_b128 a[172:175], v10 offset:16384
    v_mfma_f32_16x16x32_bf16 v[184:187], a[192:195], a[248:251], v[184:187]
    buffer_load_dword v7, v4, s[64:67], s50 offen offset:512 sc1
    v_mfma_f32_16x16x32_bf16 v[188:191], a[180:183], a[244:247], v[188:191]
    buffer_load_dwordx4 a[68:71], v27, s[16:19], s97 offen
    v_mfma_f32_16x16x32_bf16 v[188:191], a[196:199], a[248:251], v[188:191]
    v_lshrrev_b32 v25, 1, v2
    s_waitcnt lgkmcnt(9)
    v_mfma_f32_16x16x32_bf16 v[192:195], a[184:187], a[244:247], v[192:195]
    buffer_load_dwordx4 a[72:75], v27, s[16:19], s98 offen
    v_mfma_f32_16x16x32_bf16 v[192:195], a[200:203], a[248:251], v[192:195]
    v_lshlrev_b32 v25, 8, v25
    v_and_b32 v26, 1, v2
    v_mfma_f32_16x16x32_bf16 v[196:199], a[188:191], a[244:247], v[196:199]
    v_lshl_add_u32 v25, v26, 4, v25
    s_mul_i32 s38, s73, 18432
    v_mfma_f32_16x16x32_bf16 v[196:199], a[204:207], a[248:251], v[196:199]
    s_lshr_b32 s39, s72, 1
    s_mul_i32 s39, s39, 147456
    v_mfma_f32_16x16x32_bf16 v[200:203], a[208:211], a[244:247], v[200:203]
    s_add_u32 s38, s38, s39
    s_and_b32 s39, s72, 1
    v_mfma_f32_16x16x32_bf16 v[204:207], a[208:211], a[248:251], v[204:207]
    s_lshl_b32 s39, s39, 2
    s_waitcnt vmcnt(17)
    v_mfma_f32_16x16x32_bf16 v[208:211], a[176:179], a[252:255], v[208:211]
    buffer_load_dwordx4 a[76:79], v3, s[16:19], s97 offen
    v_mfma_f32_16x16x32_bf16 v[208:211], a[192:195], a[0:3], v[208:211]
    s_add_u32 s97, s97, 8192
    s_add_u32 s39, s39, s74
    v_mfma_f32_16x16x32_bf16 v[212:215], a[180:183], a[252:255], v[212:215]
    buffer_load_dwordx4 a[80:83], v3, s[16:19], s98 offen
    v_mfma_f32_16x16x32_bf16 v[212:215], a[196:199], a[0:3], v[212:215]
    s_add_u32 s98, s98, 8192
    s_lshl_b32 s39, s39, 5
    v_mfma_f32_16x16x32_bf16 v[216:219], a[184:187], a[252:255], v[216:219]
    s_add_u32 s38, s38, s39
    s_mul_i32 s31, s28, 3072
    v_mfma_f32_16x16x32_bf16 v[216:219], a[200:203], a[0:3], v[216:219]
    s_add_u32 s31, s31, 148480
    s_add_u32 s32, s31, 0
    v_mfma_f32_16x16x32_bf16 v[220:223], a[188:191], a[252:255], v[220:223]
    s_mov_b32 m0, s32
    s_add_u32 s39, s38, 0
    v_mfma_f32_16x16x32_bf16 v[220:223], a[204:207], a[0:3], v[220:223]
    buffer_load_dwordx4 v25, s[8:11], s39 offen lds
    v_mfma_f32_16x16x32_bf16 v[224:227], a[208:211], a[252:255], v[224:227]
    s_add_u32 s32, s31, 1024
    s_mov_b32 m0, s32
    v_mfma_f32_16x16x32_bf16 v[228:231], a[208:211], a[0:3], v[228:231]
    s_add_u32 s39, s38, 8192
    v_mfma_f32_16x16x32_bf16 v[232:235], a[176:179], a[4:7], v[232:235]
    buffer_load_dwordx4 a[84:87], v24, s[16:19], s97 offen
    v_mfma_f32_16x16x32_bf16 v[232:235], a[192:195], a[8:11], v[232:235]
    buffer_load_dwordx4 a[88:91], v24, s[16:19], s98 offen
    v_mfma_f32_16x16x32_bf16 v[236:239], a[180:183], a[4:7], v[236:239]
    ds_read_b128 a[176:179], v10 offset:17408
    ds_read_b128 a[192:195], v10 offset:21504
    v_mfma_f32_16x16x32_bf16 v[236:239], a[196:199], a[8:11], v[236:239]
    ds_read_b128 a[180:183], v10 offset:18432
    ds_read_b128 a[196:199], v10 offset:22528
    v_mfma_f32_16x16x32_bf16 v[240:243], a[184:187], a[4:7], v[240:243]
    ds_read_b128 a[184:187], v10 offset:19456
    v_mfma_f32_16x16x32_bf16 v[240:243], a[200:203], a[8:11], v[240:243]
    ds_read_b128 a[200:203], v10 offset:23552
    v_mfma_f32_16x16x32_bf16 v[244:247], a[188:191], a[4:7], v[244:247]
    ds_read_b128 a[188:191], v10 offset:20480
    v_mfma_f32_16x16x32_bf16 v[244:247], a[204:207], a[8:11], v[244:247]
    ds_read_b128 a[204:207], v10 offset:24576
    v_mfma_f32_16x16x32_bf16 v[248:251], a[208:211], a[4:7], v[248:251]
    buffer_load_dwordx4 v25, s[8:11], s39 offen lds
    v_mfma_f32_16x16x32_bf16 v[252:255], a[208:211], a[8:11], v[252:255]
    s_waitcnt vmcnt(21)
    s_waitcnt lgkmcnt(13)
    v_mfma_f32_16x16x32_bf16 v[184:187], a[140:143], a[12:15], v[184:187]
    buffer_load_dwordx4 a[92:95], v27, s[16:19], s97 offen
    v_mfma_f32_16x16x32_bf16 v[184:187], a[156:159], a[16:19], v[184:187]
    buffer_load_dwordx4 a[96:99], v27, s[16:19], s98 offen
    v_mfma_f32_16x16x32_bf16 v[188:191], a[144:147], a[12:15], v[188:191]
    ds_read_b128 a[208:211], v10 offset:25600
    s_add_u32 s32, s31, 2048
    v_mfma_f32_16x16x32_bf16 v[188:191], a[160:163], a[16:19], v[188:191]
    s_mov_b32 m0, s32
    s_waitcnt lgkmcnt(9)
    v_mfma_f32_16x16x32_bf16 v[192:195], a[148:151], a[12:15], v[192:195]
    s_add_u32 s39, s38, 16384
    v_mfma_f32_16x16x32_bf16 v[192:195], a[164:167], a[16:19], v[192:195]
    buffer_load_dwordx4 v25, s[8:11], s39 offen lds
    v_mfma_f32_16x16x32_bf16 v[196:199], a[152:155], a[12:15], v[196:199]
    s_lshl_b32 s39, s72, 8
    s_mul_i32 s32, s74, 8256
    v_mfma_f32_16x16x32_bf16 v[196:199], a[168:171], a[16:19], v[196:199]
    s_add_u32 s39, s39, s32
    v_mfma_f32_16x16x32_bf16 v[200:203], a[172:175], a[12:15], v[200:203]
    buffer_load_dword v14, v4, s[24:27], s39 offen sc1
    v_mfma_f32_16x16x32_bf16 v[204:207], a[172:175], a[16:19], v[204:207]
    v_and_b32 v25, 15, v2
    s_waitcnt vmcnt(21)
    v_mfma_f32_16x16x32_bf16 v[208:211], a[140:143], a[20:23], v[208:211]
    buffer_load_dwordx4 a[100:103], v3, s[16:19], s97 offen
    v_mfma_f32_16x16x32_bf16 v[208:211], a[156:159], a[24:27], v[208:211]
    s_add_u32 s97, s97, 155648
    v_lshl_add_u32 v25, v25, 3, s31
    v_mfma_f32_16x16x32_bf16 v[212:215], a[144:147], a[20:23], v[212:215]
    buffer_load_dwordx4 a[104:107], v3, s[16:19], s98 offen
    v_mfma_f32_16x16x32_bf16 v[212:215], a[160:163], a[24:27], v[212:215]
    s_add_u32 s98, s98, 155648
    v_lshrrev_b32 v26, 4, v2
    v_mfma_f32_16x16x32_bf16 v[216:219], a[148:151], a[20:23], v[216:219]
    v_lshl_add_u32 v15, v26, 8, v25
    v_and_b32 v17, 15, v2
    v_mfma_f32_16x16x32_bf16 v[216:219], a[164:167], a[24:27], v[216:219]
    v_mul_u32_u24 v17, 1152, v17
    v_lshl_add_u32 v8, v26, 4, v17
    v_mfma_f32_16x16x32_bf16 v[220:223], a[152:155], a[20:23], v[220:223]
    v_and_b32 v26, 1, v26
    v_lshl_add_u32 v16, v26, 7, v25
    v_mfma_f32_16x16x32_bf16 v[220:223], a[168:171], a[24:27], v[220:223]
    v_lshl_add_u32 v17, v26, 3, v17
    v_lshrrev_b32 v26, 5, v2
    v_mfma_f32_16x16x32_bf16 v[224:227], a[172:175], a[20:23], v[224:227]
    v_lshl_add_u32 v17, v26, 30, v17
    v_lshlrev_b32 v12, 3, v2
    v_mfma_f32_16x16x32_bf16 v[228:231], a[172:175], a[24:27], v[228:231]
    v_and_b32 v13, 3, v2
    v_max_u32 v13, 1, v13
    v_mfma_f32_16x16x32_bf16 v[232:235], a[140:143], a[28:31], v[232:235]
    s_waitcnt vmcnt(14)
    ds_read_b128 a[140:143], v10 offset:26624
    v_mfma_f32_16x16x32_bf16 v[232:235], a[156:159], a[32:35], v[232:235]
    v_cmp_eq_u32 vcc, 0, v7
    s_nop 3
    s_cbranch_vccnz POLL_SLOW2
POLL_OK2:
    v_mfma_f32_16x16x32_bf16 v[236:239], a[144:147], a[28:31], v[236:239]
    buffer_load_dwordx4 a[116:119], v24, s[16:19], s97 offen
    v_mfma_f32_16x16x32_bf16 v[236:239], a[160:163], a[32:35], v[236:239]
    buffer_load_dwordx4 a[120:123], v24, s[16:19], s98 offen
    v_mfma_f32_16x16x32_bf16 v[240:243], a[148:151], a[28:31], v[240:243]
    ds_read_b128 a[156:159], v10 offset:30720
    ds_read_b128 a[144:147], v10 offset:27648
    v_mfma_f32_16x16x32_bf16 v[240:243], a[164:167], a[32:35], v[240:243]
    ds_read_b128 a[160:163], v10 offset:31744
    ds_read_b128 a[148:151], v10 offset:28672
    v_mfma_f32_16x16x32_bf16 v[244:247], a[152:155], a[28:31], v[244:247]
    ds_read_b128 a[164:167], v10 offset:32768
    ds_read_b128 a[152:155], v10 offset:29696
    v_mfma_f32_16x16x32_bf16 v[244:247], a[168:171], a[32:35], v[244:247]
    ds_read_b128 a[168:171], v10 offset:33792
    v_add_u32 v13, s74, v13
    v_mfma_f32_16x16x32_bf16 v[248:251], a[172:175], a[28:31], v[248:251]
    v_and_b32 v13, 3, v13
    v_lshlrev_b32 v13, 2, v13
    v_mfma_f32_16x16x32_bf16 v[252:255], a[172:175], a[32:35], v[252:255]
    ds_read_b128 a[172:175], v10 offset:34816
    s_waitcnt lgkmcnt(14)
    v_mfma_f32_16x16x32_bf16 v[184:187], a[176:179], a[36:39], v[184:187]
    buffer_load_dwordx4 a[124:127], v27, s[16:19], s97 offen
    v_mfma_f32_16x16x32_bf16 v[184:187], a[192:195], a[40:43], v[184:187]
    buffer_load_dwordx4 a[128:131], v27, s[16:19], s98 offen
    v_mfma_f32_16x16x32_bf16 v[188:191], a[180:183], a[36:39], v[188:191]
    v_cmp_gt_u32 s[52:53], 32, v2
    s_lshl_b32 s33, s72, 2
    v_mfma_f32_16x16x32_bf16 v[188:191], a[196:199], a[40:43], v[188:191]
    s_add_u32 s33, s33, s74
    s_waitcnt lgkmcnt(9)
    v_mfma_f32_16x16x32_bf16 v[192:195], a[184:187], a[36:39], v[192:195]
    s_mul_i32 s33, s33, 18432
    s_mul_i32 s32, s73, 144
    v_mfma_f32_16x16x32_bf16 v[192:195], a[200:203], a[40:43], v[192:195]
    s_add_u32 s33, s33, s32
    s_mov_b32 s34, 0xffff0000
    v_mfma_f32_16x16x32_bf16 v[196:199], a[188:191], a[36:39], v[196:199]
    s_and_b32 s36, s36, -128
    s_and_b32 s35, s35, -32768
    v_mfma_f32_16x16x32_bf16 v[196:199], a[204:207], a[40:43], v[196:199]
    s_add_u32 s39, s74, 0
    s_and_b32 s39, s39, 3
    v_mfma_f32_16x16x32_bf16 v[200:203], a[208:211], a[36:39], v[200:203]
    s_lshl_b32 s39, s39, 13
    s_add_u32 s40, s39, s35
    v_mfma_f32_16x16x32_bf16 v[204:207], a[208:211], a[40:43], v[204:207]
    s_add_u32 s39, s74, 1
    s_and_b32 s39, s39, 3
    v_mfma_f32_16x16x32_bf16 v[208:211], a[176:179], a[44:47], v[208:211]
    buffer_load_dwordx4 a[132:135], v3, s[16:19], s97 offen
    v_mfma_f32_16x16x32_bf16 v[208:211], a[192:195], a[48:51], v[208:211]
    s_add_u32 s97, s97, 8192
    s_lshl_b32 s39, s39, 13
    v_mfma_f32_16x16x32_bf16 v[212:215], a[180:183], a[44:47], v[212:215]
    buffer_load_dwordx4 a[136:139], v3, s[16:19], s98 offen
    v_mfma_f32_16x16x32_bf16 v[212:215], a[196:199], a[48:51], v[212:215]
    s_add_u32 s98, s98, 8192
    s_add_u32 s41, s39, s35
    v_mfma_f32_16x16x32_bf16 v[216:219], a[184:187], a[44:47], v[216:219]
    s_add_u32 s39, s74, 2
    s_and_b32 s39, s39, 3
    v_mfma_f32_16x16x32_bf16 v[216:219], a[200:203], a[48:51], v[216:219]
    s_lshl_b32 s39, s39, 13
    s_add_u32 s42, s39, s35
    v_mfma_f32_16x16x32_bf16 v[220:223], a[188:191], a[44:47], v[220:223]
    s_add_u32 s42, s42, 2560
    s_add_u32 s39, s74, 3
    v_mfma_f32_16x16x32_bf16 v[220:223], a[204:207], a[48:51], v[220:223]
    s_and_b32 s39, s39, 3
    s_lshl_b32 s39, s39, 13
    v_mfma_f32_16x16x32_bf16 v[224:227], a[208:211], a[44:47], v[224:227]
    s_add_u32 s43, s39, s35
    s_add_u32 s43, s43, 5120
    v_mfma_f32_16x16x32_bf16 v[228:231], a[208:211], a[48:51], v[228:231]
    s_add_u32 s44, s40, 2560
    s_add_u32 s45, s40, 5120
    v_mfma_f32_16x16x32_bf16 v[232:235], a[176:179], a[52:55], v[232:235]
    buffer_load_dwordx4 a[212:215], v24, s[16:19], s97 offen
    v_mfma_f32_16x16x32_bf16 v[232:235], a[192:195], a[56:59], v[232:235]
    buffer_load_dwordx4 a[216:219], v24, s[16:19], s98 offen
    v_mfma_f32_16x16x32_bf16 v[236:239], a[180:183], a[52:55], v[236:239]
    ds_read_b128 a[176:179], v10 offset:35840
    ds_read_b128 a[192:195], v10 offset:39936
    v_mfma_f32_16x16x32_bf16 v[236:239], a[196:199], a[56:59], v[236:239]
    ds_read_b128 a[180:183], v10 offset:36864
    ds_read_b128 a[196:199], v10 offset:40960
    v_mfma_f32_16x16x32_bf16 v[240:243], a[184:187], a[52:55], v[240:243]
    ds_read_b128 a[184:187], v10 offset:37888
    v_mfma_f32_16x16x32_bf16 v[240:243], a[200:203], a[56:59], v[240:243]
    ds_read_b128 a[200:203], v10 offset:41984
    v_mfma_f32_16x16x32_bf16 v[244:247], a[188:191], a[52:55], v[244:247]
    ds_read_b128 a[188:191], v10 offset:38912
    v_mfma_f32_16x16x32_bf16 v[244:247], a[204:207], a[56:59], v[244:247]
    ds_read_b128 a[204:207], v10 offset:43008
    v_mfma_f32_16x16x32_bf16 v[248:251], a[208:211], a[52:55], v[248:251]
    buffer_load_dword v136, v13, s[64:67], s36 offen sc1
    v_mfma_f32_16x16x32_bf16 v[252:255], a[208:211], a[56:59], v[252:255]
    ds_read_b128 a[208:211], v10 offset:44032
    s_waitcnt lgkmcnt(14)
    v_mfma_f32_16x16x32_bf16 v[184:187], a[140:143], a[60:63], v[184:187]
    buffer_load_dwordx4 a[220:223], v27, s[16:19], s97 offen
    v_mfma_f32_16x16x32_bf16 v[184:187], a[156:159], a[64:67], v[184:187]
    buffer_load_dwordx4 a[224:227], v27, s[16:19], s98 offen
    v_mfma_f32_16x16x32_bf16 v[188:191], a[144:147], a[60:63], v[188:191]
    v_mfma_f32_16x16x32_bf16 v[188:191], a[160:163], a[64:67], v[188:191]
    s_waitcnt lgkmcnt(9)
    v_mfma_f32_16x16x32_bf16 v[192:195], a[148:151], a[60:63], v[192:195]
    v_mfma_f32_16x16x32_bf16 v[192:195], a[164:167], a[64:67], v[192:195]
    v_mfma_f32_16x16x32_bf16 v[196:199], a[152:155], a[60:63], v[196:199]
    v_mfma_f32_16x16x32_bf16 v[196:199], a[168:171], a[64:67], v[196:199]
    v_mfma_f32_16x16x32_bf16 v[200:203], a[172:175], a[60:63], v[200:203]
    v_mfma_f32_16x16x32_bf16 v[204:207], a[172:175], a[64:67], v[204:207]
    s_waitcnt vmcnt(21)
    v_mfma_f32_16x16x32_bf16 v[208:211], a[140:143], a[68:71], v[208:211]
    buffer_load_dwordx4 a[228:231], v3, s[16:19], s97 offen
    v_mfma_f32_16x16x32_bf16 v[208:211], a[156:159], a[72:75], v[208:211]
    s_add_u32 s97, s97, 8192
    v_mfma_f32_16x16x32_bf16 v[212:215], a[144:147], a[68:71], v[212:215]
    buffer_load_dwordx4 a[232:235], v3, s[16:19], s98 offen
    v_mfma_f32_16x16x32_bf16 v[212:215], a[160:163], a[72:75], v[212:215]
    s_add_u32 s98, s98, 8192
    v_mfma_f32_16x16x32_bf16 v[216:219], a[148:151], a[68:71], v[216:219]
    v_mfma_f32_16x16x32_bf16 v[216:219], a[164:167], a[72:75], v[216:219]
    v_mfma_f32_16x16x32_bf16 v[220:223], a[152:155], a[68:71], v[220:223]
    v_mfma_f32_16x16x32_bf16 v[220:223], a[168:171], a[72:75], v[220:223]
    v_mfma_f32_16x16x32_bf16 v[224:227], a[172:175], a[68:71], v[224:227]
    v_mfma_f32_16x16x32_bf16 v[228:231], a[172:175], a[72:75], v[228:231]
    v_mfma_f32_16x16x32_bf16 v[232:235], a[140:143], a[76:79], v[232:235]
    buffer_load_dwordx4 a[236:239], v24, s[16:19], s97 offen
    v_mfma_f32_16x16x32_bf16 v[232:235], a[156:159], a[80:83], v[232:235]
    buffer_load_dwordx4 a[240:243], v24, s[16:19], s98 offen
    v_mfma_f32_16x16x32_bf16 v[236:239], a[144:147], a[76:79], v[236:239]
    ds_read_b128 a[140:143], v10 offset:45056
    ds_read_b128 a[156:159], v10 offset:49152
    v_mfma_f32_16x16x32_bf16 v[236:239], a[160:163], a[80:83], v[236:239]
    ds_read_b128 a[144:147], v10 offset:46080
    ds_read_b128 a[160:163], v10 offset:50176
    v_mfma_f32_16x16x32_bf16 v[240:243], a[148:151], a[76:79], v[240:243]
    ds_read_b128 a[148:151], v10 offset:47104
    v_mfma_f32_16x16x32_bf16 v[240:243], a[164:167], a[80:83], v[240:243]
    ds_read_b128 a[164:167], v10 offset:51200
    v_mfma_f32_16x16x32_bf16 v[244:247], a[152:155], a[76:79], v[244:247]
    ds_read_b128 a[152:155], v10 offset:48128
    v_mfma_f32_16x16x32_bf16 v[244:247], a[168:171], a[80:83], v[244:247]
    ds_read_b128 a[168:171], v10 offset:52224
    v_mfma_f32_16x16x32_bf16 v[248:251], a[172:175], a[76:79], v[248:251]
    v_mfma_f32_16x16x32_bf16 v[252:255], a[172:175], a[80:83], v[252:255]
    s_waitcnt vmcnt(22)
    s_waitcnt lgkmcnt(13)
    v_mfma_f32_16x16x32_bf16 v[184:187], a[176:179], a[84:87], v[184:187]
    buffer_load_dwordx4 a[244:247], v27, s[16:19], s97 offen
    v_mfma_f32_16x16x32_bf16 v[184:187], a[192:195], a[88:91], v[184:187]
    buffer_load_dwordx4 a[248:251], v27, s[16:19], s98 offen
    v_mfma_f32_16x16x32_bf16 v[188:191], a[180:183], a[84:87], v[188:191]
    ds_read_b128 a[172:175], v10 offset:53248
    v_mfma_f32_16x16x32_bf16 v[188:191], a[196:199], a[88:91], v[188:191]
    s_waitcnt lgkmcnt(9)
    v_mfma_f32_16x16x32_bf16 v[192:195], a[184:187], a[84:87], v[192:195]
    v_mfma_f32_16x16x32_bf16 v[192:195], a[200:203], a[88:91], v[192:195]
    v_mfma_f32_16x16x32_bf16 v[196:199], a[188:191], a[84:87], v[196:199]
    v_mfma_f32_16x16x32_bf16 v[196:199], a[204:207], a[88:91], v[196:199]
    v_mfma_f32_16x16x32_bf16 v[200:203], a[208:211], a[84:87], v[200:203]
    v_mfma_f32_16x16x32_bf16 v[204:207], a[208:211], a[88:91], v[204:207]
    s_waitcnt vmcnt(17)
    v_mfma_f32_16x16x32_bf16 v[208:211], a[176:179], a[92:95], v[208:211]
    buffer_load_dwordx4 a[252:255], v3, s[16:19], s97 offen
    v_mfma_f32_16x16x32_bf16 v[208:211], a[192:195], a[96:99], v[208:211]
    s_add_u32 s97, s97, 8192
    v_mfma_f32_16x16x32_bf16 v[212:215], a[180:183], a[92:95], v[212:215]
    buffer_load_dwordx4 a[0:3], v3, s[16:19], s98 offen
    v_mfma_f32_16x16x32_bf16 v[212:215], a[196:199], a[96:99], v[212:215]
    s_add_u32 s98, s98, 8192
    v_mfma_f32_16x16x32_bf16 v[216:219], a[184:187], a[92:95], v[216:219]
    v_mfma_f32_16x16x32_bf16 v[216:219], a[200:203], a[96:99], v[216:219]
    v_mfma_f32_16x16x32_bf16 v[220:223], a[188:191], a[92:95], v[220:223]
    v_mfma_f32_16x16x32_bf16 v[220:223], a[204:207], a[96:99], v[220:223]
    v_mfma_f32_16x16x32_bf16 v[224:227], a[208:211], a[92:95], v[224:227]
    v_mfma_f32_16x16x32_bf16 v[228:231], a[208:211], a[96:99], v[228:231]
    v_mfma_f32_16x16x32_bf16 v[232:235], a[176:179], a[100:103], v[232:235]
    buffer_load_dwordx4 a[4:7], v24, s[16:19], s97 offen
    v_mfma_f32_16x16x32_bf16 v[232:235], a[192:195], a[104:107], v[232:235]
    buffer_load_dwordx4 a[8:11], v24, s[16:19], s98 offen
    v_mfma_f32_16x16x32_bf16 v[236:239], a[180:183], a[100:103], v[236:239]
    ds_read_b128 a[176:179], v10 offset:54272
    ds_read_b128 a[192:195], v10 offset:58368
    v_mfma_f32_16x16x32_bf16 v[236:239], a[196:199], a[104:107], v[236:239]
    ds_read_b128 a[180:183], v10 offset:55296
    ds_read_b128 a[196:199], v10 offset:59392
    v_mfma_f32_16x16x32_bf16 v[240:243], a[184:187], a[100:103], v[240:243]
    ds_read_b128 a[184:187], v10 offset:56320
    v_mfma_f32_16x16x32_bf16 v[240:243], a[200:203], a[104:107], v[240:243]
    ds_read_b128 a[200:203], v10 offset:60416
    v_mfma_f32_16x16x32_bf16 v[244:247], a[188:191], a[100:103], v[244:247]
    ds_read_b128 a[188:191], v10 offset:57344
    v_mfma_f32_16x16x32_bf16 v[244:247], a[204:207], a[104:107], v[244:247]
    ds_read_b128 a[204:207], v10 offset:61440
    v_mfma_f32_16x16x32_bf16 v[248:251], a[208:211], a[100:103], v[248:251]
    s_waitcnt vmcnt(12)
    v_mfma_f32_16x16x32_bf16 v[252:255], a[208:211], a[104:107], v[252:255]
    ds_read_b128 a[208:211], v10 offset:62464
    s_waitcnt lgkmcnt(14)
    v_mfma_f32_16x16x32_bf16 v[184:187], a[140:143], a[116:119], v[184:187]
    buffer_load_dwordx4 a[12:15], v27, s[16:19], s97 offen
    v_mfma_f32_16x16x32_bf16 v[184:187], a[156:159], a[120:123], v[184:187]
    buffer_load_dwordx4 a[16:19], v27, s[16:19], s98 offen
    v_mfma_f32_16x16x32_bf16 v[188:191], a[144:147], a[116:119], v[188:191]
    v_cmp_ne_u32 vcc, 1, v136
    s_nop 3
    s_cbranch_vccnz XC_SLOW
XC_OK:
    v_mfma_f32_16x16x32_bf16 v[188:191], a[160:163], a[120:123], v[188:191]
    s_waitcnt lgkmcnt(9)
    v_mfma_f32_16x16x32_bf16 v[192:195], a[148:151], a[116:119], v[192:195]
    v_mfma_f32_16x16x32_bf16 v[192:195], a[164:167], a[120:123], v[192:195]
    v_mfma_f32_16x16x32_bf16 v[196:199], a[152:155], a[116:119], v[196:199]
    v_mfma_f32_16x16x32_bf16 v[196:199], a[168:171], a[120:123], v[196:199]
    v_mfma_f32_16x16x32_bf16 v[200:203], a[172:175], a[116:119], v[200:203]
    v_mfma_f32_16x16x32_bf16 v[204:207], a[172:175], a[120:123], v[204:207]
    v_mfma_f32_16x16x32_bf16 v[208:211], a[140:143], a[124:127], v[208:211]
    buffer_load_dwordx4 a[20:23], v3, s[16:19], s97 offen
    v_mfma_f32_16x16x32_bf16 v[208:211], a[156:159], a[128:131], v[208:211]
    s_add_u32 s97, s97, 8192
    v_mfma_f32_16x16x32_bf16 v[212:215], a[144:147], a[124:127], v[212:215]
    buffer_load_dwordx4 a[24:27], v3, s[16:19], s98 offen
    v_mfma_f32_16x16x32_bf16 v[212:215], a[160:163], a[128:131], v[212:215]
    s_add_u32 s98, s98, 8192
    v_mfma_f32_16x16x32_bf16 v[216:219], a[148:151], a[124:127], v[216:219]
    v_mfma_f32_16x16x32_bf16 v[216:219], a[164:167], a[128:131], v[216:219]
    v_mfma_f32_16x16x32_bf16 v[220:223], a[152:155], a[124:127], v[220:223]
    v_mfma_f32_16x16x32_bf16 v[220:223], a[168:171], a[128:131], v[220:223]
    v_mfma_f32_16x16x32_bf16 v[224:227], a[172:175], a[124:127], v[224:227]
    v_mfma_f32_16x16x32_bf16 v[228:231], a[172:175], a[128:131], v[228:231]
    v_mfma_f32_16x16x32_bf16 v[232:235], a[140:143], a[132:135], v[232:235]
    buffer_load_dwordx4 a[28:31], v24, s[16:19], s97 offen
    v_mfma_f32_16x16x32_bf16 v[232:235], a[156:159], a[136:139], v[232:235]
    buffer_load_dwordx4 a[32:35], v24, s[16:19], s98 offen
    v_mfma_f32_16x16x32_bf16 v[236:239], a[144:147], a[132:135], v[236:239]
    ds_read_b128 a[140:143], v10 offset:63488
    ds_read_b128 a[156:159], v11 offset:2048
    v_mfma_f32_16x16x32_bf16 v[236:239], a[160:163], a[136:139], v[236:239]
    ds_read_b128 a[144:147], v10 offset:64512
    ds_read_b128 a[160:163], v11 offset:3072
    v_mfma_f32_16x16x32_bf16 v[240:243], a[148:151], a[132:135], v[240:243]
    ds_read_b128 a[148:151], v11 offset:0
    v_mfma_f32_16x16x32_bf16 v[240:243], a[164:167], a[136:139], v[240:243]
    ds_read_b128 a[164:167], v11 offset:4096
    v_mfma_f32_16x16x32_bf16 v[244:247], a[152:155], a[132:135], v[244:247]
    ds_read_b128 a[152:155], v11 offset:1024
    v_mfma_f32_16x16x32_bf16 v[244:247], a[168:171], a[136:139], v[244:247]
    ds_read_b128 a[168:171], v11 offset:5120
    v_mfma_f32_16x16x32_bf16 v[248:251], a[172:175], a[132:135], v[248:251]
    v_mfma_f32_16x16x32_bf16 v[252:255], a[172:175], a[136:139], v[252:255]
    ds_read_b128 a[172:175], v11 offset:6144
    s_waitcnt lgkmcnt(14)
    v_mfma_f32_16x16x32_bf16 v[184:187], a[176:179], a[212:215], v[184:187]
    buffer_load_dwordx4 a[36:39], v27, s[16:19], s97 offen
    v_mfma_f32_16x16x32_bf16 v[184:187], a[192:195], a[216:219], v[184:187]
    buffer_load_dwordx4 a[40:43], v27, s[16:19], s98 offen
    v_mfma_f32_16x16x32_bf16 v[188:191], a[180:183], a[212:215], v[188:191]
    v_mfma_f32_16x16x32_bf16 v[188:191], a[196:199], a[216:219], v[188:191]
    s_waitcnt lgkmcnt(9)
    v_mfma_f32_16x16x32_bf16 v[192:195], a[184:187], a[212:215], v[192:195]
    v_mfma_f32_16x16x32_bf16 v[192:195], a[200:203], a[216:219], v[192:195]
    v_mfma_f32_16x16x32_bf16 v[196:199], a[188:191], a[212:215], v[196:199]
    v_mfma_f32_16x16x32_bf16 v[196:199], a[204:207], a[216:219], v[196:199]
    v_mfma_f32_16x16x32_bf16 v[200:203], a[208:211], a[212:215], v[200:203]
    v_mfma_f32_16x16x32_bf16 v[204:207], a[208:211], a[216:219], v[204:207]
    s_waitcnt vmcnt(16)
    v_mfma_f32_16x16x32_bf16 v[208:211], a[176:179], a[220:223], v[208:211]
    buffer_load_dwordx4 a[44:47], v3, s[16:19], s97 offen
    v_mfma_f32_16x16x32_bf16 v[208:211], a[192:195], a[224:227], v[208:211]
    s_add_u32 s97, s97, 8192
    v_mfma_f32_16x16x32_bf16 v[212:215], a[180:183], a[220:223], v[212:215]
    buffer_load_dwordx4 a[48:51], v3, s[16:19], s98 offen
    v_mfma_f32_16x16x32_bf16 v[212:215], a[196:199], a[224:227], v[212:215]
    s_add_u32 s98, s98, 8192
    v_mfma_f32_16x16x32_bf16 v[216:219], a[184:187], a[220:223], v[216:219]
    v_mfma_f32_16x16x32_bf16 v[216:219], a[200:203], a[224:227], v[216:219]
    v_mfma_f32_16x16x32_bf16 v[220:223], a[188:191], a[220:223], v[220:223]
    v_mfma_f32_16x16x32_bf16 v[220:223], a[204:207], a[224:227], v[220:223]
    v_mfma_f32_16x16x32_bf16 v[224:227], a[208:211], a[220:223], v[224:227]
    v_mfma_f32_16x16x32_bf16 v[228:231], a[208:211], a[224:227], v[228:231]
    v_mfma_f32_16x16x32_bf16 v[232:235], a[176:179], a[228:231], v[232:235]
    buffer_load_dwordx4 a[52:55], v24, s[16:19], s97 offen
    v_mfma_f32_16x16x32_bf16 v[232:235], a[192:195], a[232:235], v[232:235]
    buffer_load_dwordx4 a[56:59], v24, s[16:19], s98 offen
    v_mfma_f32_16x16x32_bf16 v[236:239], a[180:183], a[228:231], v[236:239]
    ds_read_b128 a[176:179], v11 offset:7168
    ds_read_b128 a[192:195], v11 offset:11264
    v_mfma_f32_16x16x32_bf16 v[236:239], a[196:199], a[232:235], v[236:239]
    ds_read_b128 a[180:183], v11 offset:8192
    ds_read_b128 a[196:199], v11 offset:12288
    v_mfma_f32_16x16x32_bf16 v[240:243], a[184:187], a[228:231], v[240:243]
    ds_read_b128 a[184:187], v11 offset:9216
    v_mfma_f32_16x16x32_bf16 v[240:243], a[200:203], a[232:235], v[240:243]
    ds_read_b128 a[200:203], v11 offset:13312
    v_mfma_f32_16x16x32_bf16 v[244:247], a[188:191], a[228:231], v[244:247]
    ds_read_b128 a[188:191], v11 offset:10240
    v_mfma_f32_16x16x32_bf16 v[244:247], a[204:207], a[232:235], v[244:247]
    ds_read_b128 a[204:207], v11 offset:14336
    v_mfma_f32_16x16x32_bf16 v[248:251], a[208:211], a[228:231], v[248:251]
    v_mfma_f32_16x16x32_bf16 v[252:255], a[208:211], a[232:235], v[252:255]
    s_waitcnt vmcnt(18)
    s_waitcnt lgkmcnt(13)
    v_mfma_f32_16x16x32_bf16 v[184:187], a[140:143], a[236:239], v[184:187]
    buffer_load_dwordx4 a[60:63], v27, s[16:19], s97 offen
    v_mfma_f32_16x16x32_bf16 v[184:187], a[156:159], a[240:243], v[184:187]
    buffer_load_dwordx4 a[64:67], v27, s[16:19], s98 offen
    v_mfma_f32_16x16x32_bf16 v[188:191], a[144:147], a[236:239], v[188:191]
    ds_read_b128 a[208:211], v11 offset:15360
    v_mfma_f32_16x16x32_bf16 v[188:191], a[160:163], a[240:243], v[188:191]
    s_waitcnt lgkmcnt(9)
    v_mfma_f32_16x16x32_bf16 v[192:195], a[148:151], a[236:239], v[192:195]
    v_mfma_f32_16x16x32_bf16 v[192:195], a[164:167], a[240:243], v[192:195]
    v_mfma_f32_16x16x32_bf16 v[196:199], a[152:155], a[236:239], v[196:199]
    v_mfma_f32_16x16x32_bf16 v[196:199], a[168:171], a[240:243], v[196:199]
    v_mfma_f32_16x16x32_bf16 v[200:203], a[172:175], a[236:239], v[200:203]
    v_mfma_f32_16x16x32_bf16 v[204:207], a[172:175], a[240:243], v[204:207]
    s_waitcnt vmcnt(16)
    v_mfma_f32_16x16x32_bf16 v[208:211], a[140:143], a[244:247], v[208:211]
    buffer_load_dwordx4 a[68:71], v3, s[16:19], s97 offen
    v_mfma_f32_16x16x32_bf16 v[208:211], a[156:159], a[248:251], v[208:211]
    s_add_u32 s97, s97, 155648
    v_mfma_f32_16x16x32_bf16 v[212:215], a[144:147], a[244:247], v[212:215]
    buffer_load_dwordx4 a[72:75], v3, s[16:19], s98 offen
    v_mfma_f32_16x16x32_bf16 v[212:215], a[160:163], a[248:251], v[212:215]
    s_add_u32 s98, s98, 155648
    v_mfma_f32_16x16x32_bf16 v[216:219], a[148:151], a[244:247], v[216:219]
    v_mfma_f32_16x16x32_bf16 v[216:219], a[164:167], a[248:251], v[216:219]
    v_mfma_f32_16x16x32_bf16 v[220:223], a[152:155], a[244:247], v[220:223]
    v_mfma_f32_16x16x32_bf16 v[220:223], a[168:171], a[248:251], v[220:223]
    v_mfma_f32_16x16x32_bf16 v[224:227], a[172:175], a[244:247], v[224:227]
    v_mfma_f32_16x16x32_bf16 v[228:231], a[172:175], a[248:251], v[228:231]
    v_mfma_f32_16x16x32_bf16 v[232:235], a[140:143], a[252:255], v[232:235]
    ds_read_b128 a[140:143], v9 offset:0
    v_mfma_f32_16x16x32_bf16 v[232:235], a[156:159], a[0:3], v[232:235]
    ds_read_b128 a[156:159], v9 offset:4096
    v_mfma_f32_16x16x32_bf16 v[236:239], a[144:147], a[252:255], v[236:239]
    ds_read_b128 a[144:147], v9 offset:1024
    v_mfma_f32_16x16x32_bf16 v[236:239], a[160:163], a[0:3], v[236:239]
    ds_read_b128 a[160:163], v9 offset:5120
    v_mfma_f32_16x16x32_bf16 v[240:243], a[148:151], a[252:255], v[240:243]
    ds_read_b128 a[148:151], v9 offset:2048
    v_mfma_f32_16x16x32_bf16 v[240:243], a[164:167], a[0:3], v[240:243]
    ds_read_b128 a[164:167], v9 offset:6144
    v_mfma_f32_16x16x32_bf16 v[244:247], a[152:155], a[252:255], v[244:247]
    ds_read_b128 a[152:155], v9 offset:3072
    v_mfma_f32_16x16x32_bf16 v[244:247], a[168:171], a[0:3], v[244:247]
    ds_read_b128 a[168:171], v9 offset:7168
    v_mfma_f32_16x16x32_bf16 v[248:251], a[172:175], a[252:255], v[248:251]
    v_mfma_f32_16x16x32_bf16 v[252:255], a[172:175], a[0:3], v[252:255]
    s_waitcnt vmcnt(16)
    s_waitcnt lgkmcnt(13)
    v_mfma_f32_16x16x32_bf16 v[184:187], a[176:179], a[4:7], v[184:187]
    buffer_load_dwordx4 a[76:79], v1, s[16:19], s100 offen
    v_mfma_f32_16x16x32_bf16 v[184:187], a[192:195], a[8:11], v[184:187]
    s_add_u32 s100, s100, 8192
    ds_read_b128 a[172:175], v9 offset:8192
    v_mfma_f32_16x16x32_bf16 v[188:191], a[180:183], a[4:7], v[188:191]
    buffer_load_dwordx4 a[80:83], v1, s[16:19], s101 offen
    v_mfma_f32_16x16x32_bf16 v[188:191], a[196:199], a[8:11], v[188:191]
    s_add_u32 s101, s101, 8192
    s_waitcnt lgkmcnt(9)
    v_mfma_f32_16x16x32_bf16 v[192:195], a[184:187], a[4:7], v[192:195]
    v_mfma_f32_16x16x32_bf16 v[192:195], a[200:203], a[8:11], v[192:195]
    v_mfma_f32_16x16x32_bf16 v[196:199], a[188:191], a[4:7], v[196:199]
    v_mfma_f32_16x16x32_bf16 v[196:199], a[204:207], a[8:11], v[196:199]
    v_mfma_f32_16x16x32_bf16 v[200:203], a[208:211], a[4:7], v[200:203]
    v_mfma_f32_16x16x32_bf16 v[204:207], a[208:211], a[8:11], v[204:207]
    s_waitcnt vmcnt(14)
    v_mfma_f32_16x16x32_bf16 v[208:211], a[176:179], a[12:15], v[208:211]
    buffer_load_dwordx4 a[84:87], v1, s[16:19], s100 offen
    v_mfma_f32_16x16x32_bf16 v[208:211], a[192:195], a[16:19], v[208:211]
    s_add_u32 s100, s100, 8192
    v_mfma_f32_16x16x32_bf16 v[212:215], a[180:183], a[12:15], v[212:215]
    buffer_load_dwordx4 a[88:91], v1, s[16:19], s101 offen
    v_mfma_f32_16x16x32_bf16 v[212:215], a[196:199], a[16:19], v[212:215]
    s_add_u32 s101, s101, 8192
    v_mfma_f32_16x16x32_bf16 v[216:219], a[184:187], a[12:15], v[216:219]
    v_mfma_f32_16x16x32_bf16 v[216:219], a[200:203], a[16:19], v[216:219]
    v_mfma_f32_16x16x32_bf16 v[220:223], a[188:191], a[12:15], v[220:223]
    v_mfma_f32_16x16x32_bf16 v[220:223], a[204:207], a[16:19], v[220:223]
    v_mfma_f32_16x16x32_bf16 v[224:227], a[208:211], a[12:15], v[224:227]
    v_mfma_f32_16x16x32_bf16 v[228:231], a[208:211], a[16:19], v[228:231]
    v_mfma_f32_16x16x32_bf16 v[232:235], a[176:179], a[20:23], v[232:235]
    buffer_load_dwordx4 a[92:95], v1, s[16:19], s100 offen
    v_mfma_f32_16x16x32_bf16 v[232:235], a[192:195], a[24:27], v[232:235]
    s_add_u32 s100, s100, 8192
    ds_read_b128 a[176:179], v9 offset:9216
    v_mfma_f32_16x16x32_bf16 v[236:239], a[180:183], a[20:23], v[236:239]
    buffer_load_dwordx4 a[96:99], v1, s[16:19], s101 offen
    v_mfma_f32_16x16x32_bf16 v[236:239], a[196:199], a[24:27], v[236:239]
    s_add_u32 s101, s101, 8192
    ds_read_b128 a[192:195], v9 offset:13312
    v_mfma_f32_16x16x32_bf16 v[240:243], a[184:187], a[20:23], v[240:243]
    ds_read_b128 a[180:183], v9 offset:10240
    ds_read_b128 a[196:199], v9 offset:14336
    v_mfma_f32_16x16x32_bf16 v[240:243], a[200:203], a[24:27], v[240:243]
    ds_read_b128 a[184:187], v9 offset:11264
    ds_read_b128 a[200:203], v9 offset:15360
    v_mfma_f32_16x16x32_bf16 v[244:247], a[188:191], a[20:23], v[244:247]
    ds_read_b128 a[188:191], v9 offset:12288
    v_mfma_f32_16x16x32_bf16 v[244:247], a[204:207], a[24:27], v[244:247]
    ds_read_b128 a[204:207], v9 offset:16384
    v_mfma_f32_16x16x32_bf16 v[248:251], a[208:211], a[20:23], v[248:251]
    v_mfma_f32_16x16x32_bf16 v[252:255], a[208:211], a[24:27], v[252:255]
    s_waitcnt vmcnt(16)
    s_waitcnt lgkmcnt(13)
    v_mfma_f32_16x16x32_bf16 v[184:187], a[140:143], a[28:31], v[184:187]
    buffer_load_dwordx4 a[100:103], v1, s[16:19], s100 offen
    v_mfma_f32_16x16x32_bf16 v[184:187], a[156:159], a[32:35], v[184:187]
    s_add_u32 s100, s100, 8192
    ds_read_b128 a[208:211], v9 offset:17408
    v_mfma_f32_16x16x32_bf16 v[188:191], a[144:147], a[28:31], v[188:191]
    buffer_load_dwordx4 a[104:107], v1, s[16:19], s101 offen
    v_mfma_f32_16x16x32_bf16 v[188:191], a[160:163], a[32:35], v[188:191]
    s_add_u32 s101, s101, 8192
    s_waitcnt lgkmcnt(9)
    v_mfma_f32_16x16x32_bf16 v[192:195], a[148:151], a[28:31], v[192:195]
    v_mfma_f32_16x16x32_bf16 v[192:195], a[164:167], a[32:35], v[192:195]
    v_mfma_f32_16x16x32_bf16 v[196:199], a[152:155], a[28:31], v[196:199]
    v_mfma_f32_16x16x32_bf16 v[196:199], a[168:171], a[32:35], v[196:199]
    v_mfma_f32_16x16x32_bf16 v[200:203], a[172:175], a[28:31], v[200:203]
    v_mfma_f32_16x16x32_bf16 v[204:207], a[172:175], a[32:35], v[204:207]
    s_waitcnt vmcnt(14)
    v_mfma_f32_16x16x32_bf16 v[208:211], a[140:143], a[36:39], v[208:211]
    buffer_load_dwordx4 a[116:119], v1, s[16:19], s100 offen
    v_mfma_f32_16x16x32_bf16 v[208:211], a[156:159], a[40:43], v[208:211]
    s_add_u32 s100, s100, 8192
    v_mfma_f32_16x16x32_bf16 v[212:215], a[144:147], a[36:39], v[212:215]
    buffer_load_dwordx4 a[120:123], v1, s[16:19], s101 offen
    v_mfma_f32_16x16x32_bf16 v[212:215], a[160:163], a[40:43], v[212:215]
    s_add_u32 s101, s101, 8192
    v_mfma_f32_16x16x32_bf16 v[216:219], a[148:151], a[36:39], v[216:219]
    v_mfma_f32_16x16x32_bf16 v[216:219], a[164:167], a[40:43], v[216:219]
    v_mfma_f32_16x16x32_bf16 v[220:223], a[152:155], a[36:39], v[220:223]
    v_mfma_f32_16x16x32_bf16 v[220:223], a[168:171], a[40:43], v[220:223]
    v_mfma_f32_16x16x32_bf16 v[224:227], a[172:175], a[36:39], v[224:227]
    v_mfma_f32_16x16x32_bf16 v[228:231], a[172:175], a[40:43], v[228:231]
    v_mfma_f32_16x16x32_bf16 v[232:235], a[140:143], a[44:47], v[232:235]
    buffer_load_dwordx4 a[124:127], v1, s[16:19], s100 offen
    v_mfma_f32_16x16x32_bf16 v[232:235], a[156:159], a[48:51], v[232:235]
    s_add_u32 s100, s100, 155648
    ds_read_b128 a[140:143], v9 offset:46080
    v_mfma_f32_16x16x32_bf16 v[236:239], a[144:147], a[44:47], v[236:239]
    buffer_load_dwordx4 a[128:131], v1, s[16:19], s101 offen
    v_mfma_f32_16x16x32_bf16 v[236:239], a[160:163], a[48:51], v[236:239]
    s_add_u32 s101, s101, 155648
    ds_read_b128 a[156:159], v9 offset:50176
    v_mfma_f32_16x16x32_bf16 v[240:243], a[148:151], a[44:47], v[240:243]
    ds_read_b128 a[144:147], v9 offset:47104
    ds_read_b128 a[160:163], v9 offset:51200
    v_mfma_f32_16x16x32_bf16 v[240:243], a[164:167], a[48:51], v[240:243]
    ds_read_b128 a[148:151], v9 offset:48128
    ds_read_b128 a[164:167], v9 offset:52224
    v_mfma_f32_16x16x32_bf16 v[244:247], a[152:155], a[44:47], v[244:247]
    ds_read_b128 a[152:155], v9 offset:49152
    v_mfma_f32_16x16x32_bf16 v[244:247], a[168:171], a[48:51], v[244:247]
    ds_read_b128 a[168:171], v9 offset:53248
    v_mfma_f32_16x16x32_bf16 v[248:251], a[172:175], a[44:47], v[248:251]
    v_mfma_f32_16x16x32_bf16 v[252:255], a[172:175], a[48:51], v[252:255]
    s_waitcnt vmcnt(16)
    s_waitcnt lgkmcnt(13)
    v_mfma_f32_16x16x32_bf16 v[184:187], a[176:179], a[52:55], v[184:187]
    buffer_load_dwordx4 a[132:135], v1, s[16:19], s100 offen
    v_mfma_f32_16x16x32_bf16 v[184:187], a[192:195], a[56:59], v[184:187]
    s_add_u32 s100, s100, 8192
    ds_read_b128 a[172:175], v9 offset:54272
    v_mfma_f32_16x16x32_bf16 v[188:191], a[180:183], a[52:55], v[188:191]
    buffer_load_dwordx4 a[136:139], v1, s[16:19], s101 offen
    v_mfma_f32_16x16x32_bf16 v[188:191], a[196:199], a[56:59], v[188:191]
    s_add_u32 s101, s101, 8192
    s_waitcnt lgkmcnt(9)
    v_mfma_f32_16x16x32_bf16 v[192:195], a[184:187], a[52:55], v[192:195]
    v_mfma_f32_16x16x32_bf16 v[192:195], a[200:203], a[56:59], v[192:195]
    v_mfma_f32_16x16x32_bf16 v[196:199], a[188:191], a[52:55], v[196:199]
    v_mfma_f32_16x16x32_bf16 v[196:199], a[204:207], a[56:59], v[196:199]
    v_mfma_f32_16x16x32_bf16 v[200:203], a[208:211], a[52:55], v[200:203]
    v_mfma_f32_16x16x32_bf16 v[204:207], a[208:211], a[56:59], v[204:207]
    s_waitcnt vmcnt(14)
    v_mfma_f32_16x16x32_bf16 v[208:211], a[176:179], a[60:63], v[208:211]
    buffer_load_dwordx4 a[212:215], v1, s[16:19], s100 offen
    v_mfma_f32_16x16x32_bf16 v[208:211], a[192:195], a[64:67], v[208:211]
    s_add_u32 s100, s100, 8192
    v_mfma_f32_16x16x32_bf16 v[212:215], a[180:183], a[60:63], v[212:215]
    buffer_load_dwordx4 a[216:219], v1, s[16:19], s101 offen
    v_mfma_f32_16x16x32_bf16 v[212:215], a[196:199], a[64:67], v[212:215]
    v_cndmask_b32 v200, v204, v200, s[52:53]
    v_cndmask_b32 v201, v205, v201, s[52:53]
    v_mfma_f32_16x16x32_bf16 v[216:219], a[184:187], a[60:63], v[216:219]
    v_cndmask_b32 v202, v206, v202, s[52:53]
    v_cndmask_b32 v203, v207, v203, s[52:53]
    v_mfma_f32_16x16x32_bf16 v[216:219], a[200:203], a[64:67], v[216:219]
    v_cvt_pk_bf16_f32 v64, v184, v185
    v_cvt_pk_bf16_f32 v65, v186, v187
    v_mfma_f32_16x16x32_bf16 v[220:223], a[188:191], a[60:63], v[220:223]
    v_cvt_pk_bf16_f32 v66, v188, v189
    v_cvt_pk_bf16_f32 v67, v190, v191
    v_mfma_f32_16x16x32_bf16 v[220:223], a[204:207], a[64:67], v[220:223]
    buffer_store_dwordx4 v[64:67], v9, s[16:19], s41 offen offset:0 sc1
    v_mfma_f32_16x16x32_bf16 v[224:227], a[208:211], a[60:63], v[224:227]
    v_cvt_pk_bf16_f32 v68, v192, v193
    v_cvt_pk_bf16_f32 v69, v194, v195
    v_mfma_f32_16x16x32_bf16 v[228:231], a[208:211], a[64:67], v[228:231]
    v_cvt_pk_bf16_f32 v70, v196, v197
    v_cvt_pk_bf16_f32 v71, v198, v199
    v_mfma_f32_16x16x32_bf16 v[232:235], a[176:179], a[68:71], v[232:235]
    buffer_store_dwordx4 v[68:71], v9, s[16:19], s41 offen offset:1024 sc1
    v_mfma_f32_16x16x32_bf16 v[232:235], a[192:195], a[72:75], v[232:235]
    v_cvt_pk_bf16_f32 v72, v200, v201
    v_cvt_pk_bf16_f32 v73, v202, v203
    v_mfma_f32_16x16x32_bf16 v[236:239], a[180:183], a[68:71], v[236:239]
    buffer_store_dwordx2 v[72:73], v12, s[16:19], s41 offen offset:2048 sc1
    v_mfma_f32_16x16x32_bf16 v[236:239], a[196:199], a[72:75], v[236:239]
    v_cndmask_b32 v224, v228, v224, s[52:53]
    v_cndmask_b32 v225, v229, v225, s[52:53]
    v_mfma_f32_16x16x32_bf16 v[240:243], a[184:187], a[68:71], v[240:243]
    v_cndmask_b32 v226, v230, v226, s[52:53]
    v_cndmask_b32 v227, v231, v227, s[52:53]
    v_mfma_f32_16x16x32_bf16 v[240:243], a[200:203], a[72:75], v[240:243]
    v_cvt_pk_bf16_f32 v76, v208, v209
    v_cvt_pk_bf16_f32 v77, v210, v211
    v_mfma_f32_16x16x32_bf16 v[244:247], a[188:191], a[68:71], v[244:247]
    v_cvt_pk_bf16_f32 v78, v212, v213
    v_cvt_pk_bf16_f32 v79, v214, v215
    v_mfma_f32_16x16x32_bf16 v[244:247], a[204:207], a[72:75], v[244:247]
    buffer_store_dwordx4 v[76:79], v9, s[16:19], s42 offen offset:0 sc1
    v_mfma_f32_16x16x32_bf16 v[248:251], a[208:211], a[68:71], v[248:251]
    v_cvt_pk_bf16_f32 v80, v216, v217
    v_cvt_pk_bf16_f32 v81, v218, v219
    v_mfma_f32_16x16x32_bf16 v[252:255], a[208:211], a[72:75], v[252:255]
    v_cvt_pk_bf16_f32 v82, v220, v221
    s_waitcnt lgkmcnt(5)
    v_mfma_f32_16x16x32_bf16 v[160:163], a[140:143], a[108:111], v[160:163]
    v_cvt_pk_bf16_f32 v83, v222, v223
    buffer_store_dwordx4 v[80:83], v9, s[16:19], s42 offen offset:1024 sc1
    v_cvt_pk_bf16_f32 v84, v224, v225
    v_cvt_pk_bf16_f32 v85, v226, v227
    s_add_u32 s101, s101, 8192
    v_mfma_f32_16x16x32_bf16 v[160:163], a[156:159], a[112:115], v[160:163]
    buffer_store_dwordx2 v[84:85], v12, s[16:19], s42 offen offset:2048 sc1
    v_cndmask_b32 v248, v252, v248, s[52:53]
    v_cndmask_b32 v249, v253, v249, s[52:53]
    v_cndmask_b32 v250, v254, v250, s[52:53]
    v_cndmask_b32 v251, v255, v251, s[52:53]
    v_mfma_f32_16x16x32_bf16 v[164:167], a[144:147], a[108:111], v[164:167]
    v_cvt_pk_bf16_f32 v88, v232, v233
    v_cvt_pk_bf16_f32 v89, v234, v235
    v_cvt_pk_bf16_f32 v90, v236, v237
    v_cvt_pk_bf16_f32 v91, v238, v239
    buffer_store_dwordx4 v[88:91], v9, s[16:19], s43 offen offset:0 sc1
    v_mfma_f32_16x16x32_bf16 v[164:167], a[160:163], a[112:115], v[164:167]
    v_cvt_pk_bf16_f32 v92, v240, v241
    v_cvt_pk_bf16_f32 v93, v242, v243
    v_cvt_pk_bf16_f32 v94, v244, v245
    v_cvt_pk_bf16_f32 v95, v246, v247
    ds_read_b128 a[176:179], v9 offset:55296
    s_waitcnt lgkmcnt(1)
    v_mfma_f32_16x16x32_bf16 v[168:171], a[148:151], a[108:111], v[168:171]
    buffer_store_dwordx4 v[92:95], v9, s[16:19], s43 offen offset:1024 sc1
    v_cvt_pk_bf16_f32 v96, v248, v249
    v_cvt_pk_bf16_f32 v97, v250, v251
    ds_read_b128 a[192:195], v9 offset:59392
    ds_read_b128 a[180:183], v9 offset:56320
    v_mfma_f32_16x16x32_bf16 v[168:171], a[164:167], a[112:115], v[168:171]
    buffer_store_dwordx2 v[96:97], v12, s[16:19], s43 offen offset:2048 sc1
    ds_read_b128 a[196:199], v9 offset:60416
    ds_read_b128 a[184:187], v9 offset:57344
    ds_read_b128 a[200:203], v9 offset:61440
    ds_read_b128 a[188:191], v9 offset:58368
    v_mfma_f32_16x16x32_bf16 v[172:175], a[152:155], a[108:111], v[172:175]
    buffer_load_dwordx4 a[220:223], v1, s[16:19], s100 offen
    s_add_u32 s100, s100, 8192
    v_mfma_f32_16x16x32_bf16 v[172:175], a[168:171], a[112:115], v[172:175]
    buffer_load_dwordx4 a[224:227], v1, s[16:19], s101 offen
    s_add_u32 s101, s101, 8192
    v_mfma_f32_16x16x32_bf16 v[176:179], a[172:175], a[108:111], v[176:179]
    buffer_load_dwordx4 a[228:231], v1, s[16:19], s100 offen
    s_add_u32 s100, s100, 8192
    v_mfma_f32_16x16x32_bf16 v[180:183], a[172:175], a[112:115], v[180:183]
    ds_read_b128 a[204:207], v9 offset:62464
    s_waitcnt vmcnt(26)
    s_waitcnt lgkmcnt(4)
    v_mfma_f32_16x16x32_bf16 v[160:163], a[176:179], a[76:79], v[160:163]
    buffer_load_dwordx4 a[232:235], v1, s[16:19], s101 offen
    s_add_u32 s101, s101, 8192
    v_mfma_f32_16x16x32_bf16 v[160:163], a[192:195], a[80:83], v[160:163]
    buffer_load_dwordx4 a[236:239], v1, s[16:19], s100 offen
    s_add_u32 s100, s100, 8192
    v_mfma_f32_16x16x32_bf16 v[164:167], a[180:183], a[76:79], v[164:167]
    buffer_load_dwordx4 a[240:243], v1, s[16:19], s101 offen
    s_add_u32 s101, s101, 8192
    v_mfma_f32_16x16x32_bf16 v[164:167], a[196:199], a[80:83], v[164:167]
    ds_read_b128 a[208:211], v9 offset:63488
    ds_read_b128 a[140:143], v9 offset:64512
    s_waitcnt lgkmcnt(1)
    v_mfma_f32_16x16x32_bf16 v[168:171], a[184:187], a[76:79], v[168:171]
    ds_read_b128 a[156:159], v10 offset:3072
    ds_read_b128 a[144:147], v10 offset:0
    ds_read_b128 a[160:163], v10 offset:4096
    v_mfma_f32_16x16x32_bf16 v[168:171], a[200:203], a[80:83], v[168:171]
    ds_read_b128 a[148:151], v10 offset:1024
    ds_read_b128 a[164:167], v10 offset:5120
    ds_read_b128 a[152:155], v10 offset:2048
    v_mfma_f32_16x16x32_bf16 v[172:175], a[188:191], a[76:79], v[172:175]
    ds_read_b128 a[168:171], v10 offset:6144
    ds_read_b128 a[172:175], v10 offset:7168
    ds_read_b128 v[184:187], v10 offset:8192
    v_mfma_f32_16x16x32_bf16 v[172:175], a[204:207], a[80:83], v[172:175]
    ds_read_b128 v[200:203], v10 offset:12288
    ds_read_b128 v[188:191], v10 offset:9216
    ds_read_b128 v[204:207], v10 offset:13312
    v_mfma_f32_16x16x32_bf16 v[176:179], a[208:211], a[76:79], v[176:179]
    ds_read_b128 v[192:195], v10 offset:10240
    ds_read_b128 v[208:211], v10 offset:14336
    ds_read_b128 v[196:199], v10 offset:11264
    v_mfma_f32_16x16x32_bf16 v[180:183], a[208:211], a[80:83], v[180:183]
    ds_read_b128 v[212:215], v10 offset:15360
    s_waitcnt vmcnt(27)
    s_waitcnt lgkmcnt(13)
    v_mfma_f32_16x16x32_bf16 v[160:163], a[140:143], a[84:87], v[160:163]
    buffer_load_dwordx4 a[244:247], v1, s[16:19], s100 offen
    s_add_u32 s100, s100, 155648
    v_mfma_f32_16x16x32_bf16 v[160:163], a[156:159], a[88:91], v[160:163]
    buffer_load_dwordx4 a[248:251], v1, s[16:19], s101 offen
    s_add_u32 s101, s101, 155648
    v_mfma_f32_16x16x32_bf16 v[164:167], a[144:147], a[84:87], v[164:167]
    ds_read_b128 v[216:219], v10 offset:16384
    ds_read_b128 v[220:223], v10 offset:17408
    ds_read_b128 v[236:239], v10 offset:21504
    v_mfma_f32_16x16x32_bf16 v[164:167], a[160:163], a[88:91], v[164:167]
    ds_read_b128 v[224:227], v10 offset:18432
    ds_read_b128 v[240:243], v10 offset:22528
    s_waitcnt lgkmcnt(13)
    v_mfma_f32_16x16x32_bf16 v[168:171], a[148:151], a[84:87], v[168:171]
    ds_read_b128 v[228:231], v10 offset:19456
    ds_read_b128 v[244:247], v10 offset:23552
    ds_read_b128 v[232:235], v10 offset:20480
    v_mfma_f32_16x16x32_bf16 v[168:171], a[164:167], a[88:91], v[168:171]
    ds_read_b128 v[248:251], v10 offset:24576
    ds_read_b128 v[252:255], v10 offset:25600
    ds_read_b128 a[176:179], v10 offset:26624
    v_mfma_f32_16x16x32_bf16 v[172:175], a[152:155], a[84:87], v[172:175]
    ds_read_b128 a[192:195], v10 offset:30720
    ds_read_b128 a[180:183], v10 offset:27648
    ds_read_b128 a[196:199], v10 offset:31744
    v_mfma_f32_16x16x32_bf16 v[172:175], a[168:171], a[88:91], v[172:175]
    ds_read_b128 a[184:187], v10 offset:28672
    ds_read_b128 a[200:203], v10 offset:32768
    ds_read_b128 a[188:191], v10 offset:29696
    v_mfma_f32_16x16x32_bf16 v[176:179], a[172:175], a[84:87], v[176:179]
    ds_read_b128 a[204:207], v10 offset:33792
    ds_read_b128 a[208:211], v10 offset:34816
    ds_read_b128 a[140:143], v10 offset:35840
    v_mfma_f32_16x16x32_bf16 v[180:183], a[172:175], a[88:91], v[180:183]
    ds_read_b128 a[156:159], v10 offset:39936
    s_waitcnt vmcnt(27)
    s_waitcnt lgkmcnt(15)
    v_mfma_f32_16x16x32_bf16 v[160:163], v[184:187], a[92:95], v[160:163]
    ds_read_b128 a[144:147], v10 offset:36864
    ds_read_b128 a[160:163], v10 offset:40960
    ds_read_b128 a[148:151], v10 offset:37888
    v_mfma_f32_16x16x32_bf16 v[160:163], v[200:203], a[96:99], v[160:163]
    ds_read_b128 a[164:167], v10 offset:41984
    ds_read_b128 a[152:155], v10 offset:38912
    ds_read_b128 a[168:171], v10 offset:43008
    v_mfma_f32_16x16x32_bf16 v[164:167], v[188:191], a[92:95], v[164:167]
    ds_read_b128 a[172:175], v10 offset:44032
    ds_read_b128 v[184:187], v10 offset:45056
    ds_read_b128 v[200:203], v10 offset:49152
    v_mfma_f32_16x16x32_bf16 v[164:167], v[204:207], a[96:99], v[164:167]
    ds_read_b128 v[188:191], v10 offset:46080
    ds_read_b128 v[204:207], v10 offset:50176
    v_mfma_f32_16x16x32_bf16 v[168:171], v[192:195], a[92:95], v[168:171]
    ds_read_b128 v[192:195], v10 offset:47104
    v_mfma_f32_16x16x32_bf16 v[168:171], v[208:211], a[96:99], v[168:171]
    ds_read_b128 v[208:211], v10 offset:51200
    v_mfma_f32_16x16x32_bf16 v[172:175], v[196:199], a[92:95], v[172:175]
    ds_read_b128 v[196:199], v10 offset:48128
    v_mfma_f32_16x16x32_bf16 v[172:175], v[212:215], a[96:99], v[172:175]
    ds_read_b128 v[212:215], v10 offset:52224
    v_mfma_f32_16x16x32_bf16 v[176:179], v[216:219], a[92:95], v[176:179]
    v_mfma_f32_16x16x32_bf16 v[180:183], v[216:219], a[96:99], v[180:183]
    ds_read_b128 v[216:219], v10 offset:53248
    s_waitcnt vmcnt(25)
    v_mfma_f32_16x16x32_bf16 v[160:163], v[220:223], a[100:103], v[160:163]
    ds_read_b128 v[220:223], v10 offset:54272
    v_mfma_f32_16x16x32_bf16 v[160:163], v[236:239], a[104:107], v[160:163]
    ds_read_b128 v[236:239], v10 offset:58368
    v_mfma_f32_16x16x32_bf16 v[164:167], v[224:227], a[100:103], v[164:167]
    ds_read_b128 v[224:227], v10 offset:55296
    v_mfma_f32_16x16x32_bf16 v[164:167], v[240:243], a[104:107], v[164:167]
    ds_read_b128 v[240:243], v10 offset:59392
    s_waitcnt lgkmcnt(15)
    v_mfma_f32_16x16x32_bf16 v[168:171], v[228:231], a[100:103], v[168:171]
    ds_read_b128 v[228:231], v10 offset:56320
    v_mfma_f32_16x16x32_bf16 v[168:171], v[244:247], a[104:107], v[168:171]
    ds_read_b128 v[244:247], v10 offset:60416
    v_mfma_f32_16x16x32_bf16 v[172:175], v[232:235], a[100:103], v[172:175]
    ds_read_b128 v[232:235], v10 offset:57344
    v_mfma_f32_16x16x32_bf16 v[172:175], v[248:251], a[104:107], v[172:175]
    ds_read_b128 v[248:251], v10 offset:61440
    v_mfma_f32_16x16x32_bf16 v[176:179], v[252:255], a[100:103], v[176:179]
    v_mfma_f32_16x16x32_bf16 v[180:183], v[252:255], a[104:107], v[180:183]
    ds_read_b128 v[252:255], v10 offset:62464
    s_waitcnt vmcnt(23)
    v_mfma_f32_16x16x32_bf16 v[160:163], a[176:179], a[116:119], v[160:163]
    ds_read_b128 a[176:179], v10 offset:63488
    v_mfma_f32_16x16x32_bf16 v[160:163], a[192:195], a[120:123], v[160:163]
    ds_read_b128 a[192:195], v11 offset:2048
    v_mfma_f32_16x16x32_bf16 v[164:167], a[180:183], a[116:119], v[164:167]
    ds_read_b128 a[180:183], v10 offset:64512
    v_mfma_f32_16x16x32_bf16 v[164:167], a[196:199], a[120:123], v[164:167]
    ds_read_b128 a[196:199], v11 offset:3072
    v_mfma_f32_16x16x32_bf16 v[168:171], a[184:187], a[116:119], v[168:171]
    ds_read_b128 a[184:187], v11 offset:0
    v_mfma_f32_16x16x32_bf16 v[168:171], a[200:203], a[120:123], v[168:171]
    ds_read_b128 a[200:203], v11 offset:4096
    v_mfma_f32_16x16x32_bf16 v[172:175], a[188:191], a[116:119], v[172:175]
    ds_read_b128 a[188:191], v11 offset:1024
    v_mfma_f32_16x16x32_bf16 v[172:175], a[204:207], a[120:123], v[172:175]
    ds_read_b128 a[204:207], v11 offset:5120
    v_mfma_f32_16x16x32_bf16 v[176:179], a[208:211], a[116:119], v[176:179]
    v_mfma_f32_16x16x32_bf16 v[180:183], a[208:211], a[120:123], v[180:183]
    ds_read_b128 a[208:211], v11 offset:6144
    s_waitcnt vmcnt(21)
    v_mfma_f32_16x16x32_bf16 v[160:163], a[140:143], a[124:127], v[160:163]
    ds_read_b128 a[140:143], v11 offset:7168
    v_mfma_f32_16x16x32_bf16 v[160:163], a[156:159], a[128:131], v[160:163]
    ds_read_b128 a[156:159], v11 offset:11264
    v_mfma_f32_16x16x32_bf16 v[164:167], a[144:147], a[124:127], v[164:167]
    ds_read_b128 a[144:147], v11 offset:8192
    v_mfma_f32_16x16x32_bf16 v[164:167], a[160:163], a[128:131], v[164:167]
    ds_read_b128 a[160:163], v11 offset:12288
    s_waitcnt lgkmcnt(15)
    v_mfma_f32_16x16x32_bf16 v[168:171], a[148:151], a[124:127], v[168:171]
    ds_read_b128 a[148:151], v11 offset:9216
    v_mfma_f32_16x16x32_bf16 v[168:171], a[164:167], a[128:131], v[168:171]
    ds_read_b128 a[164:167], v11 offset:13312
    v_mfma_f32_16x16x32_bf16 v[172:175], a[152:155], a[124:127], v[172:175]
    ds_read_b128 a[152:155], v11 offset:10240
    v_mfma_f32_16x16x32_bf16 v[172:175], a[168:171], a[128:131], v[172:175]
    ds_read_b128 a[168:171], v11 offset:14336
    v_mfma_f32_16x16x32_bf16 v[176:179], a[172:175], a[124:127], v[176:179]
    v_mfma_f32_16x16x32_bf16 v[180:183], a[172:175], a[128:131], v[180:183]
    ds_read_b128 a[172:175], v11 offset:15360
    s_waitcnt vmcnt(19)
    v_mfma_f32_16x16x32_bf16 v[160:163], v[184:187], a[132:135], v[160:163]
    ds_read_b128 v[184:187], v9 offset:0
    v_mfma_f32_16x16x32_bf16 v[160:163], v[200:203], a[136:139], v[160:163]
    ds_read_b128 v[200:203], v9 offset:4096
    v_mfma_f32_16x16x32_bf16 v[164:167], v[188:191], a[132:135], v[164:167]
    ds_read_b128 v[188:191], v9 offset:1024
    v_mfma_f32_16x16x32_bf16 v[164:167], v[204:207], a[136:139], v[164:167]
    ds_read_b128 v[204:207], v9 offset:5120
    v_mfma_f32_16x16x32_bf16 v[168:171], v[192:195], a[132:135], v[168:171]
    ds_read_b128 v[192:195], v9 offset:2048
    v_mfma_f32_16x16x32_bf16 v[168:171], v[208:211], a[136:139], v[168:171]
    ds_read_b128 v[208:211], v9 offset:6144
    v_mfma_f32_16x16x32_bf16 v[172:175], v[196:199], a[132:135], v[172:175]
    ds_read_b128 v[196:199], v9 offset:3072
    v_mfma_f32_16x16x32_bf16 v[172:175], v[212:215], a[136:139], v[172:175]
    ds_read_b128 v[212:215], v9 offset:7168
    v_mfma_f32_16x16x32_bf16 v[176:179], v[216:219], a[132:135], v[176:179]
    v_mfma_f32_16x16x32_bf16 v[180:183], v[216:219], a[136:139], v[180:183]
    ds_read_b128 v[216:219], v9 offset:8192
    s_waitcnt vmcnt(17)
    v_mfma_f32_16x16x32_bf16 v[160:163], v[220:223], a[212:215], v[160:163]
    ds_read_b128 v[220:223], v9 offset:9216
    v_mfma_f32_16x16x32_bf16 v[160:163], v[236:239], a[216:219], v[160:163]
    ds_read_b128 v[236:239], v9 offset:13312
    v_mfma_f32_16x16x32_bf16 v[164:167], v[224:227], a[212:215], v[164:167]
    ds_read_b128 v[224:227], v9 offset:10240
    v_mfma_f32_16x16x32_bf16 v[164:167], v[240:243], a[216:219], v[164:167]
    ds_read_b128 v[240:243], v9 offset:14336
    s_waitcnt lgkmcnt(15)
    v_mfma_f32_16x16x32_bf16 v[168:171], v[228:231], a[212:215], v[168:171]
    ds_read_b128 v[228:231], v9 offset:11264
    v_mfma_f32_16x16x32_bf16 v[168:171], v[244:247], a[216:219], v[168:171]
    ds_read_b128 v[244:247], v9 offset:15360
    v_mfma_f32_16x16x32_bf16 v[172:175], v[232:235], a[212:215], v[172:175]
    ds_read_b128 v[232:235], v9 offset:12288
    v_mfma_f32_16x16x32_bf16 v[172:175], v[248:251], a[216:219], v[172:175]
    ds_read_b128 v[248:251], v9 offset:16384
    v_mfma_f32_16x16x32_bf16 v[176:179], v[252:255], a[212:215], v[176:179]
    v_mfma_f32_16x16x32_bf16 v[180:183], v[252:255], a[216:219], v[180:183]
    ds_read_b128 v[252:255], v9 offset:17408
    s_waitcnt vmcnt(6)
    v_mfma_f32_16x16x32_bf16 v[160:163], a[176:179], a[220:223], v[160:163]
    v_mfma_f32_16x16x32_bf16 v[160:163], a[192:195], a[224:227], v[160:163]
    v_mfma_f32_16x16x32_bf16 v[164:167], a[180:183], a[220:223], v[164:167]
    v_mfma_f32_16x16x32_bf16 v[164:167], a[196:199], a[224:227], v[164:167]
    v_mfma_f32_16x16x32_bf16 v[168:171], a[184:187], a[220:223], v[168:171]
    v_mfma_f32_16x16x32_bf16 v[168:171], a[200:203], a[224:227], v[168:171]
    v_mfma_f32_16x16x32_bf16 v[172:175], a[188:191], a[220:223], v[172:175]
    v_mfma_f32_16x16x32_bf16 v[172:175], a[204:207], a[224:227], v[172:175]
    v_mfma_f32_16x16x32_bf16 v[176:179], a[208:211], a[220:223], v[176:179]
    v_mfma_f32_16x16x32_bf16 v[180:183], a[208:211], a[224:227], v[180:183]
    s_waitcnt vmcnt(4)
    v_mfma_f32_16x16x32_bf16 v[160:163], a[140:143], a[228:231], v[160:163]
    v_mfma_f32_16x16x32_bf16 v[160:163], a[156:159], a[232:235], v[160:163]
    v_mfma_f32_16x16x32_bf16 v[164:167], a[144:147], a[228:231], v[164:167]
    v_mfma_f32_16x16x32_bf16 v[164:167], a[160:163], a[232:235], v[164:167]
    s_waitcnt lgkmcnt(15)
    v_mfma_f32_16x16x32_bf16 v[168:171], a[148:151], a[228:231], v[168:171]
    v_mfma_f32_16x16x32_bf16 v[168:171], a[164:167], a[232:235], v[168:171]
    v_mfma_f32_16x16x32_bf16 v[172:175], a[152:155], a[228:231], v[172:175]
    buffer_load_dwordx4 v[100:103], v9, s[16:19], s40 offen sc1
    v_mfma_f32_16x16x32_bf16 v[172:175], a[168:171], a[232:235], v[172:175]
    buffer_load_dwordx4 v[104:107], v9, s[16:19], s40 offen offset:1024 sc1
    v_mfma_f32_16x16x32_bf16 v[176:179], a[172:175], a[228:231], v[176:179]
    buffer_load_dwordx2 v[108:109], v12, s[16:19], s40 offen offset:2048 sc1
    v_mfma_f32_16x16x32_bf16 v[180:183], a[172:175], a[232:235], v[180:183]
    s_waitcnt vmcnt(5)
    s_waitcnt lgkmcnt(14)
    v_mfma_f32_16x16x32_bf16 v[160:163], v[184:187], a[236:239], v[160:163]
    buffer_load_dwordx4 v[112:115], v9, s[16:19], s44 offen sc1
    v_mfma_f32_16x16x32_bf16 v[160:163], v[200:203], a[240:243], v[160:163]
    buffer_load_dwordx4 v[116:119], v9, s[16:19], s44 offen offset:1024 sc1
    v_mfma_f32_16x16x32_bf16 v[164:167], v[188:191], a[236:239], v[164:167]
    buffer_load_dwordx2 v[120:121], v12, s[16:19], s44 offen offset:2048 sc1
    v_mfma_f32_16x16x32_bf16 v[164:167], v[204:207], a[240:243], v[164:167]
    buffer_load_dwordx4 v[124:127], v9, s[16:19], s45 offen sc1
    s_waitcnt lgkmcnt(9)
    v_mfma_f32_16x16x32_bf16 v[168:171], v[192:195], a[236:239], v[168:171]
    buffer_load_dwordx4 v[128:131], v9, s[16:19], s45 offen offset:1024 sc1
    v_mfma_f32_16x16x32_bf16 v[168:171], v[208:211], a[240:243], v[168:171]
    buffer_load_dwordx2 v[132:133], v12, s[16:19], s45 offen offset:2048 sc1
    v_mfma_f32_16x16x32_bf16 v[172:175], v[196:199], a[236:239], v[172:175]
    v_mfma_f32_16x16x32_bf16 v[172:175], v[212:215], a[240:243], v[172:175]
    v_mfma_f32_16x16x32_bf16 v[176:179], v[216:219], a[236:239], v[176:179]
    v_mfma_f32_16x16x32_bf16 v[180:183], v[216:219], a[240:243], v[180:183]
    s_waitcnt vmcnt(9)
    s_waitcnt lgkmcnt(5)
    v_mfma_f32_16x16x32_bf16 v[160:163], v[220:223], a[244:247], v[160:163]
    v_mfma_f32_16x16x32_bf16 v[160:163], v[236:239], a[248:251], v[160:163]
    v_mfma_f32_16x16x32_bf16 v[164:167], v[224:227], a[244:247], v[164:167]
    v_mfma_f32_16x16x32_bf16 v[164:167], v[240:243], a[248:251], v[164:167]
    s_waitcnt lgkmcnt(0)
    v_mfma_f32_16x16x32_bf16 v[168:171], v[228:231], a[244:247], v[168:171]
    v_mfma_f32_16x16x32_bf16 v[168:171], v[244:247], a[248:251], v[168:171]
    v_mfma_f32_16x16x32_bf16 v[172:175], v[232:235], a[244:247], v[172:175]
    v_mfma_f32_16x16x32_bf16 v[172:175], v[248:251], a[248:251], v[172:175]
    v_mfma_f32_16x16x32_bf16 v[176:179], v[252:255], a[244:247], v[176:179]
    v_mfma_f32_16x16x32_bf16 v[180:183], v[252:255], a[248:251], v[180:183]
    ds_read_b64_tr_b16 v[140:141], v15 offset:0
    ds_read_b64_tr_b16 v[142:143], v15 offset:128
    ds_read_b64_tr_b16 v[144:145], v15 offset:1024
    ds_read_b64_tr_b16 v[146:147], v15 offset:1152
    ds_read_b64_tr_b16 v[148:149], v16 offset:2048
    s_nop 2
    v_cndmask_b32 v176, v180, v176, s[52:53]
    v_cndmask_b32 v177, v181, v177, s[52:53]
    v_cndmask_b32 v178, v182, v178, s[52:53]
    v_cndmask_b32 v179, v183, v179, s[52:53]
    s_waitcnt lgkmcnt(0)
    v_lshlrev_b32 v184, 16, v140
    v_and_b32 v185, s34, v140
    v_lshlrev_b32 v186, 16, v141
    v_and_b32 v187, s34, v141
    v_lshlrev_b32 v188, 16, v142
    v_and_b32 v189, s34, v142
    v_lshlrev_b32 v190, 16, v143
    v_and_b32 v191, s34, v143
    v_lshlrev_b32 v192, 16, v144
    v_and_b32 v193, s34, v144
    v_lshlrev_b32 v194, 16, v145
    v_and_b32 v195, s34, v145
    v_lshlrev_b32 v196, 16, v146
    v_and_b32 v197, s34, v146
    v_lshlrev_b32 v198, 16, v147
    v_and_b32 v199, s34, v147
    v_lshlrev_b32 v200, 16, v148
    v_and_b32 v201, s34, v148
    v_lshlrev_b32 v202, 16, v149
    v_and_b32 v203, s34, v149
    s_waitcnt vmcnt(0)
    v_max_u32 v136, v100, v101
    v_max3_u32 v136, v102, v103, v136
    v_max3_u32 v136, v104, v105, v136
    v_max3_u32 v136, v106, v107, v136
    v_max3_u32 v136, v108, v109, v136
    v_max3_u32 v136, v112, v113, v136
    v_max3_u32 v136, v114, v115, v136
    v_max3_u32 v136, v116, v117, v136
    v_max3_u32 v136, v118, v119, v136
    v_max3_u32 v136, v120, v121, v136
    v_max3_u32 v136, v124, v125, v136
    v_max3_u32 v136, v126, v127, v136
    v_max3_u32 v136, v128, v129, v136
    v_max3_u32 v136, v130, v131, v136
    v_max3_u32 v136, v132, v133, v136
    v_cmp_eq_u32 vcc, -1, v136
    s_nop 3
    s_cbranch_vccnz XP_SLOW
XP_OK:
    v_lshlrev_b32 v64, 16, v100
    v_and_b32 v65, s34, v100
    v_lshlrev_b32 v66, 16, v101
    v_and_b32 v67, s34, v101
    v_lshlrev_b32 v68, 16, v102
    v_and_b32 v69, s34, v102
    v_lshlrev_b32 v70, 16, v103
    v_and_b32 v71, s34, v103
    v_lshlrev_b32 v72, 16, v104
    v_and_b32 v73, s34, v104
    v_lshlrev_b32 v74, 16, v105
    v_and_b32 v75, s34, v105
    v_lshlrev_b32 v76, 16, v106
    v_and_b32 v77, s34, v106
    v_lshlrev_b32 v78, 16, v107
    v_and_b32 v79, s34, v107
    v_lshlrev_b32 v80, 16, v108
    v_and_b32 v81, s34, v108
    v_lshlrev_b32 v82, 16, v109
    v_and_b32 v83, s34, v109
    v_pk_add_f32 v[160:161], v[160:161], v[64:65]
    v_pk_add_f32 v[162:163], v[162:163], v[66:67]
    v_pk_add_f32 v[164:165], v[164:165], v[68:69]
    v_pk_add_f32 v[166:167], v[166:167], v[70:71]
    v_pk_add_f32 v[168:169], v[168:169], v[72:73]
    v_pk_add_f32 v[170:171], v[170:171], v[74:75]
    v_pk_add_f32 v[172:173], v[172:173], v[76:77]
    v_pk_add_f32 v[174:175], v[174:175], v[78:79]
    v_pk_add_f32 v[176:177], v[176:177], v[80:81]
    v_pk_add_f32 v[178:179], v[178:179], v[82:83]
    v_lshlrev_b32 v64, 16, v112
    v_and_b32 v65, s34, v112
    v_lshlrev_b32 v66, 16, v113
    v_and_b32 v67, s34, v113
    v_lshlrev_b32 v68, 16, v114
    v_and_b32 v69, s34, v114
    v_lshlrev_b32 v70, 16, v115
    v_and_b32 v71, s34, v115
    v_lshlrev_b32 v72, 16, v116
    v_and_b32 v73, s34, v116
    v_lshlrev_b32 v74, 16, v117
    v_and_b32 v75, s34, v117
    v_lshlrev_b32 v76, 16, v118
    v_and_b32 v77, s34, v118
    v_lshlrev_b32 v78, 16, v119
    v_and_b32 v79, s34, v119
    v_lshlrev_b32 v80, 16, v120
    v_and_b32 v81, s34, v120
    v_lshlrev_b32 v82, 16, v121
    v_and_b32 v83, s34, v121
    v_pk_add_f32 v[160:161], v[160:161], v[64:65]
    v_pk_add_f32 v[162:163], v[162:163], v[66:67]
    v_pk_add_f32 v[164:165], v[164:165], v[68:69]
    v_pk_add_f32 v[166:167], v[166:167], v[70:71]
    v_pk_add_f32 v[168:169], v[168:169], v[72:73]
    v_pk_add_f32 v[170:171], v[170:171], v[74:75]
    v_pk_add_f32 v[172:173], v[172:173], v[76:77]
    v_pk_add_f32 v[174:175], v[174:175], v[78:79]
    v_pk_add_f32 v[176:177], v[176:177], v[80:81]
    v_pk_add_f32 v[178:179], v[178:179], v[82:83]
    v_lshlrev_b32 v64, 16, v124
    v_and_b32 v65, s34, v124
    v_lshlrev_b32 v66, 16, v125
    v_and_b32 v67, s34, v125
    v_lshlrev_b32 v68, 16, v126
    v_and_b32 v69, s34, v126
    v_lshlrev_b32 v70, 16, v127
    v_and_b32 v71, s34, v127
    v_lshlrev_b32 v72, 16, v128
    v_and_b32 v73, s34, v128
    v_lshlrev_b32 v74, 16, v129
    v_and_b32 v75, s34, v129
    v_lshlrev_b32 v76, 16, v130
    v_and_b32 v77, s34, v130
    v_lshlrev_b32 v78, 16, v131
    v_and_b32 v79, s34, v131
    v_lshlrev_b32 v80, 16, v132
    v_and_b32 v81, s34, v132
    v_lshlrev_b32 v82, 16, v133
    v_and_b32 v83, s34, v133
    v_pk_add_f32 v[160:161], v[160:161], v[64:65]
    v_pk_add_f32 v[162:163], v[162:163], v[66:67]
    v_pk_add_f32 v[164:165], v[164:165], v[68:69]
    v_pk_add_f32 v[166:167], v[166:167], v[70:71]
    v_pk_add_f32 v[168:169], v[168:169], v[72:73]
    v_pk_add_f32 v[170:171], v[170:171], v[74:75]
    v_pk_add_f32 v[172:173], v[172:173], v[76:77]
    v_pk_add_f32 v[174:175], v[174:175], v[78:79]
    v_pk_add_f32 v[176:177], v[176:177], v[80:81]
    v_pk_add_f32 v[178:179], v[178:179], v[82:83]
    v_mov_b32 v64, v176
    v_mov_b32 v65, v177
    v_mov_b32 v66, v178
    v_mov_b32 v67, v179
    v_permlane32_swap_b32 v176, v64
    v_permlane32_swap_b32 v177, v65
    v_permlane32_swap_b32 v178, v66
    v_permlane32_swap_b32 v179, v67
    v_add_f32 v176, v176, v64
    v_add_f32 v177, v177, v65
    v_add_f32 v178, v178, v66
    v_add_f32 v179, v179, v67
    v_pk_mul_f32 v[160:161], v[160:161], v[14:15] op_sel_hi:[1,0]
    v_pk_mul_f32 v[162:163], v[162:163], v[14:15] op_sel_hi:[1,0]
    v_cvt_pk_bf16_f32 v160, 0, v160
    v_cvt_pk_bf16_f32 v161, 0, v161
    v_cvt_pk_bf16_f32 v162, 0, v162
    v_cvt_pk_bf16_f32 v163, 0, v163
    v_pk_add_f32 v[160:161], v[160:161], v[184:185]
    v_pk_add_f32 v[162:163], v[162:163], v[186:187]
    v_cvt_pk_bf16_f32 v150, v160, v161
    v_cvt_pk_bf16_f32 v151, v162, v163
    v_pk_mul_f32 v[164:165], v[164:165], v[14:15] op_sel_hi:[1,0]
    v_pk_mul_f32 v[166:167], v[166:167], v[14:15] op_sel_hi:[1,0]
    v_cvt_pk_bf16_f32 v164, 0, v164
    v_cvt_pk_bf16_f32 v165, 0, v165
    v_cvt_pk_bf16_f32 v166, 0, v166
    v_cvt_pk_bf16_f32 v167, 0, v167
    v_pk_add_f32 v[164:165], v[164:165], v[188:189]
    v_pk_add_f32 v[166:167], v[166:167], v[190:191]
    v_cvt_pk_bf16_f32 v152, v164, v165
    v_cvt_pk_bf16_f32 v153, v166, v167
    buffer_store_dwordx4 v[150:153], v8, s[68:71], s33 offen offset:0
    v_pk_mul_f32 v[168:169], v[168:169], v[14:15] op_sel_hi:[1,0]
    v_pk_mul_f32 v[170:171], v[170:171], v[14:15] op_sel_hi:[1,0]
    v_cvt_pk_bf16_f32 v168, 0, v168
    v_cvt_pk_bf16_f32 v169, 0, v169
    v_cvt_pk_bf16_f32 v170, 0, v170
    v_cvt_pk_bf16_f32 v171, 0, v171
    v_pk_add_f32 v[168:169], v[168:169], v[192:193]
    v_pk_add_f32 v[170:171], v[170:171], v[194:195]
    v_cvt_pk_bf16_f32 v154, v168, v169
    v_cvt_pk_bf16_f32 v155, v170, v171
    v_pk_mul_f32 v[172:173], v[172:173], v[14:15] op_sel_hi:[1,0]
    v_pk_mul_f32 v[174:175], v[174:175], v[14:15] op_sel_hi:[1,0]
    v_cvt_pk_bf16_f32 v172, 0, v172
    v_cvt_pk_bf16_f32 v173, 0, v173
    v_cvt_pk_bf16_f32 v174, 0, v174
    v_cvt_pk_bf16_f32 v175, 0, v175
    v_pk_add_f32 v[172:173], v[172:173], v[196:197]
    v_pk_add_f32 v[174:175], v[174:175], v[198:199]
    v_cvt_pk_bf16_f32 v156, v172, v173
    v_cvt_pk_bf16_f32 v157, v174, v175
    buffer_store_dwordx4 v[154:157], v8, s[68:71], s33 offen offset:64
    v_pk_mul_f32 v[176:177], v[176:177], v[14:15] op_sel_hi:[1,0]
    v_pk_mul_f32 v[178:179], v[178:179], v[14:15] op_sel_hi:[1,0]
    v_cvt_pk_bf16_f32 v176, 0, v176
    v_cvt_pk_bf16_f32 v177, 0, v177
    v_cvt_pk_bf16_f32 v178, 0, v178
    v_cvt_pk_bf16_f32 v179, 0, v179
    v_pk_add_f32 v[176:177], v[176:177], v[200:201]
    v_pk_add_f32 v[178:179], v[178:179], v[202:203]
    v_cvt_pk_bf16_f32 v158, v176, v177
    v_cvt_pk_bf16_f32 v159, v178, v179
    buffer_store_dwordx2 v[158:159], v17, s[68:71], s33 offen offset:128
    s_endpgm
XP_SLOW:
    s_mov_b32 s59, 200000
XP_LOOP:
    s_sleep 6
    buffer_load_dwordx4 v[100:103], v9, s[16:19], s40 offen sc1
    buffer_load_dwordx4 v[104:107], v9, s[16:19], s40 offen offset:1024 sc1
    buffer_load_dwordx2 v[108:109], v12, s[16:19], s40 offen offset:2048 sc1
    buffer_load_dwordx4 v[112:115], v9, s[16:19], s44 offen sc1
    buffer_load_dwordx4 v[116:119], v9, s[16:19], s44 offen offset:1024 sc1
    buffer_load_dwordx2 v[120:121], v12, s[16:19], s44 offen offset:2048 sc1
    buffer_load_dwordx4 v[124:127], v9, s[16:19], s45 offen sc1
    buffer_load_dwordx4 v[128:131], v9, s[16:19], s45 offen offset:1024 sc1
    buffer_load_dwordx2 v[132:133], v12, s[16:19], s45 offen offset:2048 sc1
    s_waitcnt vmcnt(0)
    v_max_u32 v136, v100, v101
    v_max3_u32 v136, v102, v103, v136
    v_max3_u32 v136, v104, v105, v136
    v_max3_u32 v136, v106, v107, v136
    v_max3_u32 v136, v108, v109, v136
    v_max3_u32 v136, v112, v113, v136
    v_max3_u32 v136, v114, v115, v136
    v_max3_u32 v136, v116, v117, v136
    v_max3_u32 v136, v118, v119, v136
    v_max3_u32 v136, v120, v121, v136
    v_max3_u32 v136, v124, v125, v136
    v_max3_u32 v136, v126, v127, v136
    v_max3_u32 v136, v128, v129, v136
    v_max3_u32 v136, v130, v131, v136
    v_max3_u32 v136, v132, v133, v136
    v_cmp_eq_u32 vcc, -1, v136
    s_nop 3
    s_cbranch_vccz XP_OK
    s_sub_u32 s59, s59, 1
    s_cmp_lg_u32 s59, 0
    s_cbranch_scc1 XP_LOOP
    s_branch XP_OK
XC_SLOW:
    s_mov_b32 s59, 200000
XC_LOOP:
    buffer_load_dword v136, v13, s[64:67], s36 offen sc1
    s_waitcnt vmcnt(0)
    v_cmp_ne_u32 vcc, 1, v136
    s_nop 3
    s_cbranch_vccz XC_OK
    s_sleep 2
    s_sub_u32 s59, s59, 1
    s_cmp_lg_u32 s59, 0
    s_cbranch_scc1 XC_LOOP
    s_branch XC_OK
POLL_SLOW0:
    s_mov_b32 s59, 200000
POLL_LOOP0:
    buffer_load_dword v7, v4, s[64:67], s50 offen offset:0 sc1
    s_waitcnt vmcnt(0)
    v_cmp_eq_u32 vcc, 0, v7
    s_nop 3
    s_cbranch_vccz POLL_OK0
    s_sleep 2
    s_sub_u32 s59, s59, 1
    s_cmp_lg_u32 s59, 0
    s_cbranch_scc1 POLL_LOOP0
    s_branch POLL_OK0
POLL_SLOW1:
    s_mov_b32 s59, 200000
POLL_LOOP1:
    buffer_load_dword v7, v4, s[64:67], s50 offen offset:256 sc1
    s_waitcnt vmcnt(0)
    v_cmp_eq_u32 vcc, 0, v7
    s_nop 3
    s_cbranch_vccz POLL_OK1
    s_sleep 2
    s_sub_u32 s59, s59, 1
    s_cmp_lg_u32 s59, 0
    s_cbranch_scc1 POLL_LOOP1
    s_branch POLL_OK1
POLL_SLOW2:
    s_mov_b32 s59, 200000
POLL_LOOP2:
    buffer_load_dword v7, v4, s[64:67], s50 offen offset:512 sc1
    s_waitcnt vmcnt(0)
    v_cmp_eq_u32 vcc, 0, v7
    s_nop 3
    s_cbranch_vccz POLL_OK2
    s_sleep 2
    s_sub_u32 s59, s59, 1
    s_cmp_lg_u32 s59, 0
    s_cbranch_scc1 POLL_LOOP2
    s_branch POLL_OK2
G2_END:
    s_endpgm
.section .rodata,"a"
.p2align 6
.amdhsa_kernel k1_kernel
  .amdhsa_next_free_vgpr 248
  .amdhsa_next_free_sgpr 80
  .amdhsa_accum_offset 248
  .amdhsa_group_segment_fixed_size 0
  .amdhsa_kernarg_size 112
  .amdhsa_user_sgpr_count 2
  .amdhsa_user_sgpr_kernarg_segment_ptr 1
  .amdhsa_system_sgpr_workgroup_id_x 1
.end_amdhsa_kernel
.p2align 6
.amdhsa_kernel k3_kernel
  .amdhsa_next_free_vgpr 512
  .amdhsa_next_free_sgpr 102
  .amdhsa_accum_offset 256
  .amdhsa_group_segment_fixed_size 0
  .amdhsa_kernarg_size 112
  .amdhsa_user_sgpr_count 2
  .amdhsa_user_sgpr_kernarg_segment_ptr 1
  .amdhsa_system_sgpr_workgroup_id_x 1
.end_amdhsa_kernel
```
